```python
import torch

def _softmax(x, axis=-1):
    return torch.softmax(x, dim=axis)
def _gelu(x):
    return torch.nn.functional.gelu(x, approximate="tanh")
def _silu(x):
    return torch.nn.functional.silu(x)
def _sigmoid(x):
    return torch.sigmoid(x)
def _layernorm(x, axis=-1, eps=1e-5):
    m = x.mean(dim=axis, keepdim=True)
    v = x.var(dim=axis, keepdim=True, unbiased=False)
    return (x - m) / torch.sqrt(v + eps)
def _scatter_add(tgt, idx, src, axis=0):
    return tgt.clone().index_add_(axis, idx, src)
def _segment_sum(src, seg, n):
    out = torch.zeros((n,) + src.shape[1:], dtype=src.dtype)
    return out.index_add_(0, seg, src)
def _pad(x, pw):
    flat = tuple(v for pair in reversed(pw) for v in pair)
    return torch.nn.functional.pad(x, flat)

kernel_name = 'concat_heads__ssm_conv_s4d__linear_kernel_hedgehog__prompt'

def setup_inputs():

    _w = (lambda a: (lambda t: t.to(torch.bfloat16) if t.is_floating_point() else t)(torch.as_tensor(a)))
    def _A_setup():
        Bsz, L, D, N = 1, 2048, 576, 128
        return {
            "u": _w((lambda *s: torch.randn(*s, dtype=torch.bfloat16) * 0.05)(Bsz, L, D)),
            "log_A_real": _w((lambda *s: torch.randn(*s, dtype=torch.bfloat16) * 3.2)(D, N) * 0.5),
            "A_imag": _w((lambda *s: torch.randn(*s, dtype=torch.bfloat16) * 0.2)(D, N) * 3.14),
            "C_real": _w((lambda *s: torch.randn(*s, dtype=torch.bfloat16) * 3.2)(D, N) / N ** 0.5),
            "C_imag": _w((lambda *s: torch.randn(*s, dtype=torch.bfloat16) * 3.2)(D, N) / N ** 0.5),
            "log_dt": _w((lambda *s: torch.randn(*s, dtype=torch.bfloat16) * 0.2)(D) * 0.5 - 4.0),
            "D_skip": _w((lambda *s: torch.randn(*s, dtype=torch.bfloat16) * 0.4)(D)),
        }
    _A_in = _A_setup()

    def _B_setup():
        B, S, D, H = 1, 2048, 576, 32
        Dh = D // H
        return {
            "x": _w((lambda *s: torch.randn(*s, dtype=torch.bfloat16) * 0.4)(B, S, D)),
            "wqkv": _w((lambda *s: torch.randn(*s, dtype=torch.bfloat16) * 0.4)(D, 3 * D)),
            "w_phi": _w((lambda *s: torch.randn(*s, dtype=torch.bfloat16) * 0.4)(H, Dh, Dh) * (Dh ** -0.5)),
            "wo": _w((lambda *s: torch.randn(*s, dtype=torch.bfloat16) * 0.05)(D, D)),
        }
    _B_in = _B_setup()

    return {
        "A_u": _A_in["u"],
        "A_log_A_real": _A_in["log_A_real"],
        "A_A_imag": _A_in["A_imag"],
        "A_C_real": _A_in["C_real"],
        "A_C_imag": _A_in["C_imag"],
        "A_log_dt": _A_in["log_dt"],
        "A_D_skip": _A_in["D_skip"],
        "B_x": _B_in["x"],
        "B_wqkv": _B_in["wqkv"],
        "B_w_phi": _B_in["w_phi"],
        "B_wo": _B_in["wo"],
    }

def reference(A_u, A_log_A_real, A_A_imag, A_C_real, A_C_imag, A_log_dt, A_D_skip, B_x, B_wqkv, B_w_phi, B_wo):
    def _A_ref(u, log_A_real, A_imag, C_real, C_imag, log_dt, D_skip):
        L = u.shape[1]
        dt = torch.exp(log_dt)
        A = -torch.exp(log_A_real) + 1j * A_imag
        C = (C_real + 1j * C_imag) * dt[:, None]
        pos = (lambda x, dt: x.to(dt))(torch.arange(L), log_dt.dtype)
        P = torch.exp((A * dt[:, None])[:, :, None] * pos[None, None, :])
        K = 2.0 * torch.einsum("dn,dnl->dl", C, P).real
        L2 = 2 * L
        u_t = (lambda x, *d: x.permute(*d))(u, 0, 2, 1)
        Kf = (lambda x, *a, **k: torch.fft.rfft(x.float(), *a, **k))(K, L2)
        Uf = (lambda x, *a, **k: torch.fft.rfft(x.float(), *a, **k))(u_t, L2)
        y = (lambda x, *a, **k: torch.fft.irfft(x, *a, **k).to(torch.bfloat16))(Uf * Kf[None, :, :], L2)[:, :, :L]
        y = (lambda x, *d: x.permute(*d))(y, 0, 2, 1)
        return y + u * D_skip[None, None, :]

    def _B_ref(x, wqkv, w_phi, wo):
        B, S, D = x.shape
        H = 32; Dh = D // H
        qkv = (lambda x, *d: x.permute(*d))((x @ wqkv).reshape(B, S, 3, H, Dh), 2, 0, 3, 1, 4)
        q, k, v = qkv[0], qkv[1], qkv[2]
        pq = torch.einsum("bhsd,hdf->bhsf", q, w_phi)
        pk = torch.einsum("bhsd,hdf->bhsf", k, w_phi)
        phi_q = torch.concatenate([_softmax(pq, axis=-1), _softmax(-pq, axis=-1)], axis=-1)
        phi_k = torch.concatenate([_softmax(pk, axis=-1), _softmax(-pk, axis=-1)], axis=-1)
        kv = torch.einsum("bhsf,bhsd->bhfd", phi_k, v)
        z  = torch.einsum("bhsf->bhf", phi_k)
        num = torch.einsum("bhqf,bhfd->bhqd", phi_q, kv)
        den = torch.einsum("bhqf,bhf->bhq", phi_q, z)[..., None] + 1e-6
        o = num / den
        return (lambda x, *d: x.permute(*d))(o, 0, 2, 1, 3).reshape(B, S, D) @ wo

    a = _A_ref(A_u, A_log_A_real, A_A_imag, A_C_real, A_C_imag, A_log_dt, A_D_skip)
    b = _B_ref(B_x, B_wqkv, B_w_phi, B_wo)
    return torch.concatenate([a, b], axis=-1)
```

```asm
; @launch grid=(256,1,1) block=(512,1,1) lds=163840
.amdgcn_target "amdgcn-amd-amdhsa--gfx950"
.text
.globl concat_heads__ssm_conv_s4d__linear_kernel_hedgehog__prompt_kernel
.p2align 8
.type concat_heads__ssm_conv_s4d__linear_kernel_hedgehog__prompt_kernel,@function
concat_heads__ssm_conv_s4d__linear_kernel_hedgehog__prompt_kernel:
    s_load_dwordx16 s[16:31], s[0:1], 0
    s_load_dwordx8 s[32:39], s[0:1], 64
    s_load_dwordx4 s[40:43], s[0:1], 96
    s_memrealtime s[76:77]
    s_cmp_ge_u32 s2, 256
    s_cbranch_scc1 L_exit
    v_lshrrev_b32 v1, 6, v0
    v_and_b32 v2, 63, v0
    v_readfirstlane_b32 s6, v1
    s_and_b32 s10, s2, 7
    s_lshr_b32 s11, s2, 3
    s_cmp_lg_u32 s11, 16
    s_cbranch_scc1 L_nocpf
    s_getpc_b64 s[90:91]
L_pc:
    v_lshlrev_b32 v3, 7, v0
    v_min_u32 v3, L_code_end-L_pc, v3
    global_load_dword v255, v3, s[90:91]
L_nocpf:
    v_lshrrev_b32 v19, 4, v2
    v_and_b32 v22, 15, v2
    v_bfe_u32 v23, v2, 2, 2
    v_and_b32 v24, 3, v2
    s_and_b32 s12, s6, 3
    s_lshr_b32 s13, s6, 2
    s_lshr_b32 s4, s10, 1
    s_lshl_b32 s4, s4, 2
    s_and_b32 s14, s11, 3
    s_add_u32 s4, s4, s14
    s_and_b32 s15, s10, 1
    s_cmp_lt_u32 s11, 16
    s_cbranch_scc0 L_notB
    s_mov_b32 s95, 0
    s_lshl_b32 s5, s15, 2
    s_lshr_b32 s14, s11, 2
    s_add_u32 s5, s5, s14
    s_mul_i32 s92, s5, 144
    s_add_u32 s93, s92, 2304
    s_add_u32 s92, s92, 1152
    s_lshl_b32 s68, s12, 1
    s_lshl_b32 s65, s4, 7
    s_mov_b32 s70, 95232
    s_branch L_gemm
L_notB:
    s_cmp_lt_u32 s11, 24
    s_cbranch_scc1 L_A
    s_cmp_eq_u32 s10, 7
    s_cbranch_scc1 L_A
    s_mov_b32 s95, 1
    s_lshl_b32 s5, s15, 1
    s_bfe_u32 s14, s11, 0x10002
    s_add_u32 s5, s5, s14
    s_and_b32 s14, s11, 7
    s_cmp_eq_u32 s10, 6
    s_cselect_b32 s4, 12, s4
    s_cselect_b32 s5, s14, s5
    s_cmp_ge_u32 s5, 4
    s_cselect_b32 s95, 3, s95
    s_lshl_b32 s3, s4, 2
    s_add_u32 s3, s3, s5
    s_lshl_b32 s14, s6, 2
    s_lshr_b32 s68, 0x74208630, s14
    s_and_b32 s68, s68, 15
    s_mul_i32 s92, s5, 288
    s_add_u32 s93, s92, 144
    s_mul_i32 s65, s4, 160
    s_mov_b32 s70, 61440
L_gemm:
    s_mul_i32 s14, s4, 2
    s_mul_i32 s15, s5, 5
    s_add_u32 s14, s14, s15
    s_mul_i32 s15, s14, 7282
    s_lshr_b32 s15, s15, 16
    s_mul_i32 s15, s15, 9
    s_sub_u32 s14, s14, s15

    s_add_u32 s89, s4, s5
    s_mul_i32 s15, s89, 21846
    s_lshr_b32 s15, s15, 16
    s_mul_i32 s15, s15, 3
    s_sub_u32 s89, s89, s15
    s_mov_b32 s14, s89
    s_lshl_b32 s64, s14, 7
    s_mul_i32 s66, s14, 221184
    s_lshl_b32 s69, s68, 11
    s_mul_i32 s14, s12, 2304
    s_add_u32 s70, s70, s14
    s_lshl_b32 s15, s68, 4
    s_add_u32 s14, s65, s15
    v_lshrrev_b32 v18, 3, v2
    v_add_u32 v3, s14, v18
    v_mul_u32_u24 v3, 1152, v3
    v_and_b32 v20, 7, v2
    v_xor_b32 v21, v20, v19
    v_lshl_add_u32 v3, v21, 4, v3
    v_xor_b32 v4, 64, v3
    v_add_u32 v4, 9216, v4
    s_mul_i32 s14, s12, 55296
    v_mul_u32_u24 v20, 57, v2
    v_lshrrev_b32 v20, 9, v20
    v_mul_u32_u24 v21, 9, v20
    v_sub_u32 v21, v2, v21
    v_lshl_add_u32 v21, v21, 4, s14

    v_add_u32 v27, 0, v20
    v_and_b32 v25, 1, v27
    v_bfe_u32 v26, v27, 1, 2
    v_and_b32 v27, 8, v27
    v_lshl_add_u32 v27, v25, 2, v27
    v_add_u32 v27, v27, v26
    v_mul_u32_u24 v27, 3456, v27
    v_add_u32 v5, v27, v21

    v_add_u32 v27, 7, v20
    v_and_b32 v25, 1, v27
    v_bfe_u32 v26, v27, 1, 2
    v_and_b32 v27, 8, v27
    v_lshl_add_u32 v27, v25, 2, v27
    v_add_u32 v27, v27, v26
    v_mul_u32_u24 v27, 3456, v27
    v_add_u32 v6, v27, v21

    v_add_u32 v27, 14, v20
    v_and_b32 v25, 1, v27
    v_bfe_u32 v26, v27, 1, 2
    v_and_b32 v27, 8, v27
    v_lshl_add_u32 v27, v25, 2, v27
    v_add_u32 v27, v27, v26
    v_mul_u32_u24 v27, 3456, v27
    v_add_u32 v7, v27, v21

    s_waitcnt lgkmcnt(0)
    s_mov_b32 s44, s30
    s_mov_b32 s45, s31
    s_mov_b32 s46, 2359296
    s_mov_b32 s47, 0x00020000
    s_mov_b32 s48, s32
    s_mov_b32 s49, s33
    s_mov_b32 s50, 1990656
    s_mov_b32 s51, 0x00020000
    s_cmp_eq_u32 s95, 3
    s_cbranch_scc1 L_common
    s_cmp_eq_u32 s13, 0
    s_cbranch_scc1 L_w0

    s_add_u32 m0, s69, 0
    s_nop 0
    buffer_load_dwordx4 v3, s[44:47], s64 offen lds
    s_add_u32 m0, s69, 1024
    s_nop 0
    buffer_load_dwordx4 v4, s[44:47], s64 offen lds
    s_add_u32 s65, s64, 18432
    s_add_u32 m0, s69, 2048
    s_nop 0
    buffer_load_dwordx4 v3, s[44:47], s65 offen lds
    s_add_u32 m0, s69, 3072
    s_nop 0
    buffer_load_dwordx4 v4, s[44:47], s65 offen lds
    s_cmp_lt_u32 s6, 6
    s_cbranch_scc1 L_x0d
    s_cmp_eq_u32 s95, 0
    s_cbranch_scc1 L_x0d
    s_add_u32 s65, s64, 36864
    s_add_u32 m0, s69, 4096
    s_nop 0
    buffer_load_dwordx4 v3, s[44:47], s65 offen lds
    s_add_u32 m0, s69, 5120
    s_nop 0
    buffer_load_dwordx4 v4, s[44:47], s65 offen lds
L_x0d:
    s_add_u32 s64, s64, 128
    s_cmp_eq_u32 s64, 1152
    s_cselect_b32 s64, 0, s64
    s_branch L_common
L_w0:
    s_add_u32 s67, s66, s92
    s_add_u32 m0, s70, 18432
    s_mov_b32 exec_hi, 0x7fffffff
    buffer_load_dwordx4 v5, s[48:51], s67 offen lds
    s_mov_b64 exec, -1
    s_add_u32 m0, s70, 19440
    s_mov_b32 exec_hi, 0x7fffffff
    buffer_load_dwordx4 v6, s[48:51], s67 offen lds
    s_mov_b64 exec, -1
    s_add_u32 m0, s70, 20448
    s_mov_b64 exec, 0x3ffff
    buffer_load_dwordx4 v7, s[48:51], s67 offen lds
    s_mov_b64 exec, -1
    s_add_u32 s67, s66, s93
    s_add_u32 m0, s70, 27648
    s_mov_b32 exec_hi, 0x7fffffff
    buffer_load_dwordx4 v5, s[48:51], s67 offen lds
    s_mov_b64 exec, -1
    s_add_u32 m0, s70, 28656
    s_mov_b32 exec_hi, 0x7fffffff
    buffer_load_dwordx4 v6, s[48:51], s67 offen lds
    s_mov_b64 exec, -1
    s_add_u32 m0, s70, 29664
    s_mov_b64 exec, 0x3ffff
    buffer_load_dwordx4 v7, s[48:51], s67 offen lds
    s_mov_b64 exec, -1
    s_add_u32 s66, s66, 221184
    s_cmp_eq_u32 s66, 1990656
    s_cselect_b32 s66, 0, s66
    s_branch L_common
L_A:
    s_lshl_b32 s4, s10, 3
    s_add_u32 s4, s4, s11
    s_sub_u32 s4, s4, 16
    s_lshl_b32 s5, s4, 3
    s_add_u32 s5, s5, s6
    s_lshl_b32 s3, s5, 8
    v_lshl_add_u32 v3, v2, 2, s3
    s_lshl_b32 s14, s5, 1
    v_mov_b32 v28, s14
    v_mov_b32 v74, v19
    v_mov_b32 v75, v23
    v_mov_b32 v76, v24
    v_mov_b32 v77, v22
    s_waitcnt lgkmcnt(0)
    global_load_dword v22, v3, s[18:19]
    global_load_ushort v26, v28, s[26:27]
    global_load_dword v23, v3, s[20:21]
    global_load_dword v24, v3, s[22:23]
    global_load_dword v25, v3, s[24:25]
    global_load_ushort v27, v28, s[28:29]
    s_mov_b32 s56, s38
    s_mov_b32 s57, s39
    s_mov_b32 s58, 4718592
    s_mov_b32 s59, 0x00020000

    s_mov_b32 s52, s42
    s_mov_b32 s53, s43
    s_mov_b32 s54, 0x1000000
    s_mov_b32 s55, 0x00020000
    s_branch A_entry
L_common:

    s_sub_u32 s14, s11, 8
    s_cmp_lt_u32 s11, 16
    s_cselect_b32 s14, s11, s14
    s_mul_i32 s15, s10, 23
    s_add_u32 s15, s14, s15
    s_cmp_lt_u32 s14, 23
    s_cselect_b32 s14, s15, 240
    s_mul_i32 s7, s14, 7282
    s_lshr_b32 s7, s7, 16
    s_mul_i32 s8, s7, 9
    s_sub_u32 s8, s14, s8
    s_mul_i32 s96, s8, 7
    s_mov_b32 s52, s42
    s_mov_b32 s53, s43
    s_mov_b32 s54, 0x1000000
    s_mov_b32 s55, 0x00020000
    s_mov_b32 s56, s38
    s_mov_b32 s57, s39
    s_mov_b32 s58, 4718592
    s_mov_b32 s59, 0x00020000
    s_or_b32 s90, s76, 1
    v_mov_b32 v30, 0
    v_mov_b32 v31, 0
    s_cmp_eq_u32 s95, 3
    s_cbranch_scc1 O_join
    s_cmp_eq_u32 s95, 0
    s_cbranch_scc0 L_qd
    s_cmp_eq_u32 s13, 0
    s_cbranch_scc1 B_entry
    s_branch V_path
L_qd:
    s_cmp_lt_u32 s6, 2
    s_cbranch_scc1 Q_v0
    s_cmp_lt_u32 s6, 4
    s_cbranch_scc1 Q_v1
    s_cmp_lt_u32 s6, 6
    s_cbranch_scc1 Q_v2
    s_branch Q_v3

L_exit:
    s_endpgm
B_entry:
    v_mov_b32 v30, 0
    v_lshrrev_b32 v21, 1, v22
    v_xor_b32 v21, v21, v19
    v_lshlrev_b32 v21, 4, v21
    v_lshl_add_u32 v8, v22, 7, v21
    s_lshl_b32 s14, s68, 11
    v_add_u32 v8, s14, v8
    v_xor_b32 v9, 64, v8
    v_lshlrev_b32 v21, 1, v23
    v_lshl_add_u32 v21, v19, 3, v21
    v_mul_u32_u24 v21, 144, v21
    v_add_u32 v21, 95232, v21
    v_lshl_add_u32 v10, v24, 3, v21
    v_and_b32 v20, 1, v24
    v_mul_u32_u24 v20, 9216, v20
    v_add3_u32 v11, v21, v20, 64

    s_mov_b32 s60, s34
    s_mov_b32 s61, s35
    s_mov_b32 s62, 20736
    s_mov_b32 s63, 0x00020000
    s_mul_i32 s14, s5, 2592
    v_lshl_add_u32 v25, v0, 2, s14
    buffer_load_dword v244, v25, s[60:63], 0 offen
    buffer_load_dword v245, v25, s[60:63], 0 offen offset:1024
    buffer_load_dword v246, v25, s[60:63], 0 offen offset:2048

    v_add_u32 v21, 0, v0
    v_mul_u32_u24 v20, 7282, v21
    v_lshrrev_b32 v20, 16, v20
    v_mul_u32_u24 v247, 44, v20
    v_lshl_add_u32 v247, v21, 2, v247
    v_add_u32 v247, 154624, v247

    v_add_u32 v21, 256, v0
    v_mul_u32_u24 v20, 7282, v21
    v_lshrrev_b32 v20, 16, v20
    v_mul_u32_u24 v248, 44, v20
    v_lshl_add_u32 v248, v21, 2, v248
    v_add_u32 v248, 154624, v248

    v_add_u32 v21, 512, v0
    v_mul_u32_u24 v20, 7282, v21
    v_lshrrev_b32 v20, 16, v20
    v_mul_u32_u24 v249, 44, v20
    v_lshl_add_u32 v249, v21, 2, v249
    v_add_u32 v249, 154624, v249

    v_cmp_gt_u32 vcc, 136, v0
    v_mov_b32 v20, 262144
    s_nop 0
    v_cndmask_b32 v249, v20, v249, vcc
    v_lshlrev_b32 v21, 2, v2
    v_min_u32 v21, 44, v21
    v_add_u32 v21, 160384, v21
    ds_write_b32 v21, v30

    s_mov_b32 s72, 0x3fb8aa3b
    s_mov_b32 s73, 0x3fb8aa3b
    s_mul_i32 s14, s13, 2880
    s_add_u32 s14, s14, 154624
    v_lshl_add_u32 v20, v19, 2, v23
    v_and_b32 v21, 1, v24
    v_mul_u32_u24 v21, 40, v21
    v_add_u32 v21, s14, v21
    v_mov_b32 v25, 160384
    v_mul_u32_u24 v12, 80, v20
    v_add_u32 v12, v12, v21
    v_add_u32 v13, 1280, v12
    v_mul_u32_u24 v14, 80, v23
    v_add_u32 v14, v14, v21
    v_add_u32 v14, 2560, v14
    s_and_b32 s91, s4, 1
    s_sub_i32 s15, s91, s13
    s_mul_i32 s15, s15, 2880
    v_add_u32 v234, s15, v12
    v_add_u32 v235, s15, v13
    v_add_u32 v15, s15, v14
    s_and_b32 s15, s5, 1
    s_lshl_b32 s74, s91, 1
    s_add_u32 s15, s15, s74
    v_cmp_gt_u32 vcc, 2, v24
    v_cmp_gt_u32 s[76:77], 2, v20
    v_cmp_eq_u32 s[78:79], 0, v19
    v_cmp_eq_u32 s[74:75], s15, v19
    v_cndmask_b32 v12, v25, v12, vcc
    v_cndmask_b32 v234, v25, v234, vcc
    s_xnor_b64 s[76:77], s[76:77], vcc
    s_andn2_b64 s[78:79], s[78:79], vcc
    s_andn2_b64 s[74:75], s[74:75], vcc
    v_cndmask_b32 v13, v25, v13, s[76:77]
    v_cndmask_b32 v235, v25, v235, s[76:77]
    v_cndmask_b32 v15, v25, v15, s[74:75]
    v_cndmask_b32 v14, v25, v14, s[78:79]
    s_mul_i32 s84, s13, 21504
    s_mul_i32 s85, s13, 11264
    s_add_u32 s85, s85, 132096
    s_lshl_b32 s14, s12, 5
    v_add_u32 v20, s14, v22
    v_mul_u32_u24 v200, 168, v20
    v_mul_u32_u24 v21, 40, v19
    v_add3_u32 v200, v200, v21, s84
    v_mul_u32_u24 v201, 88, v20
    v_add_u32 v201, s85, v201
    v_min_u32 v21, 48, v21
    v_add3_u32 v202, v201, v21, 32
    v_lshl_add_u32 v201, v19, 3, v201
    v_and_b32 v20, 1, v19
    v_lshlrev_b32 v20, 4, v20
    v_lshl_add_u32 v20, v23, 2, v20
    v_lshrrev_b32 v21, 1, v19
    v_lshl_add_u32 v20, v21, 1, v20
    v_mul_u32_u24 v203, 168, v20
    v_lshl_add_u32 v203, v24, 3, v203
    v_add_u32 v203, s84, v203
    s_lshr_b32 s10, s12, 1
    s_add_u32 s11, s12, s10
    s_lshl_b32 s14, s11, 5
    v_add_u32 v204, 64, v203
    v_add_u32 v203, s14, v203
    v_mul_u32_u24 v205, 88, v20
    v_add_u32 v205, s85, v205
    v_and_b32 v21, 1, v24
    v_lshl_add_u32 v206, v21, 3, v205
    v_add_u32 v206, 32, v206
    v_lshl_add_u32 v205, v24, 3, v205
    s_mul_i32 s14, s10, 48
    v_add_u32 v205, s14, v205
    s_lshl_b32 s3, s5, 1
    s_add_u32 s3, s3, s13
    s_lshl_b32 s15, s3, 4
    s_add_u32 s15, s15, s4
    s_mul_i32 s14, s15, 3200
    s_lshl_b32 s74, s12, 9
    s_add_u32 s74, s74, s14
    v_lshl_add_u32 v207, v2, 3, s74
    s_lshl_b32 s74, s11, 7
    s_add_u32 s74, s74, s14
    s_add_u32 s74, s74, 2560
    v_lshl_add_u32 v208, v22, 3, s74
    v_mov_b32 v25, 0x7f000000
    v_cmp_eq_u32 vcc, s10, v19
    v_lshrrev_b32 v20, 3, v22
    s_nop 0
    v_cndmask_b32 v208, v25, v208, vcc
    v_and_b32 v21, 7, v22
    v_lshlrev_b32 v21, 3, v21
    v_lshl_add_u32 v21, v19, 6, v21
    s_lshl_b32 s74, s10, 8
    s_add_u32 s74, s74, s14
    s_add_u32 s74, s74, 2048
    v_add_u32 v209, s74, v21
    v_cmp_eq_u32 vcc, s10, v20
    s_bitcmp0_b32 s12, 0
    s_cselect_b64 s[76:77], vcc, 0
    v_cndmask_b32 v209, v25, v209, s[76:77]
    s_add_u32 s74, s14, 2816
    v_lshl_add_u32 v210, v22, 3, s74
    v_cmp_eq_u32 vcc, v19, v20
    s_cmp_eq_u32 s12, 1
    s_cselect_b64 s[76:77], vcc, 0
    v_cndmask_b32 v210, v25, v210, s[76:77]
    s_lshl_b32 s74, s5, 4
    s_add_u32 s74, s74, s4
    s_lshl_b32 s74, s74, 7
    s_add_u32 s74, s74, 0xd0000
    v_mov_b32 v211, s74
    s_lshl_b32 s3, s5, 1
    s_add_u32 s3, s3, s91
    s_lshr_b32 s14, s4, 1
    s_lshl_b32 s14, s14, 4
    s_lshl_b32 s75, s6, 1
    s_add_u32 s14, s14, s75
    s_mul_i32 s74, s14, 18432
    s_add_u32 s74, s74, 0x100000
    s_lshl_b32 s75, s3, 10
    s_add_u32 s75, s75, s74
    v_lshl_add_u32 v228, v2, 4, s75
    s_lshl_b32 s75, s3, 7
    s_add_u32 s75, s75, s74
    s_add_u32 s75, s75, 16384
    v_lshl_add_u32 v229, v2, 3, s75
    v_cmp_gt_u32 vcc, 16, v2
    s_nop 1
    v_cndmask_b32 v229, v25, v229, vcc
    s_lshl_b32 s74, s4, 3
    s_add_u32 s74, s74, s5
    s_lshl_b32 s74, s74, 7
    s_add_u32 s74, s74, 0xd8000
    v_mov_b32 v230, s74
    s_mul_i32 s74, s14, 18432
    s_add_u32 s74, s74, 0x401000
    s_lshl_b32 s75, s3, 10
    s_add_u32 s75, s75, s74
    v_lshl_add_u32 v231, v2, 4, s75
    s_lshr_b32 s75, s5, 1
    s_lshl_b32 s76, s75, 9
    s_add_u32 s76, s76, s74
    s_add_u32 s76, s76, 16384
    v_lshl_add_u32 v232, v2, 3, s76
    v_mov_b32 v20, s14
    v_mul_u32_u24 v20, 6554, v20
    v_lshrrev_b32 v20, 16, v20
    v_lshl_add_u32 v20, v20, 2, s75
    v_lshlrev_b32 v20, 7, v20
    v_add_u32 v233, 0xdc000, v20

    v_mov_b32 v25, 0x7f000000
    s_lshl_b32 s74, s5, 11
    s_add_u32 s74, s74, 0xd0000
    v_lshl_add_u32 v212, v22, 7, s74
    s_mul_i32 s74, s3, 51200
    s_lshl_b32 s75, s6, 9
    s_add_u32 s74, s74, s75
    v_and_b32 v20, 31, v2
    v_lshl_add_u32 v213, v20, 4, s74
    v_lshrrev_b32 v21, 5, v2
    v_mul_u32_u24 v21, 3200, v21
    v_add_u32 v213, v213, v21
    v_lshl_add_u32 v21, v20, 4, s75
    v_cmp_gt_u32 vcc, 3200, v21
    s_nop 1
    v_cndmask_b32 v213, v25, v213, vcc
    v_lshrrev_b32 v20, 3, v22
    v_and_b32 v21, 1, v19
    v_cmp_eq_u32 vcc, v20, v21
    v_and_b32 v20, 1, v22
    v_lshlrev_b32 v20, 4, v20
    v_mov_b32 v21, 0x3f80
    v_lshlrev_b32 v21, v20, v21
    v_cndmask_b32 v21, 0, v21, vcc
    v_bfe_u32 v20, v22, 1, 2

    v_cmp_eq_u32 vcc, 0, v20
    s_nop 1
    v_cndmask_b32 v216, 0, v21, vcc
    v_cmp_eq_u32 vcc, 1, v20
    s_nop 1
    v_cndmask_b32 v217, 0, v21, vcc
    v_cmp_eq_u32 vcc, 2, v20
    s_nop 1
    v_cndmask_b32 v218, 0, v21, vcc
    v_cmp_eq_u32 vcc, 3, v20
    s_nop 1
    v_cndmask_b32 v219, 0, v21, vcc
    s_mov_b32 s94, 132096
    v_lshrrev_b32 v16, 1, v19
    v_lshlrev_b32 v16, 5, v16
    v_lshl_add_u32 v16, v22, 1, v16
    v_and_b32 v20, 1, v19
    v_add_u32 v16, v16, v20
    v_and_b32 v20, 15, v16
    s_lshl_b32 s74, s11, 4
    v_add_u32 v20, s74, v20
    v_mul_u32_u24 v220, 56, v20
    v_lshrrev_b32 v20, 4, v16
    v_lshl_add_u32 v220, v20, 3, v220
    v_add_u32 v220, s94, v220
    v_lshrrev_b32 v20, 5, v16
    v_and_b32 v21, 7, v16
    v_lshl_add_u32 v20, v20, 3, v21
    v_mul_u32_u24 v221, 56, v20
    v_bfe_u32 v20, v16, 3, 2
    v_lshl_add_u32 v221, v20, 3, v221
    s_add_u32 s74, s94, 1792
    v_add_u32 v221, s74, v221
    v_mov_b32 v18, 262144
    s_cmp_eq_u32 s6, 4
    s_cselect_b64 vcc, -1, 0
    v_cndmask_b32 v221, v18, v221, vcc
    s_cmp_lt_u32 s6, 4
    s_cselect_b64 vcc, -1, 0
    v_cndmask_b32 v220, v221, v220, vcc
    s_sub_u32 s74, s6, 5
    s_lshl_b32 s74, s74, 6
    v_add_u32 v16, s74, v16
    v_mul_u32_u24 v222, 56, v16
    v_add3_u32 v222, v222, s94, 32
    v_cmp_gt_u32 vcc, 80, v16
    v_cmp_gt_u32 s[86:87], 40, v16
    s_nop 0
    v_cndmask_b32 v222, v18, v222, vcc
    v_mul_u32_u24 v16, 20, v19
    v_add_u32 v16, v16, v23
    v_mul_u32_u24 v16, 56, v16
    v_add_u32 v16, s94, v16
    v_cmp_gt_u32 s[78:79], 2, v19

    v_lshl_add_u32 v21, v24, 1, 0
    v_cmp_lt_u32 vcc, 4, v21
    v_subrev_u32 v18, 5, v21
    s_nop 0
    v_cndmask_b32 v20, v21, 6, vcc
    v_cndmask_b32 v18, 6, v18, vcc
    v_cmp_eq_u32 vcc, 4, v21
    s_nop 1
    v_cndmask_b32 v18, v18, 4, vcc
    v_cndmask_b32 v20, v18, v20, s[78:79]
    v_lshl_add_u32 v224, v20, 3, v16

    v_lshl_add_u32 v21, v24, 1, 1
    v_cmp_lt_u32 vcc, 4, v21
    v_subrev_u32 v18, 5, v21
    s_nop 0
    v_cndmask_b32 v20, v21, 6, vcc
    v_cndmask_b32 v18, 6, v18, vcc
    v_cmp_eq_u32 vcc, 4, v21
    s_nop 1
    v_cndmask_b32 v18, v18, 4, vcc
    v_cndmask_b32 v20, v18, v20, s[78:79]
    v_lshl_add_u32 v225, v20, 3, v16

    v_mov_b32 v21, 8
    v_cmp_lt_u32 vcc, 4, v21
    v_subrev_u32 v18, 5, v21
    s_nop 0
    v_cndmask_b32 v20, v21, 6, vcc
    v_cndmask_b32 v18, 6, v18, vcc
    v_cmp_eq_u32 vcc, 4, v21
    s_nop 1
    v_cndmask_b32 v18, v18, 4, vcc
    v_cndmask_b32 v20, v18, v20, s[78:79]
    v_lshl_add_u32 v226, v20, 3, v16

    v_add_u32 v227, 40, v16
    v_cmp_gt_u32 s[84:85], 3, v19

    v_mov_b32 v18, 0
    s_add_u32 s66, s89, 1
    s_sub_u32 s15, s66, 3
    s_cmp_ge_u32 s66, 3
    s_cselect_b32 s66, s15, s66
    s_add_u32 s66, s66, 0
    s_mul_i32 s66, s66, 221184
    s_add_u32 s67, s66, s92
    s_add_u32 m0, s70, 36864
    s_mov_b32 exec_hi, 0x7fffffff
    buffer_load_dwordx4 v5, s[48:51], s67 offen lds
    s_mov_b64 exec, -1
    s_add_u32 m0, s70, 37872
    s_mov_b32 exec_hi, 0x7fffffff
    buffer_load_dwordx4 v6, s[48:51], s67 offen lds
    s_mov_b64 exec, -1
    s_add_u32 m0, s70, 38880
    s_mov_b64 exec, 0x3ffff
    buffer_load_dwordx4 v7, s[48:51], s67 offen lds
    s_mov_b64 exec, -1
    s_add_u32 s67, s66, s93
    s_add_u32 m0, s70, 46080
    s_mov_b32 exec_hi, 0x7fffffff
    buffer_load_dwordx4 v5, s[48:51], s67 offen lds
    s_mov_b64 exec, -1
    s_add_u32 m0, s70, 47088
    s_mov_b32 exec_hi, 0x7fffffff
    buffer_load_dwordx4 v6, s[48:51], s67 offen lds
    s_mov_b64 exec, -1
    s_add_u32 m0, s70, 48096
    s_mov_b64 exec, 0x3ffff
    buffer_load_dwordx4 v7, s[48:51], s67 offen lds
    s_mov_b64 exec, -1
    s_waitcnt vmcnt(9) lgkmcnt(0)
    s_barrier
    ds_read_b128 v[112:115], v8 offset:0
    ds_read_b128 v[116:119], v8 offset:2048
    ds_read_b64_tr_b16 v[32:33], v10 offset:18432
    ds_read_b64_tr_b16 v[34:35], v10 offset:18576
    ds_read_b64_tr_b16 v[36:37], v10 offset:18464
    ds_read_b64_tr_b16 v[38:39], v10 offset:18608
    ds_read_b64_tr_b16 v[40:41], v10 offset:27648
    ds_read_b64_tr_b16 v[42:43], v10 offset:27792
    ds_read_b64_tr_b16 v[44:45], v10 offset:27680
    ds_read_b64_tr_b16 v[46:47], v10 offset:27824
    ds_read_b64_tr_b16 v[48:49], v11 offset:18432
    ds_read_b64_tr_b16 v[50:51], v11 offset:18576
    s_waitcnt lgkmcnt(8)
    v_mfma_f32_16x16x32_bf16 v[72:75], v[32:35], v[112:115], 0
    ds_read_b128 v[120:123], v9 offset:0
    ds_read_b128 v[124:127], v9 offset:2048
    v_mfma_f32_16x16x32_bf16 v[76:79], v[32:35], v[116:119], 0
    ds_read_b64_tr_b16 v[52:53], v10 offset:23040
    ds_read_b64_tr_b16 v[54:55], v10 offset:23184
    s_waitcnt lgkmcnt(10)
    v_mfma_f32_16x16x32_bf16 v[80:83], v[36:39], v[112:115], 0
    ds_read_b64_tr_b16 v[56:57], v10 offset:23072
    ds_read_b64_tr_b16 v[58:59], v10 offset:23216
    v_mfma_f32_16x16x32_bf16 v[84:87], v[36:39], v[116:119], 0
    ds_read_b64_tr_b16 v[60:61], v10 offset:32256
    s_waitcnt lgkmcnt(11)
    v_mfma_f32_16x16x32_bf16 v[88:91], v[40:43], v[112:115], 0
    ds_read_b64_tr_b16 v[62:63], v10 offset:32400
    v_mfma_f32_16x16x32_bf16 v[92:95], v[40:43], v[116:119], 0
    ds_read_b64_tr_b16 v[64:65], v10 offset:32288
    s_waitcnt lgkmcnt(11)
    v_mfma_f32_16x16x32_bf16 v[96:99], v[44:47], v[112:115], 0
    ds_read_b64_tr_b16 v[66:67], v10 offset:32432
    v_mfma_f32_16x16x32_bf16 v[100:103], v[44:47], v[116:119], 0
    ds_read_b64_tr_b16 v[68:69], v11 offset:23040
    s_waitcnt lgkmcnt(11)
    v_mfma_f32_16x16x32_bf16 v[104:107], v[48:51], v[112:115], 0
    ds_read_b64_tr_b16 v[70:71], v11 offset:23184
    v_mfma_f32_16x16x32_bf16 v[108:111], v[48:51], v[116:119], 0
    s_add_u32 s66, s89, 2
    s_sub_u32 s15, s66, 3
    s_cmp_ge_u32 s66, 3
    s_cselect_b32 s66, s15, s66
    s_add_u32 s66, s66, 0
    s_mul_i32 s66, s66, 221184
    s_add_u32 s67, s66, s92
    s_add_u32 m0, s70, 0
    s_mov_b32 exec_hi, 0x7fffffff
    buffer_load_dwordx4 v5, s[48:51], s67 offen lds
    s_mov_b64 exec, -1
    s_add_u32 m0, s70, 1008
    s_mov_b32 exec_hi, 0x7fffffff
    buffer_load_dwordx4 v6, s[48:51], s67 offen lds
    s_mov_b64 exec, -1
    s_add_u32 m0, s70, 2016
    s_mov_b64 exec, 0x3ffff
    buffer_load_dwordx4 v7, s[48:51], s67 offen lds
    s_mov_b64 exec, -1
    s_add_u32 s67, s66, s93
    s_add_u32 m0, s70, 9216
    s_mov_b32 exec_hi, 0x7fffffff
    buffer_load_dwordx4 v5, s[48:51], s67 offen lds
    s_mov_b64 exec, -1
    s_add_u32 m0, s70, 10224
    s_mov_b32 exec_hi, 0x7fffffff
    buffer_load_dwordx4 v6, s[48:51], s67 offen lds
    s_mov_b64 exec, -1
    s_add_u32 m0, s70, 11232
    s_mov_b64 exec, 0x3ffff
    buffer_load_dwordx4 v7, s[48:51], s67 offen lds
    s_mov_b64 exec, -1
    s_waitcnt vmcnt(6) lgkmcnt(0)
    s_barrier
    v_mfma_f32_16x16x32_bf16 v[72:75], v[52:55], v[120:123], v[72:75]
    ds_read_b128 v[112:115], v8 offset:16384
    ds_read_b128 v[116:119], v8 offset:18432
    v_mfma_f32_16x16x32_bf16 v[76:79], v[52:55], v[124:127], v[76:79]
    ds_read_b64_tr_b16 v[32:33], v10 offset:36864
    ds_read_b64_tr_b16 v[34:35], v10 offset:37008
    v_mfma_f32_16x16x32_bf16 v[80:83], v[56:59], v[120:123], v[80:83]
    ds_read_b64_tr_b16 v[36:37], v10 offset:36896
    ds_read_b64_tr_b16 v[38:39], v10 offset:37040
    v_mfma_f32_16x16x32_bf16 v[84:87], v[56:59], v[124:127], v[84:87]
    ds_read_b64_tr_b16 v[40:41], v10 offset:46080
    v_mfma_f32_16x16x32_bf16 v[88:91], v[60:63], v[120:123], v[88:91]
    ds_read_b64_tr_b16 v[42:43], v10 offset:46224
    v_mfma_f32_16x16x32_bf16 v[92:95], v[60:63], v[124:127], v[92:95]
    ds_read_b64_tr_b16 v[44:45], v10 offset:46112
    v_mfma_f32_16x16x32_bf16 v[96:99], v[64:67], v[120:123], v[96:99]
    ds_read_b64_tr_b16 v[46:47], v10 offset:46256
    v_mfma_f32_16x16x32_bf16 v[100:103], v[64:67], v[124:127], v[100:103]
    ds_read_b64_tr_b16 v[48:49], v11 offset:36864
    v_mfma_f32_16x16x32_bf16 v[104:107], v[68:71], v[120:123], v[104:107]
    ds_read_b64_tr_b16 v[50:51], v11 offset:37008
    v_mfma_f32_16x16x32_bf16 v[108:111], v[68:71], v[124:127], v[108:111]
    s_waitcnt lgkmcnt(8)
    v_mfma_f32_16x16x32_bf16 v[72:75], v[32:35], v[112:115], v[72:75]
    ds_read_b128 v[120:123], v9 offset:16384
    ds_read_b128 v[124:127], v9 offset:18432
    v_mfma_f32_16x16x32_bf16 v[76:79], v[32:35], v[116:119], v[76:79]
    ds_read_b64_tr_b16 v[52:53], v10 offset:41472
    ds_read_b64_tr_b16 v[54:55], v10 offset:41616
    s_waitcnt lgkmcnt(10)
    v_mfma_f32_16x16x32_bf16 v[80:83], v[36:39], v[112:115], v[80:83]
    ds_read_b64_tr_b16 v[56:57], v10 offset:41504
    ds_read_b64_tr_b16 v[58:59], v10 offset:41648
    v_mfma_f32_16x16x32_bf16 v[84:87], v[36:39], v[116:119], v[84:87]
    ds_read_b64_tr_b16 v[60:61], v10 offset:50688
    s_waitcnt lgkmcnt(11)
    v_mfma_f32_16x16x32_bf16 v[88:91], v[40:43], v[112:115], v[88:91]
    ds_read_b64_tr_b16 v[62:63], v10 offset:50832
    v_mfma_f32_16x16x32_bf16 v[92:95], v[40:43], v[116:119], v[92:95]
    ds_read_b64_tr_b16 v[64:65], v10 offset:50720
    s_waitcnt lgkmcnt(11)
    v_mfma_f32_16x16x32_bf16 v[96:99], v[44:47], v[112:115], v[96:99]
    ds_read_b64_tr_b16 v[66:67], v10 offset:50864
    v_mfma_f32_16x16x32_bf16 v[100:103], v[44:47], v[116:119], v[100:103]
    ds_read_b64_tr_b16 v[68:69], v11 offset:41472
    s_waitcnt lgkmcnt(11)
    v_mfma_f32_16x16x32_bf16 v[104:107], v[48:51], v[112:115], v[104:107]
    ds_read_b64_tr_b16 v[70:71], v11 offset:41616
    v_mfma_f32_16x16x32_bf16 v[108:111], v[48:51], v[116:119], v[108:111]
    s_add_u32 s66, s89, 0
    s_sub_u32 s15, s66, 3
    s_cmp_ge_u32 s66, 3
    s_cselect_b32 s66, s15, s66
    s_add_u32 s66, s66, 3
    s_mul_i32 s66, s66, 221184
    s_add_u32 s67, s66, s92
    s_add_u32 m0, s70, 18432
    s_mov_b32 exec_hi, 0x7fffffff
    buffer_load_dwordx4 v5, s[48:51], s67 offen lds
    s_mov_b64 exec, -1
    s_add_u32 m0, s70, 19440
    s_mov_b32 exec_hi, 0x7fffffff
    buffer_load_dwordx4 v6, s[48:51], s67 offen lds
    s_mov_b64 exec, -1
    s_add_u32 m0, s70, 20448
    s_mov_b64 exec, 0x3ffff
    buffer_load_dwordx4 v7, s[48:51], s67 offen lds
    s_mov_b64 exec, -1
    s_add_u32 s67, s66, s93
    s_add_u32 m0, s70, 27648
    s_mov_b32 exec_hi, 0x7fffffff
    buffer_load_dwordx4 v5, s[48:51], s67 offen lds
    s_mov_b64 exec, -1
    s_add_u32 m0, s70, 28656
    s_mov_b32 exec_hi, 0x7fffffff
    buffer_load_dwordx4 v6, s[48:51], s67 offen lds
    s_mov_b64 exec, -1
    s_add_u32 m0, s70, 29664
    s_mov_b64 exec, 0x3ffff
    buffer_load_dwordx4 v7, s[48:51], s67 offen lds
    s_mov_b64 exec, -1
    v_xor_b32 v20, 0x80008000, v244
    ds_write2_b32 v247, v244, v20 offset0:0 offset1:10
    v_xor_b32 v20, 0x80008000, v245
    ds_write2_b32 v248, v245, v20 offset0:0 offset1:10
    v_xor_b32 v20, 0x80008000, v246
    ds_write2_b32 v249, v246, v20 offset0:0 offset1:10
    s_mov_b32 s60, s36
    s_mov_b32 s61, s37
    s_mov_b32 s62, 663552
    s_mov_b32 s63, 0x00020000
    s_lshl_b32 s71, s12, 10
    s_add_u32 s71, s71, 49152
    v_lshrrev_b32 v25, 3, v2
    v_and_b32 v26, 1, v19
    v_lshlrev_b32 v26, 1, v26
    s_and_b32 s74, s12, 1
    s_lshl_b32 s74, s74, 2
    v_or_b32 v26, s74, v26
    v_and_b32 v27, 7, v2
    v_xor_b32 v26, v26, v27
    s_lshl_b32 s75, s8, 7
    v_lshl_add_u32 v26, v26, 4, s75
    s_lshl_b32 s74, s12, 3
    v_add_u32 v240, s74, v25
    v_mul_u32_u24 v240, 1152, v240
    v_add_u32 v240, v240, v26
    v_lshrrev_b32 v27, 2, v25
    s_lshl_b32 s74, s12, 1
    v_add_u32 v27, s74, v27
    v_mul_u32_u24 v27, 36, v27
    v_and_b32 v28, 3, v25
    v_add3_u32 v27, v27, v28, 32
    v_mul_u32_u24 v241, 1152, v27
    v_add_u32 v241, v241, v26

    s_waitcnt vmcnt(6) lgkmcnt(0)
    s_barrier
    s_lshl_b32 s14, s2, 3
    s_add_u32 s14, s14, s6
    s_cmp_lg_u32 s14, 3
    s_cbranch_scc1 B_nonn
    v_mov_b32 v20, s90
    s_mov_b64 exec, 1
    global_store_dword v30, v20, s[40:41] sc1
    s_mov_b64 exec, -1

B_nonn:
    v_mfma_f32_16x16x32_bf16 v[72:75], v[52:55], v[120:123], v[72:75]
    ds_read_b128 v[112:115], v8 offset:32768
    ds_read_b128 v[116:119], v8 offset:34816
    v_mfma_f32_16x16x32_bf16 v[76:79], v[52:55], v[124:127], v[76:79]
    ds_read_b64_tr_b16 v[32:33], v10 offset:0
    ds_read_b64_tr_b16 v[34:35], v10 offset:144
    v_mfma_f32_16x16x32_bf16 v[80:83], v[56:59], v[120:123], v[80:83]
    ds_read_b64_tr_b16 v[36:37], v10 offset:32
    ds_read_b64_tr_b16 v[38:39], v10 offset:176
    v_mfma_f32_16x16x32_bf16 v[84:87], v[56:59], v[124:127], v[84:87]
    ds_read_b64_tr_b16 v[40:41], v10 offset:9216
    v_mfma_f32_16x16x32_bf16 v[88:91], v[60:63], v[120:123], v[88:91]
    ds_read_b64_tr_b16 v[42:43], v10 offset:9360
    v_mfma_f32_16x16x32_bf16 v[92:95], v[60:63], v[124:127], v[92:95]
    ds_read_b64_tr_b16 v[44:45], v10 offset:9248
    v_mfma_f32_16x16x32_bf16 v[96:99], v[64:67], v[120:123], v[96:99]
    ds_read_b64_tr_b16 v[46:47], v10 offset:9392
    v_mfma_f32_16x16x32_bf16 v[100:103], v[64:67], v[124:127], v[100:103]
    ds_read_b64_tr_b16 v[48:49], v11 offset:0
    v_mfma_f32_16x16x32_bf16 v[104:107], v[68:71], v[120:123], v[104:107]
    ds_read_b64_tr_b16 v[50:51], v11 offset:144
    v_mfma_f32_16x16x32_bf16 v[108:111], v[68:71], v[124:127], v[108:111]
    s_waitcnt lgkmcnt(8)
    v_mfma_f32_16x16x32_bf16 v[72:75], v[32:35], v[112:115], v[72:75]
    ds_read_b128 v[120:123], v9 offset:32768
    ds_read_b128 v[124:127], v9 offset:34816
    v_mfma_f32_16x16x32_bf16 v[76:79], v[32:35], v[116:119], v[76:79]
    ds_read_b64_tr_b16 v[52:53], v10 offset:4608
    ds_read_b64_tr_b16 v[54:55], v10 offset:4752
    s_waitcnt lgkmcnt(10)
    v_mfma_f32_16x16x32_bf16 v[80:83], v[36:39], v[112:115], v[80:83]
    ds_read_b64_tr_b16 v[56:57], v10 offset:4640
    ds_read_b64_tr_b16 v[58:59], v10 offset:4784
    v_mfma_f32_16x16x32_bf16 v[84:87], v[36:39], v[116:119], v[84:87]
    ds_read_b64_tr_b16 v[60:61], v10 offset:13824
    s_waitcnt lgkmcnt(11)
    v_mfma_f32_16x16x32_bf16 v[88:91], v[40:43], v[112:115], v[88:91]
    ds_read_b64_tr_b16 v[62:63], v10 offset:13968
    v_mfma_f32_16x16x32_bf16 v[92:95], v[40:43], v[116:119], v[92:95]
    ds_read_b64_tr_b16 v[64:65], v10 offset:13856
    s_waitcnt lgkmcnt(11)
    v_mfma_f32_16x16x32_bf16 v[96:99], v[44:47], v[112:115], v[96:99]
    ds_read_b64_tr_b16 v[66:67], v10 offset:14000
    v_mfma_f32_16x16x32_bf16 v[100:103], v[44:47], v[116:119], v[100:103]
    ds_read_b64_tr_b16 v[68:69], v11 offset:4608
    s_waitcnt lgkmcnt(11)
    v_mfma_f32_16x16x32_bf16 v[104:107], v[48:51], v[112:115], v[104:107]
    ds_read_b64_tr_b16 v[70:71], v11 offset:4752
    v_mfma_f32_16x16x32_bf16 v[108:111], v[48:51], v[116:119], v[108:111]
    s_add_u32 s66, s89, 1
    s_sub_u32 s15, s66, 3
    s_cmp_ge_u32 s66, 3
    s_cselect_b32 s66, s15, s66
    s_add_u32 s66, s66, 3
    s_mul_i32 s66, s66, 221184
    s_add_u32 s67, s66, s92
    s_add_u32 m0, s70, 36864
    s_mov_b32 exec_hi, 0x7fffffff
    buffer_load_dwordx4 v5, s[48:51], s67 offen lds
    s_mov_b64 exec, -1
    s_add_u32 m0, s70, 37872
    s_mov_b32 exec_hi, 0x7fffffff
    buffer_load_dwordx4 v6, s[48:51], s67 offen lds
    s_mov_b64 exec, -1
    s_add_u32 m0, s70, 38880
    s_mov_b64 exec, 0x3ffff
    buffer_load_dwordx4 v7, s[48:51], s67 offen lds
    s_mov_b64 exec, -1
    s_add_u32 s67, s66, s93
    s_add_u32 m0, s70, 46080
    s_mov_b32 exec_hi, 0x7fffffff
    buffer_load_dwordx4 v5, s[48:51], s67 offen lds
    s_mov_b64 exec, -1
    s_add_u32 m0, s70, 47088
    s_mov_b32 exec_hi, 0x7fffffff
    buffer_load_dwordx4 v6, s[48:51], s67 offen lds
    s_mov_b64 exec, -1
    s_add_u32 m0, s70, 48096
    s_mov_b64 exec, 0x3ffff
    buffer_load_dwordx4 v7, s[48:51], s67 offen lds
    s_mov_b64 exec, -1
    s_waitcnt vmcnt(6) lgkmcnt(0)
    s_barrier
    v_mfma_f32_16x16x32_bf16 v[72:75], v[52:55], v[120:123], v[72:75]
    ds_read_b128 v[112:115], v8 offset:0
    ds_read_b128 v[116:119], v8 offset:2048
    v_mfma_f32_16x16x32_bf16 v[76:79], v[52:55], v[124:127], v[76:79]
    ds_read_b64_tr_b16 v[32:33], v10 offset:18432
    ds_read_b64_tr_b16 v[34:35], v10 offset:18576
    v_mfma_f32_16x16x32_bf16 v[80:83], v[56:59], v[120:123], v[80:83]
    ds_read_b64_tr_b16 v[36:37], v10 offset:18464
    ds_read_b64_tr_b16 v[38:39], v10 offset:18608
    v_mfma_f32_16x16x32_bf16 v[84:87], v[56:59], v[124:127], v[84:87]
    ds_read_b64_tr_b16 v[40:41], v10 offset:27648
    v_mfma_f32_16x16x32_bf16 v[88:91], v[60:63], v[120:123], v[88:91]
    ds_read_b64_tr_b16 v[42:43], v10 offset:27792
    v_mfma_f32_16x16x32_bf16 v[92:95], v[60:63], v[124:127], v[92:95]
    ds_read_b64_tr_b16 v[44:45], v10 offset:27680
    v_mfma_f32_16x16x32_bf16 v[96:99], v[64:67], v[120:123], v[96:99]
    ds_read_b64_tr_b16 v[46:47], v10 offset:27824
    v_mfma_f32_16x16x32_bf16 v[100:103], v[64:67], v[124:127], v[100:103]
    ds_read_b64_tr_b16 v[48:49], v11 offset:18432
    v_mfma_f32_16x16x32_bf16 v[104:107], v[68:71], v[120:123], v[104:107]
    ds_read_b64_tr_b16 v[50:51], v11 offset:18576
    v_mfma_f32_16x16x32_bf16 v[108:111], v[68:71], v[124:127], v[108:111]
    s_waitcnt lgkmcnt(8)
    v_mfma_f32_16x16x32_bf16 v[72:75], v[32:35], v[112:115], v[72:75]
    ds_read_b128 v[120:123], v9 offset:0
    ds_read_b128 v[124:127], v9 offset:2048
    v_mfma_f32_16x16x32_bf16 v[76:79], v[32:35], v[116:119], v[76:79]
    ds_read_b64_tr_b16 v[52:53], v10 offset:23040
    ds_read_b64_tr_b16 v[54:55], v10 offset:23184
    s_waitcnt lgkmcnt(10)
    v_mfma_f32_16x16x32_bf16 v[80:83], v[36:39], v[112:115], v[80:83]
    ds_read_b64_tr_b16 v[56:57], v10 offset:23072
    ds_read_b64_tr_b16 v[58:59], v10 offset:23216
    v_mfma_f32_16x16x32_bf16 v[84:87], v[36:39], v[116:119], v[84:87]
    ds_read_b64_tr_b16 v[60:61], v10 offset:32256
    s_waitcnt lgkmcnt(11)
    v_mfma_f32_16x16x32_bf16 v[88:91], v[40:43], v[112:115], v[88:91]
    ds_read_b64_tr_b16 v[62:63], v10 offset:32400
    v_mfma_f32_16x16x32_bf16 v[92:95], v[40:43], v[116:119], v[92:95]
    ds_read_b64_tr_b16 v[64:65], v10 offset:32288
    s_waitcnt lgkmcnt(11)
    v_mfma_f32_16x16x32_bf16 v[96:99], v[44:47], v[112:115], v[96:99]
    ds_read_b64_tr_b16 v[66:67], v10 offset:32432
    v_mfma_f32_16x16x32_bf16 v[100:103], v[44:47], v[116:119], v[100:103]
    ds_read_b64_tr_b16 v[68:69], v11 offset:23040
    s_waitcnt lgkmcnt(11)
    v_mfma_f32_16x16x32_bf16 v[104:107], v[48:51], v[112:115], v[104:107]
    ds_read_b64_tr_b16 v[70:71], v11 offset:23184
    v_mfma_f32_16x16x32_bf16 v[108:111], v[48:51], v[116:119], v[108:111]
    s_add_u32 s66, s89, 2
    s_sub_u32 s15, s66, 3
    s_cmp_ge_u32 s66, 3
    s_cselect_b32 s66, s15, s66
    s_add_u32 s66, s66, 3
    s_mul_i32 s66, s66, 221184
    s_add_u32 s67, s66, s92
    s_add_u32 m0, s70, 0
    s_mov_b32 exec_hi, 0x7fffffff
    buffer_load_dwordx4 v5, s[48:51], s67 offen lds
    s_mov_b64 exec, -1
    s_add_u32 m0, s70, 1008
    s_mov_b32 exec_hi, 0x7fffffff
    buffer_load_dwordx4 v6, s[48:51], s67 offen lds
    s_mov_b64 exec, -1
    s_add_u32 m0, s70, 2016
    s_mov_b64 exec, 0x3ffff
    buffer_load_dwordx4 v7, s[48:51], s67 offen lds
    s_mov_b64 exec, -1
    s_add_u32 s67, s66, s93
    s_add_u32 m0, s70, 9216
    s_mov_b32 exec_hi, 0x7fffffff
    buffer_load_dwordx4 v5, s[48:51], s67 offen lds
    s_mov_b64 exec, -1
    s_add_u32 m0, s70, 10224
    s_mov_b32 exec_hi, 0x7fffffff
    buffer_load_dwordx4 v6, s[48:51], s67 offen lds
    s_mov_b64 exec, -1
    s_add_u32 m0, s70, 11232
    s_mov_b64 exec, 0x3ffff
    buffer_load_dwordx4 v7, s[48:51], s67 offen lds
    s_mov_b64 exec, -1
    s_waitcnt vmcnt(6) lgkmcnt(0)
    s_barrier
    v_mfma_f32_16x16x32_bf16 v[72:75], v[52:55], v[120:123], v[72:75]
    ds_read_b128 v[112:115], v8 offset:16384
    ds_read_b128 v[116:119], v8 offset:18432
    v_mfma_f32_16x16x32_bf16 v[76:79], v[52:55], v[124:127], v[76:79]
    ds_read_b64_tr_b16 v[32:33], v10 offset:36864
    ds_read_b64_tr_b16 v[34:35], v10 offset:37008
    v_mfma_f32_16x16x32_bf16 v[80:83], v[56:59], v[120:123], v[80:83]
    ds_read_b64_tr_b16 v[36:37], v10 offset:36896
    ds_read_b64_tr_b16 v[38:39], v10 offset:37040
    v_mfma_f32_16x16x32_bf16 v[84:87], v[56:59], v[124:127], v[84:87]
    ds_read_b64_tr_b16 v[40:41], v10 offset:46080
    v_mfma_f32_16x16x32_bf16 v[88:91], v[60:63], v[120:123], v[88:91]
    ds_read_b64_tr_b16 v[42:43], v10 offset:46224
    v_mfma_f32_16x16x32_bf16 v[92:95], v[60:63], v[124:127], v[92:95]
    ds_read_b64_tr_b16 v[44:45], v10 offset:46112
    v_mfma_f32_16x16x32_bf16 v[96:99], v[64:67], v[120:123], v[96:99]
    ds_read_b64_tr_b16 v[46:47], v10 offset:46256
    v_mfma_f32_16x16x32_bf16 v[100:103], v[64:67], v[124:127], v[100:103]
    ds_read_b64_tr_b16 v[48:49], v11 offset:36864
    v_mfma_f32_16x16x32_bf16 v[104:107], v[68:71], v[120:123], v[104:107]
    ds_read_b64_tr_b16 v[50:51], v11 offset:37008
    v_mfma_f32_16x16x32_bf16 v[108:111], v[68:71], v[124:127], v[108:111]
    s_waitcnt lgkmcnt(8)
    v_mfma_f32_16x16x32_bf16 v[72:75], v[32:35], v[112:115], v[72:75]
    ds_read_b128 v[120:123], v9 offset:16384
    ds_read_b128 v[124:127], v9 offset:18432
    v_mfma_f32_16x16x32_bf16 v[76:79], v[32:35], v[116:119], v[76:79]
    ds_read_b64_tr_b16 v[52:53], v10 offset:41472
    ds_read_b64_tr_b16 v[54:55], v10 offset:41616
    s_waitcnt lgkmcnt(10)
    v_mfma_f32_16x16x32_bf16 v[80:83], v[36:39], v[112:115], v[80:83]
    ds_read_b64_tr_b16 v[56:57], v10 offset:41504
    ds_read_b64_tr_b16 v[58:59], v10 offset:41648
    v_mfma_f32_16x16x32_bf16 v[84:87], v[36:39], v[116:119], v[84:87]
    ds_read_b64_tr_b16 v[60:61], v10 offset:50688
    s_waitcnt lgkmcnt(11)
    v_mfma_f32_16x16x32_bf16 v[88:91], v[40:43], v[112:115], v[88:91]
    ds_read_b64_tr_b16 v[62:63], v10 offset:50832
    v_mfma_f32_16x16x32_bf16 v[92:95], v[40:43], v[116:119], v[92:95]
    ds_read_b64_tr_b16 v[64:65], v10 offset:50720
    s_waitcnt lgkmcnt(11)
    v_mfma_f32_16x16x32_bf16 v[96:99], v[44:47], v[112:115], v[96:99]
    ds_read_b64_tr_b16 v[66:67], v10 offset:50864
    v_mfma_f32_16x16x32_bf16 v[100:103], v[44:47], v[116:119], v[100:103]
    ds_read_b64_tr_b16 v[68:69], v11 offset:41472
    s_waitcnt lgkmcnt(11)
    v_mfma_f32_16x16x32_bf16 v[104:107], v[48:51], v[112:115], v[104:107]
    ds_read_b64_tr_b16 v[70:71], v11 offset:41616
    v_mfma_f32_16x16x32_bf16 v[108:111], v[48:51], v[116:119], v[108:111]
    s_add_u32 s66, s89, 0
    s_sub_u32 s15, s66, 3
    s_cmp_ge_u32 s66, 3
    s_cselect_b32 s66, s15, s66
    s_add_u32 s66, s66, 6
    s_mul_i32 s66, s66, 221184
    s_add_u32 s67, s66, s92
    s_add_u32 m0, s70, 18432
    s_mov_b32 exec_hi, 0x7fffffff
    buffer_load_dwordx4 v5, s[48:51], s67 offen lds
    s_mov_b64 exec, -1
    s_add_u32 m0, s70, 19440
    s_mov_b32 exec_hi, 0x7fffffff
    buffer_load_dwordx4 v6, s[48:51], s67 offen lds
    s_mov_b64 exec, -1
    s_add_u32 m0, s70, 20448
    s_mov_b64 exec, 0x3ffff
    buffer_load_dwordx4 v7, s[48:51], s67 offen lds
    s_mov_b64 exec, -1
    s_add_u32 s67, s66, s93
    s_add_u32 m0, s70, 27648
    s_mov_b32 exec_hi, 0x7fffffff
    buffer_load_dwordx4 v5, s[48:51], s67 offen lds
    s_mov_b64 exec, -1
    s_add_u32 m0, s70, 28656
    s_mov_b32 exec_hi, 0x7fffffff
    buffer_load_dwordx4 v6, s[48:51], s67 offen lds
    s_mov_b64 exec, -1
    s_add_u32 m0, s70, 29664
    s_mov_b64 exec, 0x3ffff
    buffer_load_dwordx4 v7, s[48:51], s67 offen lds
    s_mov_b64 exec, -1
    s_waitcnt vmcnt(6) lgkmcnt(0)
    s_barrier
    v_mfma_f32_16x16x32_bf16 v[72:75], v[52:55], v[120:123], v[72:75]
    ds_read_b128 v[112:115], v8 offset:32768
    ds_read_b128 v[116:119], v8 offset:34816
    v_mfma_f32_16x16x32_bf16 v[76:79], v[52:55], v[124:127], v[76:79]
    ds_read_b64_tr_b16 v[32:33], v10 offset:0
    ds_read_b64_tr_b16 v[34:35], v10 offset:144
    v_mfma_f32_16x16x32_bf16 v[80:83], v[56:59], v[120:123], v[80:83]
    ds_read_b64_tr_b16 v[36:37], v10 offset:32
    ds_read_b64_tr_b16 v[38:39], v10 offset:176
    v_mfma_f32_16x16x32_bf16 v[84:87], v[56:59], v[124:127], v[84:87]
    ds_read_b64_tr_b16 v[40:41], v10 offset:9216
    v_mfma_f32_16x16x32_bf16 v[88:91], v[60:63], v[120:123], v[88:91]
    ds_read_b64_tr_b16 v[42:43], v10 offset:9360
    v_mfma_f32_16x16x32_bf16 v[92:95], v[60:63], v[124:127], v[92:95]
    ds_read_b64_tr_b16 v[44:45], v10 offset:9248
    v_mfma_f32_16x16x32_bf16 v[96:99], v[64:67], v[120:123], v[96:99]
    ds_read_b64_tr_b16 v[46:47], v10 offset:9392
    v_mfma_f32_16x16x32_bf16 v[100:103], v[64:67], v[124:127], v[100:103]
    ds_read_b64_tr_b16 v[48:49], v11 offset:0
    v_mfma_f32_16x16x32_bf16 v[104:107], v[68:71], v[120:123], v[104:107]
    ds_read_b64_tr_b16 v[50:51], v11 offset:144
    v_mfma_f32_16x16x32_bf16 v[108:111], v[68:71], v[124:127], v[108:111]
    s_waitcnt lgkmcnt(8)
    v_mfma_f32_16x16x32_bf16 v[72:75], v[32:35], v[112:115], v[72:75]
    ds_read_b128 v[120:123], v9 offset:32768
    ds_read_b128 v[124:127], v9 offset:34816
    v_mfma_f32_16x16x32_bf16 v[76:79], v[32:35], v[116:119], v[76:79]
    ds_read_b64_tr_b16 v[52:53], v10 offset:4608
    ds_read_b64_tr_b16 v[54:55], v10 offset:4752
    s_waitcnt lgkmcnt(10)
    v_mfma_f32_16x16x32_bf16 v[80:83], v[36:39], v[112:115], v[80:83]
    ds_read_b64_tr_b16 v[56:57], v10 offset:4640
    ds_read_b64_tr_b16 v[58:59], v10 offset:4784
    v_mfma_f32_16x16x32_bf16 v[84:87], v[36:39], v[116:119], v[84:87]
    ds_read_b64_tr_b16 v[60:61], v10 offset:13824
    s_waitcnt lgkmcnt(11)
    v_mfma_f32_16x16x32_bf16 v[88:91], v[40:43], v[112:115], v[88:91]
    ds_read_b64_tr_b16 v[62:63], v10 offset:13968
    v_mfma_f32_16x16x32_bf16 v[92:95], v[40:43], v[116:119], v[92:95]
    ds_read_b64_tr_b16 v[64:65], v10 offset:13856
    s_waitcnt lgkmcnt(11)
    v_mfma_f32_16x16x32_bf16 v[96:99], v[44:47], v[112:115], v[96:99]
    ds_read_b64_tr_b16 v[66:67], v10 offset:14000
    v_mfma_f32_16x16x32_bf16 v[100:103], v[44:47], v[116:119], v[100:103]
    ds_read_b64_tr_b16 v[68:69], v11 offset:4608
    s_waitcnt lgkmcnt(11)
    v_mfma_f32_16x16x32_bf16 v[104:107], v[48:51], v[112:115], v[104:107]
    ds_read_b64_tr_b16 v[70:71], v11 offset:4752
    v_mfma_f32_16x16x32_bf16 v[108:111], v[48:51], v[116:119], v[108:111]
    s_add_u32 s66, s89, 1
    s_sub_u32 s15, s66, 3
    s_cmp_ge_u32 s66, 3
    s_cselect_b32 s66, s15, s66
    s_add_u32 s66, s66, 6
    s_mul_i32 s66, s66, 221184
    s_add_u32 s67, s66, s92
    s_add_u32 m0, s70, 36864
    s_mov_b32 exec_hi, 0x7fffffff
    buffer_load_dwordx4 v5, s[48:51], s67 offen lds
    s_mov_b64 exec, -1
    s_add_u32 m0, s70, 37872
    s_mov_b32 exec_hi, 0x7fffffff
    buffer_load_dwordx4 v6, s[48:51], s67 offen lds
    s_mov_b64 exec, -1
    s_add_u32 m0, s70, 38880
    s_mov_b64 exec, 0x3ffff
    buffer_load_dwordx4 v7, s[48:51], s67 offen lds
    s_mov_b64 exec, -1
    s_add_u32 s67, s66, s93
    s_add_u32 m0, s70, 46080
    s_mov_b32 exec_hi, 0x7fffffff
    buffer_load_dwordx4 v5, s[48:51], s67 offen lds
    s_mov_b64 exec, -1
    s_add_u32 m0, s70, 47088
    s_mov_b32 exec_hi, 0x7fffffff
    buffer_load_dwordx4 v6, s[48:51], s67 offen lds
    s_mov_b64 exec, -1
    s_add_u32 m0, s70, 48096
    s_mov_b64 exec, 0x3ffff
    buffer_load_dwordx4 v7, s[48:51], s67 offen lds
    s_mov_b64 exec, -1
    ds_read_b64_tr_b16 v[128:129], v12 offset:0
    ds_read_b64_tr_b16 v[130:131], v13 offset:0
    ds_read_b64_tr_b16 v[148:149], v14 offset:0
    ds_read_b64_tr_b16 v[158:159], v15 offset:0
    ds_read_b64_tr_b16 v[132:133], v12 offset:8
    ds_read_b64_tr_b16 v[134:135], v13 offset:8
    ds_read_b64_tr_b16 v[150:151], v14 offset:8
    ds_read_b64_tr_b16 v[160:161], v15 offset:8
    ds_read_b64_tr_b16 v[136:137], v12 offset:16
    ds_read_b64_tr_b16 v[138:139], v13 offset:16
    ds_read_b64_tr_b16 v[152:153], v14 offset:16
    ds_read_b64_tr_b16 v[162:163], v15 offset:16
    ds_read_b64_tr_b16 v[140:141], v12 offset:24
    ds_read_b64_tr_b16 v[142:143], v13 offset:24
    ds_read_b64_tr_b16 v[154:155], v14 offset:24
    ds_read_b64_tr_b16 v[164:165], v15 offset:24
    ds_read_b64_tr_b16 v[144:145], v12 offset:32
    ds_read_b64_tr_b16 v[146:147], v13 offset:32
    ds_read_b64_tr_b16 v[156:157], v14 offset:32
    ds_read_b64_tr_b16 v[166:167], v15 offset:32
    s_waitcnt vmcnt(6) lgkmcnt(0)
    s_barrier
    global_load_dword v18, v30, s[40:41] sc1
    v_mfma_f32_16x16x32_bf16 v[72:75], v[52:55], v[120:123], v[72:75]
    ds_read_b128 v[112:115], v8 offset:0
    ds_read_b128 v[116:119], v8 offset:2048
    v_mfma_f32_16x16x32_bf16 v[76:79], v[52:55], v[124:127], v[76:79]
    ds_read_b64_tr_b16 v[32:33], v10 offset:18432
    ds_read_b64_tr_b16 v[34:35], v10 offset:18576
    v_mfma_f32_16x16x32_bf16 v[80:83], v[56:59], v[120:123], v[80:83]
    ds_read_b64_tr_b16 v[36:37], v10 offset:18464
    ds_read_b64_tr_b16 v[38:39], v10 offset:18608
    v_mfma_f32_16x16x32_bf16 v[84:87], v[56:59], v[124:127], v[84:87]
    ds_read_b64_tr_b16 v[40:41], v10 offset:27648
    v_mfma_f32_16x16x32_bf16 v[88:91], v[60:63], v[120:123], v[88:91]
    ds_read_b64_tr_b16 v[42:43], v10 offset:27792
    v_mfma_f32_16x16x32_bf16 v[92:95], v[60:63], v[124:127], v[92:95]
    ds_read_b64_tr_b16 v[44:45], v10 offset:27680
    v_mfma_f32_16x16x32_bf16 v[96:99], v[64:67], v[120:123], v[96:99]
    ds_read_b64_tr_b16 v[46:47], v10 offset:27824
    v_mfma_f32_16x16x32_bf16 v[100:103], v[64:67], v[124:127], v[100:103]
    ds_read_b64_tr_b16 v[48:49], v11 offset:18432
    v_mfma_f32_16x16x32_bf16 v[104:107], v[68:71], v[120:123], v[104:107]
    ds_read_b64_tr_b16 v[50:51], v11 offset:18576
    v_mfma_f32_16x16x32_bf16 v[108:111], v[68:71], v[124:127], v[108:111]
    s_waitcnt lgkmcnt(8)
    v_mfma_f32_16x16x32_bf16 v[72:75], v[32:35], v[112:115], v[72:75]
    ds_read_b128 v[120:123], v9 offset:0
    ds_read_b128 v[124:127], v9 offset:2048
    v_mfma_f32_16x16x32_bf16 v[76:79], v[32:35], v[116:119], v[76:79]
    ds_read_b64_tr_b16 v[52:53], v10 offset:23040
    ds_read_b64_tr_b16 v[54:55], v10 offset:23184
    s_waitcnt lgkmcnt(10)
    v_mfma_f32_16x16x32_bf16 v[80:83], v[36:39], v[112:115], v[80:83]
    ds_read_b64_tr_b16 v[56:57], v10 offset:23072
    ds_read_b64_tr_b16 v[58:59], v10 offset:23216
    v_mfma_f32_16x16x32_bf16 v[84:87], v[36:39], v[116:119], v[84:87]
    ds_read_b64_tr_b16 v[60:61], v10 offset:32256
    s_waitcnt lgkmcnt(11)
    v_mfma_f32_16x16x32_bf16 v[88:91], v[40:43], v[112:115], v[88:91]
    ds_read_b64_tr_b16 v[62:63], v10 offset:32400
    v_mfma_f32_16x16x32_bf16 v[92:95], v[40:43], v[116:119], v[92:95]
    ds_read_b64_tr_b16 v[64:65], v10 offset:32288
    s_waitcnt lgkmcnt(11)
    v_mfma_f32_16x16x32_bf16 v[96:99], v[44:47], v[112:115], v[96:99]
    ds_read_b64_tr_b16 v[66:67], v10 offset:32432
    v_mfma_f32_16x16x32_bf16 v[100:103], v[44:47], v[116:119], v[100:103]
    ds_read_b64_tr_b16 v[68:69], v11 offset:23040
    s_waitcnt lgkmcnt(11)
    v_mfma_f32_16x16x32_bf16 v[104:107], v[48:51], v[112:115], v[104:107]
    ds_read_b64_tr_b16 v[70:71], v11 offset:23184
    v_mfma_f32_16x16x32_bf16 v[108:111], v[48:51], v[116:119], v[108:111]
    s_add_u32 s66, s89, 2
    s_sub_u32 s15, s66, 3
    s_cmp_ge_u32 s66, 3
    s_cselect_b32 s66, s15, s66
    s_add_u32 s66, s66, 6
    s_mul_i32 s66, s66, 221184
    s_add_u32 s67, s66, s92
    s_add_u32 m0, s70, 0
    s_mov_b32 exec_hi, 0x7fffffff
    buffer_load_dwordx4 v5, s[48:51], s67 offen lds
    s_mov_b64 exec, -1
    s_add_u32 m0, s70, 1008
    s_mov_b32 exec_hi, 0x7fffffff
    buffer_load_dwordx4 v6, s[48:51], s67 offen lds
    s_mov_b64 exec, -1
    s_add_u32 m0, s70, 2016
    s_mov_b64 exec, 0x3ffff
    buffer_load_dwordx4 v7, s[48:51], s67 offen lds
    s_mov_b64 exec, -1
    s_add_u32 s67, s66, s93
    s_add_u32 m0, s70, 9216
    s_mov_b32 exec_hi, 0x7fffffff
    buffer_load_dwordx4 v5, s[48:51], s67 offen lds
    s_mov_b64 exec, -1
    s_add_u32 m0, s70, 10224
    s_mov_b32 exec_hi, 0x7fffffff
    buffer_load_dwordx4 v6, s[48:51], s67 offen lds
    s_mov_b64 exec, -1
    s_add_u32 m0, s70, 11232
    s_mov_b64 exec, 0x3ffff
    buffer_load_dwordx4 v7, s[48:51], s67 offen lds
    s_mov_b64 exec, -1
    s_waitcnt vmcnt(7) lgkmcnt(0)
    s_barrier
    v_mfma_f32_16x16x32_bf16 v[72:75], v[52:55], v[120:123], v[72:75]
    ds_read_b128 v[112:115], v8 offset:16384
    ds_read_b128 v[116:119], v8 offset:18432
    v_mfma_f32_16x16x32_bf16 v[76:79], v[52:55], v[124:127], v[76:79]
    ds_read_b64_tr_b16 v[32:33], v10 offset:36864
    ds_read_b64_tr_b16 v[34:35], v10 offset:37008
    v_mfma_f32_16x16x32_bf16 v[80:83], v[56:59], v[120:123], v[80:83]
    ds_read_b64_tr_b16 v[36:37], v10 offset:36896
    ds_read_b64_tr_b16 v[38:39], v10 offset:37040
    v_mfma_f32_16x16x32_bf16 v[84:87], v[56:59], v[124:127], v[84:87]
    ds_read_b64_tr_b16 v[40:41], v10 offset:46080
    v_mfma_f32_16x16x32_bf16 v[88:91], v[60:63], v[120:123], v[88:91]
    ds_read_b64_tr_b16 v[42:43], v10 offset:46224
    v_mfma_f32_16x16x32_bf16 v[92:95], v[60:63], v[124:127], v[92:95]
    ds_read_b64_tr_b16 v[44:45], v10 offset:46112
    v_mfma_f32_16x16x32_bf16 v[96:99], v[64:67], v[120:123], v[96:99]
    ds_read_b64_tr_b16 v[46:47], v10 offset:46256
    v_mfma_f32_16x16x32_bf16 v[100:103], v[64:67], v[124:127], v[100:103]
    ds_read_b64_tr_b16 v[48:49], v11 offset:36864
    v_mfma_f32_16x16x32_bf16 v[104:107], v[68:71], v[120:123], v[104:107]
    ds_read_b64_tr_b16 v[50:51], v11 offset:37008
    v_mfma_f32_16x16x32_bf16 v[108:111], v[68:71], v[124:127], v[108:111]
    s_waitcnt lgkmcnt(8)
    v_mfma_f32_16x16x32_bf16 v[72:75], v[32:35], v[112:115], v[72:75]
    ds_read_b128 v[120:123], v9 offset:16384
    ds_read_b128 v[124:127], v9 offset:18432
    v_mfma_f32_16x16x32_bf16 v[76:79], v[32:35], v[116:119], v[76:79]
    ds_read_b64_tr_b16 v[52:53], v10 offset:41472
    ds_read_b64_tr_b16 v[54:55], v10 offset:41616
    s_waitcnt lgkmcnt(10)
    v_mfma_f32_16x16x32_bf16 v[80:83], v[36:39], v[112:115], v[80:83]
    ds_read_b64_tr_b16 v[56:57], v10 offset:41504
    ds_read_b64_tr_b16 v[58:59], v10 offset:41648
    v_mfma_f32_16x16x32_bf16 v[84:87], v[36:39], v[116:119], v[84:87]
    ds_read_b64_tr_b16 v[60:61], v10 offset:50688
    s_waitcnt lgkmcnt(11)
    v_mfma_f32_16x16x32_bf16 v[88:91], v[40:43], v[112:115], v[88:91]
    ds_read_b64_tr_b16 v[62:63], v10 offset:50832
    v_mfma_f32_16x16x32_bf16 v[92:95], v[40:43], v[116:119], v[92:95]
    ds_read_b64_tr_b16 v[64:65], v10 offset:50720
    s_waitcnt lgkmcnt(11)
    v_mfma_f32_16x16x32_bf16 v[96:99], v[44:47], v[112:115], v[96:99]
    ds_read_b64_tr_b16 v[66:67], v10 offset:50864
    v_mfma_f32_16x16x32_bf16 v[100:103], v[44:47], v[116:119], v[100:103]
    ds_read_b64_tr_b16 v[68:69], v11 offset:41472
    s_waitcnt lgkmcnt(11)
    v_mfma_f32_16x16x32_bf16 v[104:107], v[48:51], v[112:115], v[104:107]
    ds_read_b64_tr_b16 v[70:71], v11 offset:41616
    v_mfma_f32_16x16x32_bf16 v[108:111], v[48:51], v[116:119], v[108:111]
    s_mov_b32 s88, 0
    s_add_u32 m0, s71, 0
    s_nop 0
    buffer_load_dwordx4 v240, s[60:63], s88 offen lds
    s_mov_b32 s88, 41472
    s_add_u32 m0, s71, 4096
    s_nop 0
    buffer_load_dwordx4 v240, s[60:63], s88 offen lds
    s_mov_b32 s88, 82944
    s_add_u32 m0, s71, 8192
    s_nop 0
    buffer_load_dwordx4 v240, s[60:63], s88 offen lds
    s_mov_b32 s88, 124416
    s_add_u32 m0, s71, 12288
    s_nop 0
    buffer_load_dwordx4 v240, s[60:63], s88 offen lds
    s_mov_b32 s88, 165888
    s_add_u32 m0, s71, 16384
    s_nop 0
    buffer_load_dwordx4 v240, s[60:63], s88 offen lds
    s_mov_b32 s88, 207360
    s_add_u32 m0, s71, 20480
    s_nop 0
    buffer_load_dwordx4 v240, s[60:63], s88 offen lds
    s_waitcnt vmcnt(6) lgkmcnt(0)
    s_barrier
    v_mfma_f32_16x16x32_bf16 v[72:75], v[52:55], v[120:123], v[72:75]
    ds_read_b128 v[112:115], v8 offset:32768
    ds_read_b128 v[116:119], v8 offset:34816
    v_mfma_f32_16x16x32_bf16 v[76:79], v[52:55], v[124:127], v[76:79]
    ds_read_b64_tr_b16 v[32:33], v10 offset:0
    ds_read_b64_tr_b16 v[34:35], v10 offset:144
    v_mfma_f32_16x16x32_bf16 v[80:83], v[56:59], v[120:123], v[80:83]
    ds_read_b64_tr_b16 v[36:37], v10 offset:32
    ds_read_b64_tr_b16 v[38:39], v10 offset:176
    v_mfma_f32_16x16x32_bf16 v[84:87], v[56:59], v[124:127], v[84:87]
    ds_read_b64_tr_b16 v[40:41], v10 offset:9216
    v_mfma_f32_16x16x32_bf16 v[88:91], v[60:63], v[120:123], v[88:91]
    ds_read_b64_tr_b16 v[42:43], v10 offset:9360
    v_mfma_f32_16x16x32_bf16 v[92:95], v[60:63], v[124:127], v[92:95]
    ds_read_b64_tr_b16 v[44:45], v10 offset:9248
    v_mfma_f32_16x16x32_bf16 v[96:99], v[64:67], v[120:123], v[96:99]
    ds_read_b64_tr_b16 v[46:47], v10 offset:9392
    v_mfma_f32_16x16x32_bf16 v[100:103], v[64:67], v[124:127], v[100:103]
    ds_read_b64_tr_b16 v[48:49], v11 offset:0
    v_mfma_f32_16x16x32_bf16 v[104:107], v[68:71], v[120:123], v[104:107]
    ds_read_b64_tr_b16 v[50:51], v11 offset:144
    v_mfma_f32_16x16x32_bf16 v[108:111], v[68:71], v[124:127], v[108:111]
    s_waitcnt lgkmcnt(8)
    v_mfma_f32_16x16x32_bf16 v[72:75], v[32:35], v[112:115], v[72:75]
    ds_read_b128 v[120:123], v9 offset:32768
    ds_read_b128 v[124:127], v9 offset:34816
    v_mfma_f32_16x16x32_bf16 v[76:79], v[32:35], v[116:119], v[76:79]
    ds_read_b64_tr_b16 v[52:53], v10 offset:4608
    ds_read_b64_tr_b16 v[54:55], v10 offset:4752
    s_waitcnt lgkmcnt(10)
    v_mfma_f32_16x16x32_bf16 v[80:83], v[36:39], v[112:115], v[80:83]
    ds_read_b64_tr_b16 v[56:57], v10 offset:4640
    ds_read_b64_tr_b16 v[58:59], v10 offset:4784
    v_mfma_f32_16x16x32_bf16 v[84:87], v[36:39], v[116:119], v[84:87]
    ds_read_b64_tr_b16 v[60:61], v10 offset:13824
    s_waitcnt lgkmcnt(11)
    v_mfma_f32_16x16x32_bf16 v[88:91], v[40:43], v[112:115], v[88:91]
    ds_read_b64_tr_b16 v[62:63], v10 offset:13968
    v_mfma_f32_16x16x32_bf16 v[92:95], v[40:43], v[116:119], v[92:95]
    ds_read_b64_tr_b16 v[64:65], v10 offset:13856
    s_waitcnt lgkmcnt(11)
    v_mfma_f32_16x16x32_bf16 v[96:99], v[44:47], v[112:115], v[96:99]
    ds_read_b64_tr_b16 v[66:67], v10 offset:14000
    v_mfma_f32_16x16x32_bf16 v[100:103], v[44:47], v[116:119], v[100:103]
    ds_read_b64_tr_b16 v[68:69], v11 offset:4608
    s_waitcnt lgkmcnt(11)
    v_mfma_f32_16x16x32_bf16 v[104:107], v[48:51], v[112:115], v[104:107]
    ds_read_b64_tr_b16 v[70:71], v11 offset:4752
    v_mfma_f32_16x16x32_bf16 v[108:111], v[48:51], v[116:119], v[108:111]
    s_mov_b32 s88, 248832
    s_add_u32 m0, s71, 24576
    s_nop 0
    buffer_load_dwordx4 v240, s[60:63], s88 offen lds
    s_mov_b32 s88, 290304
    s_add_u32 m0, s71, 28672
    s_nop 0
    buffer_load_dwordx4 v240, s[60:63], s88 offen lds
    s_mov_b32 s88, 331776
    s_add_u32 m0, s71, 32768
    s_nop 0
    buffer_load_dwordx4 v240, s[60:63], s88 offen lds
    s_mov_b32 s88, 373248
    s_add_u32 m0, s71, 36864
    s_nop 0
    buffer_load_dwordx4 v240, s[60:63], s88 offen lds
    s_mov_b32 s88, 414720
    s_add_u32 m0, s71, 40960
    s_nop 0
    buffer_load_dwordx4 v240, s[60:63], s88 offen lds
    s_waitcnt lgkmcnt(8)
    v_mfma_f32_16x16x32_bf16 v[72:75], v[52:55], v[120:123], v[72:75]
    v_mfma_f32_16x16x32_bf16 v[76:79], v[52:55], v[124:127], v[76:79]
    s_waitcnt lgkmcnt(6)
    v_mfma_f32_16x16x32_bf16 v[80:83], v[56:59], v[120:123], v[80:83]
    v_mfma_f32_16x16x32_bf16 v[84:87], v[56:59], v[124:127], v[84:87]
    s_waitcnt lgkmcnt(4)
    v_mfma_f32_16x16x32_bf16 v[88:91], v[60:63], v[120:123], v[88:91]
    v_mfma_f32_16x16x32_bf16 v[92:95], v[60:63], v[124:127], v[92:95]
    s_waitcnt lgkmcnt(2)
    v_mfma_f32_16x16x32_bf16 v[96:99], v[64:67], v[120:123], v[96:99]
    v_mfma_f32_16x16x32_bf16 v[100:103], v[64:67], v[124:127], v[100:103]
    s_waitcnt lgkmcnt(0)
    v_mfma_f32_16x16x32_bf16 v[104:107], v[68:71], v[120:123], v[104:107]
    v_mfma_f32_16x16x32_bf16 v[108:111], v[68:71], v[124:127], v[108:111]
    s_branch B_join
V_path:
    v_mov_b32 v30, 0
    v_lshrrev_b32 v21, 1, v22
    v_xor_b32 v21, v21, v19
    v_lshlrev_b32 v21, 4, v21
    v_lshl_add_u32 v8, v22, 7, v21
    s_lshl_b32 s14, s68, 11
    v_add_u32 v8, s14, v8
    v_xor_b32 v9, 64, v8
    v_lshlrev_b32 v21, 1, v23
    v_lshl_add_u32 v21, v19, 3, v21
    v_mul_u32_u24 v21, 144, v21
    v_add_u32 v21, 95304, v21
    v_lshl_add_u32 v10, v24, 3, v21
    v_and_b32 v20, 1, v24
    v_mul_u32_u24 v20, 9216, v20
    v_add3_u32 v11, v21, v20, 64

    s_mov_b32 s72, 0x3fb8aa3b
    s_mov_b32 s73, 0x3fb8aa3b
    s_mul_i32 s14, s13, 2880
    s_add_u32 s14, s14, 154624
    v_lshl_add_u32 v20, v19, 2, v23
    v_and_b32 v21, 1, v24
    v_mul_u32_u24 v21, 40, v21
    v_add_u32 v21, s14, v21
    v_mov_b32 v25, 160384
    v_mul_u32_u24 v12, 80, v20
    v_add_u32 v12, v12, v21
    v_add_u32 v13, 1280, v12
    v_mul_u32_u24 v14, 80, v23
    v_add_u32 v14, v14, v21
    v_add_u32 v14, 2560, v14
    s_and_b32 s91, s4, 1
    s_sub_i32 s15, s91, s13
    s_mul_i32 s15, s15, 2880
    v_add_u32 v234, s15, v12
    v_add_u32 v235, s15, v13
    v_add_u32 v15, s15, v14
    s_and_b32 s15, s5, 1
    s_lshl_b32 s74, s91, 1
    s_add_u32 s15, s15, s74
    v_cmp_gt_u32 vcc, 2, v24
    v_cmp_gt_u32 s[76:77], 2, v20
    v_cmp_eq_u32 s[78:79], 0, v19
    v_cmp_eq_u32 s[74:75], s15, v19
    v_cndmask_b32 v12, v25, v12, vcc
    v_cndmask_b32 v234, v25, v234, vcc
    s_xnor_b64 s[76:77], s[76:77], vcc
    s_andn2_b64 s[78:79], s[78:79], vcc
    s_andn2_b64 s[74:75], s[74:75], vcc
    v_cndmask_b32 v13, v25, v13, s[76:77]
    v_cndmask_b32 v235, v25, v235, s[76:77]
    v_cndmask_b32 v15, v25, v15, s[74:75]
    v_cndmask_b32 v14, v25, v14, s[78:79]
    s_mul_i32 s84, s13, 21504
    s_mul_i32 s85, s13, 11264
    s_add_u32 s85, s85, 132096
    s_lshl_b32 s14, s12, 5
    v_add_u32 v20, s14, v22
    v_mul_u32_u24 v200, 168, v20
    v_mul_u32_u24 v21, 40, v19
    v_add3_u32 v200, v200, v21, s84
    v_mul_u32_u24 v201, 88, v20
    v_add_u32 v201, s85, v201
    v_min_u32 v21, 48, v21
    v_add3_u32 v202, v201, v21, 32
    v_lshl_add_u32 v201, v19, 3, v201
    v_and_b32 v20, 1, v19
    v_lshlrev_b32 v20, 4, v20
    v_lshl_add_u32 v20, v23, 2, v20
    v_lshrrev_b32 v21, 1, v19
    v_lshl_add_u32 v20, v21, 1, v20
    v_mul_u32_u24 v203, 168, v20
    v_lshl_add_u32 v203, v24, 3, v203
    v_add_u32 v203, s84, v203
    s_lshr_b32 s10, s12, 1
    s_add_u32 s11, s12, s10
    s_lshl_b32 s14, s11, 5
    v_add_u32 v204, 64, v203
    v_add_u32 v203, s14, v203
    v_mul_u32_u24 v205, 88, v20
    v_add_u32 v205, s85, v205
    v_and_b32 v21, 1, v24
    v_lshl_add_u32 v206, v21, 3, v205
    v_add_u32 v206, 32, v206
    v_lshl_add_u32 v205, v24, 3, v205
    s_mul_i32 s14, s10, 48
    v_add_u32 v205, s14, v205
    s_lshl_b32 s3, s5, 1
    s_add_u32 s3, s3, s13
    s_lshl_b32 s15, s3, 4
    s_add_u32 s15, s15, s4
    s_mul_i32 s14, s15, 3200
    s_lshl_b32 s74, s12, 9
    s_add_u32 s74, s74, s14
    v_lshl_add_u32 v207, v2, 3, s74
    s_lshl_b32 s74, s11, 7
    s_add_u32 s74, s74, s14
    s_add_u32 s74, s74, 2560
    v_lshl_add_u32 v208, v22, 3, s74
    v_mov_b32 v25, 0x7f000000
    v_cmp_eq_u32 vcc, s10, v19
    v_lshrrev_b32 v20, 3, v22
    s_nop 0
    v_cndmask_b32 v208, v25, v208, vcc
    v_and_b32 v21, 7, v22
    v_lshlrev_b32 v21, 3, v21
    v_lshl_add_u32 v21, v19, 6, v21
    s_lshl_b32 s74, s10, 8
    s_add_u32 s74, s74, s14
    s_add_u32 s74, s74, 2048
    v_add_u32 v209, s74, v21
    v_cmp_eq_u32 vcc, s10, v20
    s_bitcmp0_b32 s12, 0
    s_cselect_b64 s[76:77], vcc, 0
    v_cndmask_b32 v209, v25, v209, s[76:77]
    s_add_u32 s74, s14, 2816
    v_lshl_add_u32 v210, v22, 3, s74
    v_cmp_eq_u32 vcc, v19, v20
    s_cmp_eq_u32 s12, 1
    s_cselect_b64 s[76:77], vcc, 0
    v_cndmask_b32 v210, v25, v210, s[76:77]
    s_lshl_b32 s74, s5, 4
    s_add_u32 s74, s74, s4
    s_lshl_b32 s74, s74, 7
    s_add_u32 s74, s74, 0xd0000
    v_mov_b32 v211, s74
    s_lshl_b32 s3, s5, 1
    s_add_u32 s3, s3, s91
    s_lshr_b32 s14, s4, 1
    s_lshl_b32 s14, s14, 4
    s_lshl_b32 s75, s6, 1
    s_add_u32 s14, s14, s75
    s_mul_i32 s74, s14, 18432
    s_add_u32 s74, s74, 0x100000
    s_lshl_b32 s75, s3, 10
    s_add_u32 s75, s75, s74
    v_lshl_add_u32 v228, v2, 4, s75
    s_lshl_b32 s75, s3, 7
    s_add_u32 s75, s75, s74
    s_add_u32 s75, s75, 16384
    v_lshl_add_u32 v229, v2, 3, s75
    v_cmp_gt_u32 vcc, 16, v2
    s_nop 1
    v_cndmask_b32 v229, v25, v229, vcc
    s_lshl_b32 s74, s4, 3
    s_add_u32 s74, s74, s5
    s_lshl_b32 s74, s74, 7
    s_add_u32 s74, s74, 0xd8000
    v_mov_b32 v230, s74
    s_mul_i32 s74, s14, 18432
    s_add_u32 s74, s74, 0x401000
    s_lshl_b32 s75, s3, 10
    s_add_u32 s75, s75, s74
    v_lshl_add_u32 v231, v2, 4, s75
    s_lshr_b32 s75, s5, 1
    s_lshl_b32 s76, s75, 9
    s_add_u32 s76, s76, s74
    s_add_u32 s76, s76, 16384
    v_lshl_add_u32 v232, v2, 3, s76
    v_mov_b32 v20, s14
    v_mul_u32_u24 v20, 6554, v20
    v_lshrrev_b32 v20, 16, v20
    v_lshl_add_u32 v20, v20, 2, s75
    v_lshlrev_b32 v20, 7, v20
    v_add_u32 v233, 0xdc000, v20

    s_mov_b32 s60, s36
    s_mov_b32 s61, s37
    s_mov_b32 s62, 663552
    s_mov_b32 s63, 0x00020000
    s_lshl_b32 s71, s12, 10
    s_add_u32 s71, s71, 49152
    v_lshrrev_b32 v25, 3, v2
    v_and_b32 v26, 1, v19
    v_lshlrev_b32 v26, 1, v26
    s_and_b32 s74, s12, 1
    s_lshl_b32 s74, s74, 2
    v_or_b32 v26, s74, v26
    v_and_b32 v27, 7, v2
    v_xor_b32 v26, v26, v27
    s_lshl_b32 s75, s8, 7
    v_lshl_add_u32 v26, v26, 4, s75
    s_lshl_b32 s74, s12, 3
    v_add_u32 v240, s74, v25
    v_mul_u32_u24 v240, 1152, v240
    v_add_u32 v240, v240, v26
    v_lshrrev_b32 v27, 2, v25
    s_lshl_b32 s74, s12, 1
    v_add_u32 v27, s74, v27
    v_mul_u32_u24 v27, 36, v27
    v_and_b32 v28, 3, v25
    v_add3_u32 v27, v27, v28, 32
    v_mul_u32_u24 v241, 1152, v27
    v_add_u32 v241, v241, v26

    v_mov_b32 v25, 0x7f000000
    s_lshl_b32 s74, s5, 11
    s_add_u32 s74, s74, 0xd0000
    v_lshl_add_u32 v212, v22, 7, s74
    s_mul_i32 s74, s3, 51200
    s_lshl_b32 s75, s6, 9
    s_add_u32 s74, s74, s75
    v_and_b32 v20, 31, v2
    v_lshl_add_u32 v213, v20, 4, s74
    v_lshrrev_b32 v21, 5, v2
    v_mul_u32_u24 v21, 3200, v21
    v_add_u32 v213, v213, v21
    v_lshl_add_u32 v21, v20, 4, s75
    v_cmp_gt_u32 vcc, 3200, v21
    s_nop 1
    v_cndmask_b32 v213, v25, v213, vcc
    v_lshrrev_b32 v20, 3, v22
    v_and_b32 v21, 1, v19
    v_cmp_eq_u32 vcc, v20, v21
    v_and_b32 v20, 1, v22
    v_lshlrev_b32 v20, 4, v20
    v_mov_b32 v21, 0x3f80
    v_lshlrev_b32 v21, v20, v21
    v_cndmask_b32 v21, 0, v21, vcc
    v_bfe_u32 v20, v22, 1, 2

    v_cmp_eq_u32 vcc, 0, v20
    s_nop 1
    v_cndmask_b32 v216, 0, v21, vcc
    v_cmp_eq_u32 vcc, 1, v20
    s_nop 1
    v_cndmask_b32 v217, 0, v21, vcc
    v_cmp_eq_u32 vcc, 2, v20
    s_nop 1
    v_cndmask_b32 v218, 0, v21, vcc
    v_cmp_eq_u32 vcc, 3, v20
    s_nop 1
    v_cndmask_b32 v219, 0, v21, vcc
    s_mov_b32 s94, 132096
    v_lshrrev_b32 v16, 1, v19
    v_lshlrev_b32 v16, 5, v16
    v_lshl_add_u32 v16, v22, 1, v16
    v_and_b32 v20, 1, v19
    v_add_u32 v16, v16, v20
    v_and_b32 v20, 15, v16
    s_lshl_b32 s74, s11, 4
    v_add_u32 v20, s74, v20
    v_mul_u32_u24 v220, 56, v20
    v_lshrrev_b32 v20, 4, v16
    v_lshl_add_u32 v220, v20, 3, v220
    v_add_u32 v220, s94, v220
    v_lshrrev_b32 v20, 5, v16
    v_and_b32 v21, 7, v16
    v_lshl_add_u32 v20, v20, 3, v21
    v_mul_u32_u24 v221, 56, v20
    v_bfe_u32 v20, v16, 3, 2
    v_lshl_add_u32 v221, v20, 3, v221
    s_add_u32 s74, s94, 1792
    v_add_u32 v221, s74, v221
    v_mov_b32 v18, 262144
    s_cmp_eq_u32 s6, 4
    s_cselect_b64 vcc, -1, 0
    v_cndmask_b32 v221, v18, v221, vcc
    s_cmp_lt_u32 s6, 4
    s_cselect_b64 vcc, -1, 0
    v_cndmask_b32 v220, v221, v220, vcc
    s_sub_u32 s74, s6, 5
    s_lshl_b32 s74, s74, 6
    v_add_u32 v16, s74, v16
    v_mul_u32_u24 v222, 56, v16
    v_add3_u32 v222, v222, s94, 32
    v_cmp_gt_u32 vcc, 80, v16
    v_cmp_gt_u32 s[86:87], 40, v16
    s_nop 0
    v_cndmask_b32 v222, v18, v222, vcc
    v_mul_u32_u24 v16, 20, v19
    v_add_u32 v16, v16, v23
    v_mul_u32_u24 v16, 56, v16
    v_add_u32 v16, s94, v16
    v_cmp_gt_u32 s[78:79], 2, v19

    v_lshl_add_u32 v21, v24, 1, 0
    v_cmp_lt_u32 vcc, 4, v21
    v_subrev_u32 v18, 5, v21
    s_nop 0
    v_cndmask_b32 v20, v21, 6, vcc
    v_cndmask_b32 v18, 6, v18, vcc
    v_cmp_eq_u32 vcc, 4, v21
    s_nop 1
    v_cndmask_b32 v18, v18, 4, vcc
    v_cndmask_b32 v20, v18, v20, s[78:79]
    v_lshl_add_u32 v224, v20, 3, v16

    v_lshl_add_u32 v21, v24, 1, 1
    v_cmp_lt_u32 vcc, 4, v21
    v_subrev_u32 v18, 5, v21
    s_nop 0
    v_cndmask_b32 v20, v21, 6, vcc
    v_cndmask_b32 v18, 6, v18, vcc
    v_cmp_eq_u32 vcc, 4, v21
    s_nop 1
    v_cndmask_b32 v18, v18, 4, vcc
    v_cndmask_b32 v20, v18, v20, s[78:79]
    v_lshl_add_u32 v225, v20, 3, v16

    v_mov_b32 v21, 8
    v_cmp_lt_u32 vcc, 4, v21
    v_subrev_u32 v18, 5, v21
    s_nop 0
    v_cndmask_b32 v20, v21, 6, vcc
    v_cndmask_b32 v18, 6, v18, vcc
    v_cmp_eq_u32 vcc, 4, v21
    s_nop 1
    v_cndmask_b32 v18, v18, 4, vcc
    v_cndmask_b32 v20, v18, v20, s[78:79]
    v_lshl_add_u32 v226, v20, 3, v16

    v_add_u32 v227, 40, v16
    v_cmp_gt_u32 s[84:85], 3, v19

    v_mov_b32 v18, 0
    s_add_u32 s64, s89, 1
    s_sub_u32 s15, s64, 3
    s_cmp_ge_u32 s64, 3
    s_cselect_b32 s64, s15, s64
    s_add_u32 s64, s64, 0
    s_mul_i32 s64, s64, 128
    s_add_u32 m0, s69, 16384
    s_nop 0
    buffer_load_dwordx4 v3, s[44:47], s64 offen lds
    s_add_u32 m0, s69, 17408
    s_nop 0
    buffer_load_dwordx4 v4, s[44:47], s64 offen lds
    s_add_u32 s65, s64, 18432
    s_add_u32 m0, s69, 18432
    s_nop 0
    buffer_load_dwordx4 v3, s[44:47], s65 offen lds
    s_add_u32 m0, s69, 19456
    s_nop 0
    buffer_load_dwordx4 v4, s[44:47], s65 offen lds
    v_lshlrev_b32 v250, 21, v24
    v_add_u32 v251, 0x1f0000, v250
    v_cmp_eq_u32 vcc, 0, v24
    v_mov_b32 v252, 0xf0000
    s_nop 0
    v_cndmask_b32 v251, v251, v252, vcc
    v_cmp_eq_u32 vcc, 2, v24
    v_mov_b32 v252, 0x400000
    s_nop 0
    v_cndmask_b32 v251, v251, v252, vcc
    s_mov_b64 exec, 15
    buffer_load_dword v253, v251, s[52:55], 0 offen
    buffer_load_dword v254, v250, s[56:59], 0 offen
    s_mov_b64 exec, -1

    s_waitcnt vmcnt(6) lgkmcnt(0)
    s_barrier
    s_add_u32 s64, s89, 2
    s_sub_u32 s15, s64, 3
    s_cmp_ge_u32 s64, 3
    s_cselect_b32 s64, s15, s64
    s_add_u32 s64, s64, 0
    s_mul_i32 s64, s64, 128
    s_add_u32 m0, s69, 32768
    s_nop 0
    buffer_load_dwordx4 v3, s[44:47], s64 offen lds
    s_add_u32 m0, s69, 33792
    s_nop 0
    buffer_load_dwordx4 v4, s[44:47], s64 offen lds
    s_add_u32 s65, s64, 18432
    s_add_u32 m0, s69, 34816
    s_nop 0
    buffer_load_dwordx4 v3, s[44:47], s65 offen lds
    s_add_u32 m0, s69, 35840
    s_nop 0
    buffer_load_dwordx4 v4, s[44:47], s65 offen lds
    ds_read_b128 v[112:115], v8 offset:0
    ds_read_b128 v[116:119], v8 offset:2048
    ds_read_b64_tr_b16 v[32:33], v10 offset:18432
    ds_read_b64_tr_b16 v[34:35], v10 offset:18576
    ds_read_b64_tr_b16 v[36:37], v10 offset:18464
    ds_read_b64_tr_b16 v[38:39], v10 offset:18608
    ds_read_b64_tr_b16 v[40:41], v10 offset:27648
    ds_read_b64_tr_b16 v[42:43], v10 offset:27792
    ds_read_b64_tr_b16 v[44:45], v10 offset:27680
    ds_read_b64_tr_b16 v[46:47], v10 offset:27824
    ds_read_b64_tr_b16 v[48:49], v11 offset:18432
    ds_read_b64_tr_b16 v[50:51], v11 offset:18576
    s_waitcnt lgkmcnt(8)
    v_mfma_f32_16x16x32_bf16 v[72:75], v[32:35], v[112:115], 0
    ds_read_b128 v[120:123], v9 offset:0
    ds_read_b128 v[124:127], v9 offset:2048
    v_mfma_f32_16x16x32_bf16 v[76:79], v[32:35], v[116:119], 0
    ds_read_b64_tr_b16 v[52:53], v10 offset:23040
    ds_read_b64_tr_b16 v[54:55], v10 offset:23184
    s_waitcnt lgkmcnt(10)
    v_mfma_f32_16x16x32_bf16 v[80:83], v[36:39], v[112:115], 0
    ds_read_b64_tr_b16 v[56:57], v10 offset:23072
    ds_read_b64_tr_b16 v[58:59], v10 offset:23216
    v_mfma_f32_16x16x32_bf16 v[84:87], v[36:39], v[116:119], 0
    ds_read_b64_tr_b16 v[60:61], v10 offset:32256
    s_waitcnt lgkmcnt(11)
    v_mfma_f32_16x16x32_bf16 v[88:91], v[40:43], v[112:115], 0
    ds_read_b64_tr_b16 v[62:63], v10 offset:32400
    v_mfma_f32_16x16x32_bf16 v[92:95], v[40:43], v[116:119], 0
    ds_read_b64_tr_b16 v[64:65], v10 offset:32288
    s_waitcnt lgkmcnt(11)
    v_mfma_f32_16x16x32_bf16 v[96:99], v[44:47], v[112:115], 0
    ds_read_b64_tr_b16 v[66:67], v10 offset:32432
    v_mfma_f32_16x16x32_bf16 v[100:103], v[44:47], v[116:119], 0
    ds_read_b64_tr_b16 v[68:69], v11 offset:23040
    s_waitcnt lgkmcnt(11)
    v_mfma_f32_16x16x32_bf16 v[104:107], v[48:51], v[112:115], 0
    ds_read_b64_tr_b16 v[70:71], v11 offset:23184
    v_mfma_f32_16x16x32_bf16 v[108:111], v[48:51], v[116:119], 0
    s_waitcnt vmcnt(6) lgkmcnt(0)
    s_barrier
    s_add_u32 s64, s89, 0
    s_sub_u32 s15, s64, 3
    s_cmp_ge_u32 s64, 3
    s_cselect_b32 s64, s15, s64
    s_add_u32 s64, s64, 3
    s_mul_i32 s64, s64, 128
    s_add_u32 m0, s69, 0
    s_nop 0
    buffer_load_dwordx4 v3, s[44:47], s64 offen lds
    s_add_u32 m0, s69, 1024
    s_nop 0
    buffer_load_dwordx4 v4, s[44:47], s64 offen lds
    s_add_u32 s65, s64, 18432
    s_add_u32 m0, s69, 2048
    s_nop 0
    buffer_load_dwordx4 v3, s[44:47], s65 offen lds
    s_add_u32 m0, s69, 3072
    s_nop 0
    buffer_load_dwordx4 v4, s[44:47], s65 offen lds
    v_mfma_f32_16x16x32_bf16 v[72:75], v[52:55], v[120:123], v[72:75]
    ds_read_b128 v[112:115], v8 offset:16384
    ds_read_b128 v[116:119], v8 offset:18432
    v_mfma_f32_16x16x32_bf16 v[76:79], v[52:55], v[124:127], v[76:79]
    ds_read_b64_tr_b16 v[32:33], v10 offset:36864
    ds_read_b64_tr_b16 v[34:35], v10 offset:37008
    v_mfma_f32_16x16x32_bf16 v[80:83], v[56:59], v[120:123], v[80:83]
    ds_read_b64_tr_b16 v[36:37], v10 offset:36896
    ds_read_b64_tr_b16 v[38:39], v10 offset:37040
    v_mfma_f32_16x16x32_bf16 v[84:87], v[56:59], v[124:127], v[84:87]
    ds_read_b64_tr_b16 v[40:41], v10 offset:46080
    v_mfma_f32_16x16x32_bf16 v[88:91], v[60:63], v[120:123], v[88:91]
    ds_read_b64_tr_b16 v[42:43], v10 offset:46224
    v_mfma_f32_16x16x32_bf16 v[92:95], v[60:63], v[124:127], v[92:95]
    ds_read_b64_tr_b16 v[44:45], v10 offset:46112
    v_mfma_f32_16x16x32_bf16 v[96:99], v[64:67], v[120:123], v[96:99]
    ds_read_b64_tr_b16 v[46:47], v10 offset:46256
    v_mfma_f32_16x16x32_bf16 v[100:103], v[64:67], v[124:127], v[100:103]
    ds_read_b64_tr_b16 v[48:49], v11 offset:36864
    v_mfma_f32_16x16x32_bf16 v[104:107], v[68:71], v[120:123], v[104:107]
    ds_read_b64_tr_b16 v[50:51], v11 offset:37008
    v_mfma_f32_16x16x32_bf16 v[108:111], v[68:71], v[124:127], v[108:111]
    s_waitcnt lgkmcnt(8)
    v_mfma_f32_16x16x32_bf16 v[72:75], v[32:35], v[112:115], v[72:75]
    ds_read_b128 v[120:123], v9 offset:16384
    ds_read_b128 v[124:127], v9 offset:18432
    v_mfma_f32_16x16x32_bf16 v[76:79], v[32:35], v[116:119], v[76:79]
    ds_read_b64_tr_b16 v[52:53], v10 offset:41472
    ds_read_b64_tr_b16 v[54:55], v10 offset:41616
    s_waitcnt lgkmcnt(10)
    v_mfma_f32_16x16x32_bf16 v[80:83], v[36:39], v[112:115], v[80:83]
    ds_read_b64_tr_b16 v[56:57], v10 offset:41504
    ds_read_b64_tr_b16 v[58:59], v10 offset:41648
    v_mfma_f32_16x16x32_bf16 v[84:87], v[36:39], v[116:119], v[84:87]
    ds_read_b64_tr_b16 v[60:61], v10 offset:50688
    s_waitcnt lgkmcnt(11)
    v_mfma_f32_16x16x32_bf16 v[88:91], v[40:43], v[112:115], v[88:91]
    ds_read_b64_tr_b16 v[62:63], v10 offset:50832
    v_mfma_f32_16x16x32_bf16 v[92:95], v[40:43], v[116:119], v[92:95]
    ds_read_b64_tr_b16 v[64:65], v10 offset:50720
    s_waitcnt lgkmcnt(11)
    v_mfma_f32_16x16x32_bf16 v[96:99], v[44:47], v[112:115], v[96:99]
    ds_read_b64_tr_b16 v[66:67], v10 offset:50864
    v_mfma_f32_16x16x32_bf16 v[100:103], v[44:47], v[116:119], v[100:103]
    ds_read_b64_tr_b16 v[68:69], v11 offset:41472
    s_waitcnt lgkmcnt(11)
    v_mfma_f32_16x16x32_bf16 v[104:107], v[48:51], v[112:115], v[104:107]
    ds_read_b64_tr_b16 v[70:71], v11 offset:41616
    v_mfma_f32_16x16x32_bf16 v[108:111], v[48:51], v[116:119], v[108:111]
    s_waitcnt vmcnt(4) lgkmcnt(0)
    s_barrier
    s_add_u32 s64, s89, 1
    s_sub_u32 s15, s64, 3
    s_cmp_ge_u32 s64, 3
    s_cselect_b32 s64, s15, s64
    s_add_u32 s64, s64, 3
    s_mul_i32 s64, s64, 128
    s_add_u32 m0, s69, 16384
    s_nop 0
    buffer_load_dwordx4 v3, s[44:47], s64 offen lds
    s_add_u32 m0, s69, 17408
    s_nop 0
    buffer_load_dwordx4 v4, s[44:47], s64 offen lds
    s_add_u32 s65, s64, 18432
    s_add_u32 m0, s69, 18432
    s_nop 0
    buffer_load_dwordx4 v3, s[44:47], s65 offen lds
    s_add_u32 m0, s69, 19456
    s_nop 0
    buffer_load_dwordx4 v4, s[44:47], s65 offen lds
    v_mfma_f32_16x16x32_bf16 v[72:75], v[52:55], v[120:123], v[72:75]
    ds_read_b128 v[112:115], v8 offset:32768
    ds_read_b128 v[116:119], v8 offset:34816
    v_mfma_f32_16x16x32_bf16 v[76:79], v[52:55], v[124:127], v[76:79]
    ds_read_b64_tr_b16 v[32:33], v10 offset:0
    ds_read_b64_tr_b16 v[34:35], v10 offset:144
    v_mfma_f32_16x16x32_bf16 v[80:83], v[56:59], v[120:123], v[80:83]
    ds_read_b64_tr_b16 v[36:37], v10 offset:32
    ds_read_b64_tr_b16 v[38:39], v10 offset:176
    v_mfma_f32_16x16x32_bf16 v[84:87], v[56:59], v[124:127], v[84:87]
    ds_read_b64_tr_b16 v[40:41], v10 offset:9216
    v_mfma_f32_16x16x32_bf16 v[88:91], v[60:63], v[120:123], v[88:91]
    ds_read_b64_tr_b16 v[42:43], v10 offset:9360
    v_mfma_f32_16x16x32_bf16 v[92:95], v[60:63], v[124:127], v[92:95]
    ds_read_b64_tr_b16 v[44:45], v10 offset:9248
    v_mfma_f32_16x16x32_bf16 v[96:99], v[64:67], v[120:123], v[96:99]
    ds_read_b64_tr_b16 v[46:47], v10 offset:9392
    v_mfma_f32_16x16x32_bf16 v[100:103], v[64:67], v[124:127], v[100:103]
    ds_read_b64_tr_b16 v[48:49], v11 offset:0
    v_mfma_f32_16x16x32_bf16 v[104:107], v[68:71], v[120:123], v[104:107]
    ds_read_b64_tr_b16 v[50:51], v11 offset:144
    v_mfma_f32_16x16x32_bf16 v[108:111], v[68:71], v[124:127], v[108:111]
    s_waitcnt lgkmcnt(8)
    v_mfma_f32_16x16x32_bf16 v[72:75], v[32:35], v[112:115], v[72:75]
    ds_read_b128 v[120:123], v9 offset:32768
    ds_read_b128 v[124:127], v9 offset:34816
    v_mfma_f32_16x16x32_bf16 v[76:79], v[32:35], v[116:119], v[76:79]
    ds_read_b64_tr_b16 v[52:53], v10 offset:4608
    ds_read_b64_tr_b16 v[54:55], v10 offset:4752
    s_waitcnt lgkmcnt(10)
    v_mfma_f32_16x16x32_bf16 v[80:83], v[36:39], v[112:115], v[80:83]
    ds_read_b64_tr_b16 v[56:57], v10 offset:4640
    ds_read_b64_tr_b16 v[58:59], v10 offset:4784
    v_mfma_f32_16x16x32_bf16 v[84:87], v[36:39], v[116:119], v[84:87]
    ds_read_b64_tr_b16 v[60:61], v10 offset:13824
    s_waitcnt lgkmcnt(11)
    v_mfma_f32_16x16x32_bf16 v[88:91], v[40:43], v[112:115], v[88:91]
    ds_read_b64_tr_b16 v[62:63], v10 offset:13968
    v_mfma_f32_16x16x32_bf16 v[92:95], v[40:43], v[116:119], v[92:95]
    ds_read_b64_tr_b16 v[64:65], v10 offset:13856
    s_waitcnt lgkmcnt(11)
    v_mfma_f32_16x16x32_bf16 v[96:99], v[44:47], v[112:115], v[96:99]
    ds_read_b64_tr_b16 v[66:67], v10 offset:14000
    v_mfma_f32_16x16x32_bf16 v[100:103], v[44:47], v[116:119], v[100:103]
    ds_read_b64_tr_b16 v[68:69], v11 offset:4608
    s_waitcnt lgkmcnt(11)
    v_mfma_f32_16x16x32_bf16 v[104:107], v[48:51], v[112:115], v[104:107]
    ds_read_b64_tr_b16 v[70:71], v11 offset:4752
    v_mfma_f32_16x16x32_bf16 v[108:111], v[48:51], v[116:119], v[108:111]
    s_waitcnt vmcnt(4) lgkmcnt(0)
    s_barrier
    s_add_u32 s64, s89, 2
    s_sub_u32 s15, s64, 3
    s_cmp_ge_u32 s64, 3
    s_cselect_b32 s64, s15, s64
    s_add_u32 s64, s64, 3
    s_mul_i32 s64, s64, 128
    s_add_u32 m0, s69, 32768
    s_nop 0
    buffer_load_dwordx4 v3, s[44:47], s64 offen lds
    s_add_u32 m0, s69, 33792
    s_nop 0
    buffer_load_dwordx4 v4, s[44:47], s64 offen lds
    s_add_u32 s65, s64, 18432
    s_add_u32 m0, s69, 34816
    s_nop 0
    buffer_load_dwordx4 v3, s[44:47], s65 offen lds
    s_add_u32 m0, s69, 35840
    s_nop 0
    buffer_load_dwordx4 v4, s[44:47], s65 offen lds
    v_mfma_f32_16x16x32_bf16 v[72:75], v[52:55], v[120:123], v[72:75]
    ds_read_b128 v[112:115], v8 offset:0
    ds_read_b128 v[116:119], v8 offset:2048
    v_mfma_f32_16x16x32_bf16 v[76:79], v[52:55], v[124:127], v[76:79]
    ds_read_b64_tr_b16 v[32:33], v10 offset:18432
    ds_read_b64_tr_b16 v[34:35], v10 offset:18576
    v_mfma_f32_16x16x32_bf16 v[80:83], v[56:59], v[120:123], v[80:83]
    ds_read_b64_tr_b16 v[36:37], v10 offset:18464
    ds_read_b64_tr_b16 v[38:39], v10 offset:18608
    v_mfma_f32_16x16x32_bf16 v[84:87], v[56:59], v[124:127], v[84:87]
    ds_read_b64_tr_b16 v[40:41], v10 offset:27648
    v_mfma_f32_16x16x32_bf16 v[88:91], v[60:63], v[120:123], v[88:91]
    ds_read_b64_tr_b16 v[42:43], v10 offset:27792
    v_mfma_f32_16x16x32_bf16 v[92:95], v[60:63], v[124:127], v[92:95]
    ds_read_b64_tr_b16 v[44:45], v10 offset:27680
    v_mfma_f32_16x16x32_bf16 v[96:99], v[64:67], v[120:123], v[96:99]
    ds_read_b64_tr_b16 v[46:47], v10 offset:27824
    v_mfma_f32_16x16x32_bf16 v[100:103], v[64:67], v[124:127], v[100:103]
    ds_read_b64_tr_b16 v[48:49], v11 offset:18432
    v_mfma_f32_16x16x32_bf16 v[104:107], v[68:71], v[120:123], v[104:107]
    ds_read_b64_tr_b16 v[50:51], v11 offset:18576
    v_mfma_f32_16x16x32_bf16 v[108:111], v[68:71], v[124:127], v[108:111]
    s_waitcnt lgkmcnt(8)
    v_mfma_f32_16x16x32_bf16 v[72:75], v[32:35], v[112:115], v[72:75]
    ds_read_b128 v[120:123], v9 offset:0
    ds_read_b128 v[124:127], v9 offset:2048
    v_mfma_f32_16x16x32_bf16 v[76:79], v[32:35], v[116:119], v[76:79]
    ds_read_b64_tr_b16 v[52:53], v10 offset:23040
    ds_read_b64_tr_b16 v[54:55], v10 offset:23184
    s_waitcnt lgkmcnt(10)
    v_mfma_f32_16x16x32_bf16 v[80:83], v[36:39], v[112:115], v[80:83]
    ds_read_b64_tr_b16 v[56:57], v10 offset:23072
    ds_read_b64_tr_b16 v[58:59], v10 offset:23216
    v_mfma_f32_16x16x32_bf16 v[84:87], v[36:39], v[116:119], v[84:87]
    ds_read_b64_tr_b16 v[60:61], v10 offset:32256
    s_waitcnt lgkmcnt(11)
    v_mfma_f32_16x16x32_bf16 v[88:91], v[40:43], v[112:115], v[88:91]
    ds_read_b64_tr_b16 v[62:63], v10 offset:32400
    v_mfma_f32_16x16x32_bf16 v[92:95], v[40:43], v[116:119], v[92:95]
    ds_read_b64_tr_b16 v[64:65], v10 offset:32288
    s_waitcnt lgkmcnt(11)
    v_mfma_f32_16x16x32_bf16 v[96:99], v[44:47], v[112:115], v[96:99]
    ds_read_b64_tr_b16 v[66:67], v10 offset:32432
    v_mfma_f32_16x16x32_bf16 v[100:103], v[44:47], v[116:119], v[100:103]
    ds_read_b64_tr_b16 v[68:69], v11 offset:23040
    s_waitcnt lgkmcnt(11)
    v_mfma_f32_16x16x32_bf16 v[104:107], v[48:51], v[112:115], v[104:107]
    ds_read_b64_tr_b16 v[70:71], v11 offset:23184
    v_mfma_f32_16x16x32_bf16 v[108:111], v[48:51], v[116:119], v[108:111]
    s_waitcnt vmcnt(4) lgkmcnt(0)
    s_barrier
    s_add_u32 s64, s89, 0
    s_sub_u32 s15, s64, 3
    s_cmp_ge_u32 s64, 3
    s_cselect_b32 s64, s15, s64
    s_add_u32 s64, s64, 6
    s_mul_i32 s64, s64, 128
    s_add_u32 m0, s69, 0
    s_nop 0
    buffer_load_dwordx4 v3, s[44:47], s64 offen lds
    s_add_u32 m0, s69, 1024
    s_nop 0
    buffer_load_dwordx4 v4, s[44:47], s64 offen lds
    s_add_u32 s65, s64, 18432
    s_add_u32 m0, s69, 2048
    s_nop 0
    buffer_load_dwordx4 v3, s[44:47], s65 offen lds
    s_add_u32 m0, s69, 3072
    s_nop 0
    buffer_load_dwordx4 v4, s[44:47], s65 offen lds
    v_mfma_f32_16x16x32_bf16 v[72:75], v[52:55], v[120:123], v[72:75]
    ds_read_b128 v[112:115], v8 offset:16384
    ds_read_b128 v[116:119], v8 offset:18432
    v_mfma_f32_16x16x32_bf16 v[76:79], v[52:55], v[124:127], v[76:79]
    ds_read_b64_tr_b16 v[32:33], v10 offset:36864
    ds_read_b64_tr_b16 v[34:35], v10 offset:37008
    v_mfma_f32_16x16x32_bf16 v[80:83], v[56:59], v[120:123], v[80:83]
    ds_read_b64_tr_b16 v[36:37], v10 offset:36896
    ds_read_b64_tr_b16 v[38:39], v10 offset:37040
    v_mfma_f32_16x16x32_bf16 v[84:87], v[56:59], v[124:127], v[84:87]
    ds_read_b64_tr_b16 v[40:41], v10 offset:46080
    v_mfma_f32_16x16x32_bf16 v[88:91], v[60:63], v[120:123], v[88:91]
    ds_read_b64_tr_b16 v[42:43], v10 offset:46224
    v_mfma_f32_16x16x32_bf16 v[92:95], v[60:63], v[124:127], v[92:95]
    ds_read_b64_tr_b16 v[44:45], v10 offset:46112
    v_mfma_f32_16x16x32_bf16 v[96:99], v[64:67], v[120:123], v[96:99]
    ds_read_b64_tr_b16 v[46:47], v10 offset:46256
    v_mfma_f32_16x16x32_bf16 v[100:103], v[64:67], v[124:127], v[100:103]
    ds_read_b64_tr_b16 v[48:49], v11 offset:36864
    v_mfma_f32_16x16x32_bf16 v[104:107], v[68:71], v[120:123], v[104:107]
    ds_read_b64_tr_b16 v[50:51], v11 offset:37008
    v_mfma_f32_16x16x32_bf16 v[108:111], v[68:71], v[124:127], v[108:111]
    s_waitcnt lgkmcnt(8)
    v_mfma_f32_16x16x32_bf16 v[72:75], v[32:35], v[112:115], v[72:75]
    ds_read_b128 v[120:123], v9 offset:16384
    ds_read_b128 v[124:127], v9 offset:18432
    v_mfma_f32_16x16x32_bf16 v[76:79], v[32:35], v[116:119], v[76:79]
    ds_read_b64_tr_b16 v[52:53], v10 offset:41472
    ds_read_b64_tr_b16 v[54:55], v10 offset:41616
    s_waitcnt lgkmcnt(10)
    v_mfma_f32_16x16x32_bf16 v[80:83], v[36:39], v[112:115], v[80:83]
    ds_read_b64_tr_b16 v[56:57], v10 offset:41504
    ds_read_b64_tr_b16 v[58:59], v10 offset:41648
    v_mfma_f32_16x16x32_bf16 v[84:87], v[36:39], v[116:119], v[84:87]
    ds_read_b64_tr_b16 v[60:61], v10 offset:50688
    s_waitcnt lgkmcnt(11)
    v_mfma_f32_16x16x32_bf16 v[88:91], v[40:43], v[112:115], v[88:91]
    ds_read_b64_tr_b16 v[62:63], v10 offset:50832
    v_mfma_f32_16x16x32_bf16 v[92:95], v[40:43], v[116:119], v[92:95]
    ds_read_b64_tr_b16 v[64:65], v10 offset:50720
    s_waitcnt lgkmcnt(11)
    v_mfma_f32_16x16x32_bf16 v[96:99], v[44:47], v[112:115], v[96:99]
    ds_read_b64_tr_b16 v[66:67], v10 offset:50864
    v_mfma_f32_16x16x32_bf16 v[100:103], v[44:47], v[116:119], v[100:103]
    ds_read_b64_tr_b16 v[68:69], v11 offset:41472
    s_waitcnt lgkmcnt(11)
    v_mfma_f32_16x16x32_bf16 v[104:107], v[48:51], v[112:115], v[104:107]
    ds_read_b64_tr_b16 v[70:71], v11 offset:41616
    v_mfma_f32_16x16x32_bf16 v[108:111], v[48:51], v[116:119], v[108:111]
    s_waitcnt vmcnt(4) lgkmcnt(0)
    s_barrier
    s_add_u32 s64, s89, 1
    s_sub_u32 s15, s64, 3
    s_cmp_ge_u32 s64, 3
    s_cselect_b32 s64, s15, s64
    s_add_u32 s64, s64, 6
    s_mul_i32 s64, s64, 128
    s_add_u32 m0, s69, 16384
    s_nop 0
    buffer_load_dwordx4 v3, s[44:47], s64 offen lds
    s_add_u32 m0, s69, 17408
    s_nop 0
    buffer_load_dwordx4 v4, s[44:47], s64 offen lds
    s_add_u32 s65, s64, 18432
    s_add_u32 m0, s69, 18432
    s_nop 0
    buffer_load_dwordx4 v3, s[44:47], s65 offen lds
    s_add_u32 m0, s69, 19456
    s_nop 0
    buffer_load_dwordx4 v4, s[44:47], s65 offen lds
    v_mfma_f32_16x16x32_bf16 v[72:75], v[52:55], v[120:123], v[72:75]
    ds_read_b128 v[112:115], v8 offset:32768
    ds_read_b128 v[116:119], v8 offset:34816
    v_mfma_f32_16x16x32_bf16 v[76:79], v[52:55], v[124:127], v[76:79]
    ds_read_b64_tr_b16 v[32:33], v10 offset:0
    ds_read_b64_tr_b16 v[34:35], v10 offset:144
    v_mfma_f32_16x16x32_bf16 v[80:83], v[56:59], v[120:123], v[80:83]
    ds_read_b64_tr_b16 v[36:37], v10 offset:32
    ds_read_b64_tr_b16 v[38:39], v10 offset:176
    v_mfma_f32_16x16x32_bf16 v[84:87], v[56:59], v[124:127], v[84:87]
    ds_read_b64_tr_b16 v[40:41], v10 offset:9216
    v_mfma_f32_16x16x32_bf16 v[88:91], v[60:63], v[120:123], v[88:91]
    ds_read_b64_tr_b16 v[42:43], v10 offset:9360
    v_mfma_f32_16x16x32_bf16 v[92:95], v[60:63], v[124:127], v[92:95]
    ds_read_b64_tr_b16 v[44:45], v10 offset:9248
    v_mfma_f32_16x16x32_bf16 v[96:99], v[64:67], v[120:123], v[96:99]
    ds_read_b64_tr_b16 v[46:47], v10 offset:9392
    v_mfma_f32_16x16x32_bf16 v[100:103], v[64:67], v[124:127], v[100:103]
    ds_read_b64_tr_b16 v[48:49], v11 offset:0
    v_mfma_f32_16x16x32_bf16 v[104:107], v[68:71], v[120:123], v[104:107]
    ds_read_b64_tr_b16 v[50:51], v11 offset:144
    v_mfma_f32_16x16x32_bf16 v[108:111], v[68:71], v[124:127], v[108:111]
    s_waitcnt lgkmcnt(8)
    v_mfma_f32_16x16x32_bf16 v[72:75], v[32:35], v[112:115], v[72:75]
    ds_read_b128 v[120:123], v9 offset:32768
    ds_read_b128 v[124:127], v9 offset:34816
    v_mfma_f32_16x16x32_bf16 v[76:79], v[32:35], v[116:119], v[76:79]
    ds_read_b64_tr_b16 v[52:53], v10 offset:4608
    ds_read_b64_tr_b16 v[54:55], v10 offset:4752
    s_waitcnt lgkmcnt(10)
    v_mfma_f32_16x16x32_bf16 v[80:83], v[36:39], v[112:115], v[80:83]
    ds_read_b64_tr_b16 v[56:57], v10 offset:4640
    ds_read_b64_tr_b16 v[58:59], v10 offset:4784
    v_mfma_f32_16x16x32_bf16 v[84:87], v[36:39], v[116:119], v[84:87]
    ds_read_b64_tr_b16 v[60:61], v10 offset:13824
    s_waitcnt lgkmcnt(11)
    v_mfma_f32_16x16x32_bf16 v[88:91], v[40:43], v[112:115], v[88:91]
    ds_read_b64_tr_b16 v[62:63], v10 offset:13968
    v_mfma_f32_16x16x32_bf16 v[92:95], v[40:43], v[116:119], v[92:95]
    ds_read_b64_tr_b16 v[64:65], v10 offset:13856
    s_waitcnt lgkmcnt(11)
    v_mfma_f32_16x16x32_bf16 v[96:99], v[44:47], v[112:115], v[96:99]
    ds_read_b64_tr_b16 v[66:67], v10 offset:14000
    v_mfma_f32_16x16x32_bf16 v[100:103], v[44:47], v[116:119], v[100:103]
    ds_read_b64_tr_b16 v[68:69], v11 offset:4608
    s_waitcnt lgkmcnt(11)
    v_mfma_f32_16x16x32_bf16 v[104:107], v[48:51], v[112:115], v[104:107]
    ds_read_b64_tr_b16 v[70:71], v11 offset:4752
    v_mfma_f32_16x16x32_bf16 v[108:111], v[48:51], v[116:119], v[108:111]
    ds_read_b64_tr_b16 v[128:129], v12 offset:0
    ds_read_b64_tr_b16 v[130:131], v13 offset:0
    ds_read_b64_tr_b16 v[148:149], v14 offset:0
    ds_read_b64_tr_b16 v[158:159], v15 offset:0
    ds_read_b64_tr_b16 v[132:133], v12 offset:8
    ds_read_b64_tr_b16 v[134:135], v13 offset:8
    ds_read_b64_tr_b16 v[150:151], v14 offset:8
    ds_read_b64_tr_b16 v[160:161], v15 offset:8
    ds_read_b64_tr_b16 v[136:137], v12 offset:16
    ds_read_b64_tr_b16 v[138:139], v13 offset:16
    ds_read_b64_tr_b16 v[152:153], v14 offset:16
    ds_read_b64_tr_b16 v[162:163], v15 offset:16
    ds_read_b64_tr_b16 v[140:141], v12 offset:24
    ds_read_b64_tr_b16 v[142:143], v13 offset:24
    ds_read_b64_tr_b16 v[154:155], v14 offset:24
    ds_read_b64_tr_b16 v[164:165], v15 offset:24
    ds_read_b64_tr_b16 v[144:145], v12 offset:32
    ds_read_b64_tr_b16 v[146:147], v13 offset:32
    ds_read_b64_tr_b16 v[156:157], v14 offset:32
    ds_read_b64_tr_b16 v[166:167], v15 offset:32
    s_waitcnt vmcnt(4) lgkmcnt(0)
    s_barrier
    s_add_u32 s64, s89, 2
    s_sub_u32 s15, s64, 3
    s_cmp_ge_u32 s64, 3
    s_cselect_b32 s64, s15, s64
    s_add_u32 s64, s64, 6
    s_mul_i32 s64, s64, 128
    s_add_u32 m0, s69, 32768
    s_nop 0
    buffer_load_dwordx4 v3, s[44:47], s64 offen lds
    s_add_u32 m0, s69, 33792
    s_nop 0
    buffer_load_dwordx4 v4, s[44:47], s64 offen lds
    s_add_u32 s65, s64, 18432
    s_add_u32 m0, s69, 34816
    s_nop 0
    buffer_load_dwordx4 v3, s[44:47], s65 offen lds
    s_add_u32 m0, s69, 35840
    s_nop 0
    buffer_load_dwordx4 v4, s[44:47], s65 offen lds
    global_load_dword v18, v30, s[40:41] sc1
    v_mfma_f32_16x16x32_bf16 v[72:75], v[52:55], v[120:123], v[72:75]
    ds_read_b128 v[112:115], v8 offset:0
    ds_read_b128 v[116:119], v8 offset:2048
    v_mfma_f32_16x16x32_bf16 v[76:79], v[52:55], v[124:127], v[76:79]
    ds_read_b64_tr_b16 v[32:33], v10 offset:18432
    ds_read_b64_tr_b16 v[34:35], v10 offset:18576
    v_mfma_f32_16x16x32_bf16 v[80:83], v[56:59], v[120:123], v[80:83]
    ds_read_b64_tr_b16 v[36:37], v10 offset:18464
    ds_read_b64_tr_b16 v[38:39], v10 offset:18608
    v_mfma_f32_16x16x32_bf16 v[84:87], v[56:59], v[124:127], v[84:87]
    ds_read_b64_tr_b16 v[40:41], v10 offset:27648
    v_mfma_f32_16x16x32_bf16 v[88:91], v[60:63], v[120:123], v[88:91]
    ds_read_b64_tr_b16 v[42:43], v10 offset:27792
    v_mfma_f32_16x16x32_bf16 v[92:95], v[60:63], v[124:127], v[92:95]
    ds_read_b64_tr_b16 v[44:45], v10 offset:27680
    v_mfma_f32_16x16x32_bf16 v[96:99], v[64:67], v[120:123], v[96:99]
    ds_read_b64_tr_b16 v[46:47], v10 offset:27824
    v_mfma_f32_16x16x32_bf16 v[100:103], v[64:67], v[124:127], v[100:103]
    ds_read_b64_tr_b16 v[48:49], v11 offset:18432
    v_mfma_f32_16x16x32_bf16 v[104:107], v[68:71], v[120:123], v[104:107]
    ds_read_b64_tr_b16 v[50:51], v11 offset:18576
    v_mfma_f32_16x16x32_bf16 v[108:111], v[68:71], v[124:127], v[108:111]
    s_waitcnt lgkmcnt(8)
    v_mfma_f32_16x16x32_bf16 v[72:75], v[32:35], v[112:115], v[72:75]
    ds_read_b128 v[120:123], v9 offset:0
    ds_read_b128 v[124:127], v9 offset:2048
    v_mfma_f32_16x16x32_bf16 v[76:79], v[32:35], v[116:119], v[76:79]
    ds_read_b64_tr_b16 v[52:53], v10 offset:23040
    ds_read_b64_tr_b16 v[54:55], v10 offset:23184
    s_waitcnt lgkmcnt(10)
    v_mfma_f32_16x16x32_bf16 v[80:83], v[36:39], v[112:115], v[80:83]
    ds_read_b64_tr_b16 v[56:57], v10 offset:23072
    ds_read_b64_tr_b16 v[58:59], v10 offset:23216
    v_mfma_f32_16x16x32_bf16 v[84:87], v[36:39], v[116:119], v[84:87]
    ds_read_b64_tr_b16 v[60:61], v10 offset:32256
    s_waitcnt lgkmcnt(11)
    v_mfma_f32_16x16x32_bf16 v[88:91], v[40:43], v[112:115], v[88:91]
    ds_read_b64_tr_b16 v[62:63], v10 offset:32400
    v_mfma_f32_16x16x32_bf16 v[92:95], v[40:43], v[116:119], v[92:95]
    ds_read_b64_tr_b16 v[64:65], v10 offset:32288
    s_waitcnt lgkmcnt(11)
    v_mfma_f32_16x16x32_bf16 v[96:99], v[44:47], v[112:115], v[96:99]
    ds_read_b64_tr_b16 v[66:67], v10 offset:32432
    v_mfma_f32_16x16x32_bf16 v[100:103], v[44:47], v[116:119], v[100:103]
    ds_read_b64_tr_b16 v[68:69], v11 offset:23040
    s_waitcnt lgkmcnt(11)
    v_mfma_f32_16x16x32_bf16 v[104:107], v[48:51], v[112:115], v[104:107]
    ds_read_b64_tr_b16 v[70:71], v11 offset:23184
    v_mfma_f32_16x16x32_bf16 v[108:111], v[48:51], v[116:119], v[108:111]
    s_waitcnt vmcnt(5) lgkmcnt(0)
    s_barrier
    v_mfma_f32_16x16x32_bf16 v[72:75], v[52:55], v[120:123], v[72:75]
    ds_read_b128 v[112:115], v8 offset:16384
    ds_read_b128 v[116:119], v8 offset:18432
    v_mfma_f32_16x16x32_bf16 v[76:79], v[52:55], v[124:127], v[76:79]
    ds_read_b64_tr_b16 v[32:33], v10 offset:36864
    ds_read_b64_tr_b16 v[34:35], v10 offset:37008
    v_mfma_f32_16x16x32_bf16 v[80:83], v[56:59], v[120:123], v[80:83]
    ds_read_b64_tr_b16 v[36:37], v10 offset:36896
    ds_read_b64_tr_b16 v[38:39], v10 offset:37040
    v_mfma_f32_16x16x32_bf16 v[84:87], v[56:59], v[124:127], v[84:87]
    ds_read_b64_tr_b16 v[40:41], v10 offset:46080
    v_mfma_f32_16x16x32_bf16 v[88:91], v[60:63], v[120:123], v[88:91]
    ds_read_b64_tr_b16 v[42:43], v10 offset:46224
    v_mfma_f32_16x16x32_bf16 v[92:95], v[60:63], v[124:127], v[92:95]
    ds_read_b64_tr_b16 v[44:45], v10 offset:46112
    v_mfma_f32_16x16x32_bf16 v[96:99], v[64:67], v[120:123], v[96:99]
    ds_read_b64_tr_b16 v[46:47], v10 offset:46256
    v_mfma_f32_16x16x32_bf16 v[100:103], v[64:67], v[124:127], v[100:103]
    ds_read_b64_tr_b16 v[48:49], v11 offset:36864
    v_mfma_f32_16x16x32_bf16 v[104:107], v[68:71], v[120:123], v[104:107]
    ds_read_b64_tr_b16 v[50:51], v11 offset:37008
    v_mfma_f32_16x16x32_bf16 v[108:111], v[68:71], v[124:127], v[108:111]
    s_waitcnt lgkmcnt(8)
    v_mfma_f32_16x16x32_bf16 v[72:75], v[32:35], v[112:115], v[72:75]
    ds_read_b128 v[120:123], v9 offset:16384
    ds_read_b128 v[124:127], v9 offset:18432
    v_mfma_f32_16x16x32_bf16 v[76:79], v[32:35], v[116:119], v[76:79]
    ds_read_b64_tr_b16 v[52:53], v10 offset:41472
    ds_read_b64_tr_b16 v[54:55], v10 offset:41616
    s_waitcnt lgkmcnt(10)
    v_mfma_f32_16x16x32_bf16 v[80:83], v[36:39], v[112:115], v[80:83]
    ds_read_b64_tr_b16 v[56:57], v10 offset:41504
    ds_read_b64_tr_b16 v[58:59], v10 offset:41648
    v_mfma_f32_16x16x32_bf16 v[84:87], v[36:39], v[116:119], v[84:87]
    ds_read_b64_tr_b16 v[60:61], v10 offset:50688
    s_waitcnt lgkmcnt(11)
    v_mfma_f32_16x16x32_bf16 v[88:91], v[40:43], v[112:115], v[88:91]
    ds_read_b64_tr_b16 v[62:63], v10 offset:50832
    v_mfma_f32_16x16x32_bf16 v[92:95], v[40:43], v[116:119], v[92:95]
    ds_read_b64_tr_b16 v[64:65], v10 offset:50720
    s_waitcnt lgkmcnt(11)
    v_mfma_f32_16x16x32_bf16 v[96:99], v[44:47], v[112:115], v[96:99]
    ds_read_b64_tr_b16 v[66:67], v10 offset:50864
    v_mfma_f32_16x16x32_bf16 v[100:103], v[44:47], v[116:119], v[100:103]
    ds_read_b64_tr_b16 v[68:69], v11 offset:41472
    s_waitcnt lgkmcnt(11)
    v_mfma_f32_16x16x32_bf16 v[104:107], v[48:51], v[112:115], v[104:107]
    ds_read_b64_tr_b16 v[70:71], v11 offset:41616
    v_mfma_f32_16x16x32_bf16 v[108:111], v[48:51], v[116:119], v[108:111]
    s_waitcnt vmcnt(1) lgkmcnt(0)
    s_barrier
    v_mfma_f32_16x16x32_bf16 v[72:75], v[52:55], v[120:123], v[72:75]
    ds_read_b128 v[112:115], v8 offset:32768
    ds_read_b128 v[116:119], v8 offset:34816
    v_mfma_f32_16x16x32_bf16 v[76:79], v[52:55], v[124:127], v[76:79]
    ds_read_b64_tr_b16 v[32:33], v10 offset:0
    ds_read_b64_tr_b16 v[34:35], v10 offset:144
    v_mfma_f32_16x16x32_bf16 v[80:83], v[56:59], v[120:123], v[80:83]
    ds_read_b64_tr_b16 v[36:37], v10 offset:32
    ds_read_b64_tr_b16 v[38:39], v10 offset:176
    v_mfma_f32_16x16x32_bf16 v[84:87], v[56:59], v[124:127], v[84:87]
    ds_read_b64_tr_b16 v[40:41], v10 offset:9216
    v_mfma_f32_16x16x32_bf16 v[88:91], v[60:63], v[120:123], v[88:91]
    ds_read_b64_tr_b16 v[42:43], v10 offset:9360
    v_mfma_f32_16x16x32_bf16 v[92:95], v[60:63], v[124:127], v[92:95]
    ds_read_b64_tr_b16 v[44:45], v10 offset:9248
    v_mfma_f32_16x16x32_bf16 v[96:99], v[64:67], v[120:123], v[96:99]
    ds_read_b64_tr_b16 v[46:47], v10 offset:9392
    v_mfma_f32_16x16x32_bf16 v[100:103], v[64:67], v[124:127], v[100:103]
    ds_read_b64_tr_b16 v[48:49], v11 offset:0
    v_mfma_f32_16x16x32_bf16 v[104:107], v[68:71], v[120:123], v[104:107]
    ds_read_b64_tr_b16 v[50:51], v11 offset:144
    v_mfma_f32_16x16x32_bf16 v[108:111], v[68:71], v[124:127], v[108:111]
    s_waitcnt lgkmcnt(8)
    v_mfma_f32_16x16x32_bf16 v[72:75], v[32:35], v[112:115], v[72:75]
    ds_read_b128 v[120:123], v9 offset:32768
    ds_read_b128 v[124:127], v9 offset:34816
    v_mfma_f32_16x16x32_bf16 v[76:79], v[32:35], v[116:119], v[76:79]
    ds_read_b64_tr_b16 v[52:53], v10 offset:4608
    ds_read_b64_tr_b16 v[54:55], v10 offset:4752
    s_waitcnt lgkmcnt(10)
    v_mfma_f32_16x16x32_bf16 v[80:83], v[36:39], v[112:115], v[80:83]
    ds_read_b64_tr_b16 v[56:57], v10 offset:4640
    ds_read_b64_tr_b16 v[58:59], v10 offset:4784
    v_mfma_f32_16x16x32_bf16 v[84:87], v[36:39], v[116:119], v[84:87]
    ds_read_b64_tr_b16 v[60:61], v10 offset:13824
    s_waitcnt lgkmcnt(11)
    v_mfma_f32_16x16x32_bf16 v[88:91], v[40:43], v[112:115], v[88:91]
    ds_read_b64_tr_b16 v[62:63], v10 offset:13968
    v_mfma_f32_16x16x32_bf16 v[92:95], v[40:43], v[116:119], v[92:95]
    ds_read_b64_tr_b16 v[64:65], v10 offset:13856
    s_waitcnt lgkmcnt(11)
    v_mfma_f32_16x16x32_bf16 v[96:99], v[44:47], v[112:115], v[96:99]
    ds_read_b64_tr_b16 v[66:67], v10 offset:14000
    v_mfma_f32_16x16x32_bf16 v[100:103], v[44:47], v[116:119], v[100:103]
    ds_read_b64_tr_b16 v[68:69], v11 offset:4608
    s_waitcnt lgkmcnt(11)
    v_mfma_f32_16x16x32_bf16 v[104:107], v[48:51], v[112:115], v[104:107]
    ds_read_b64_tr_b16 v[70:71], v11 offset:4752
    v_mfma_f32_16x16x32_bf16 v[108:111], v[48:51], v[116:119], v[108:111]
    s_waitcnt lgkmcnt(8)
    v_mfma_f32_16x16x32_bf16 v[72:75], v[52:55], v[120:123], v[72:75]
    v_mfma_f32_16x16x32_bf16 v[76:79], v[52:55], v[124:127], v[76:79]
    s_waitcnt lgkmcnt(6)
    v_mfma_f32_16x16x32_bf16 v[80:83], v[56:59], v[120:123], v[80:83]
    v_mfma_f32_16x16x32_bf16 v[84:87], v[56:59], v[124:127], v[84:87]
    s_waitcnt lgkmcnt(4)
    v_mfma_f32_16x16x32_bf16 v[88:91], v[60:63], v[120:123], v[88:91]
    v_mfma_f32_16x16x32_bf16 v[92:95], v[60:63], v[124:127], v[92:95]
    s_waitcnt lgkmcnt(2)
    v_mfma_f32_16x16x32_bf16 v[96:99], v[64:67], v[120:123], v[96:99]
    v_mfma_f32_16x16x32_bf16 v[100:103], v[64:67], v[124:127], v[100:103]
    s_waitcnt lgkmcnt(0)
    v_mfma_f32_16x16x32_bf16 v[104:107], v[68:71], v[120:123], v[104:107]
    v_mfma_f32_16x16x32_bf16 v[108:111], v[68:71], v[124:127], v[108:111]
B_join:
    s_barrier
    v_cmp_eq_u32 vcc, 0, v19
    v_mov_b32 v4, 0x3f80
    v_mov_b32 v252, -1
    v_mov_b32 v253, -1
    v_mov_b32 v254, -1
    v_mov_b32 v255, -1
    v_cvt_pk_bf16_f32 v72, v72, v73
    v_cvt_pk_bf16_f32 v73, v74, v75
    v_cvt_pk_bf16_f32 v74, v80, v81
    v_cvt_pk_bf16_f32 v75, v82, v83
    v_cvt_pk_bf16_f32 v104, v104, v105
    v_cvt_pk_bf16_f32 v105, v106, v107
    v_cvt_pk_bf16_f32 v88, v88, v89
    v_cvt_pk_bf16_f32 v89, v90, v91
    v_cvt_pk_bf16_f32 v90, v96, v97
    v_cvt_pk_bf16_f32 v91, v98, v99
    v_cvt_pk_bf16_f32 v76, v76, v77
    v_cvt_pk_bf16_f32 v77, v78, v79
    v_cvt_pk_bf16_f32 v78, v84, v85
    v_cvt_pk_bf16_f32 v79, v86, v87
    v_cvt_pk_bf16_f32 v108, v108, v109
    v_cvt_pk_bf16_f32 v109, v110, v111
    v_cvt_pk_bf16_f32 v92, v92, v93
    v_cvt_pk_bf16_f32 v93, v94, v95
    v_cvt_pk_bf16_f32 v94, v100, v101
    v_cvt_pk_bf16_f32 v95, v102, v103
    v_mfma_f32_16x16x32_bf16 v[32:35], v[128:131], v[72:75], 0
    ds_write_b64 v201, v[88:89] offset:0
    v_mfma_f32_16x16x32_bf16 v[36:39], v[132:135], v[72:75], 0
    v_cndmask_b32 v106, v104, v90, vcc
    v_mfma_f32_16x16x32_bf16 v[40:43], v[136:139], v[72:75], 0
    v_cndmask_b32 v107, v105, v4, vcc
    v_mfma_f32_16x16x32_bf16 v[44:47], v[140:143], v[72:75], 0
    v_cndmask_b32 v90, v90, v4, vcc
    v_mfma_f32_16x16x32_bf16 v[48:51], v[144:147], v[72:75], 0
    ds_write_b64 v202, v[106:107] offset:0
    v_mfma_f32_16x16x16_bf16 v[32:35], v[148:149], v[104:105], v[32:35]
    ds_write_b64 v201, v[90:91] offset:40
    v_mfma_f32_16x16x16_bf16 v[36:39], v[150:151], v[104:105], v[36:39]
    ds_write_b64 v201, v[92:93] offset:1408
    v_mfma_f32_16x16x16_bf16 v[40:43], v[152:153], v[104:105], v[40:43]
    v_cndmask_b32 v110, v108, v94, vcc
    v_mfma_f32_16x16x16_bf16 v[44:47], v[154:155], v[104:105], v[44:47]
    v_cndmask_b32 v111, v109, v4, vcc
    v_mfma_f32_16x16x16_bf16 v[48:51], v[156:157], v[104:105], v[48:51]
    v_cndmask_b32 v94, v94, v4, vcc
    v_mfma_f32_16x16x32_bf16 v[52:55], v[128:131], v[76:79], 0
    ds_write_b64 v202, v[110:111] offset:1408
    v_mfma_f32_16x16x32_bf16 v[56:59], v[132:135], v[76:79], 0
    ds_write_b64 v201, v[94:95] offset:1448
    v_mfma_f32_16x16x32_bf16 v[60:63], v[136:139], v[76:79], 0
    buffer_store_dwordx2 v[252:253], v207, s[52:55], 0 offen sc1
    v_mfma_f32_16x16x32_bf16 v[64:67], v[140:143], v[76:79], 0
    buffer_store_dwordx2 v[252:253], v208, s[52:55], 0 offen sc1
    v_mfma_f32_16x16x32_bf16 v[68:71], v[144:147], v[76:79], 0
    buffer_store_dwordx2 v[252:253], v209, s[52:55], 0 offen sc1
    v_mfma_f32_16x16x16_bf16 v[52:55], v[148:149], v[108:109], v[52:55]
    buffer_store_dwordx2 v[252:253], v210, s[52:55], 0 offen sc1
    v_mfma_f32_16x16x16_bf16 v[56:59], v[150:151], v[108:109], v[56:59]
    v_mfma_f32_16x16x16_bf16 v[60:63], v[152:153], v[108:109], v[60:63]
    v_mfma_f32_16x16x16_bf16 v[64:67], v[154:155], v[108:109], v[64:67]
    v_mfma_f32_16x16x16_bf16 v[68:71], v[156:157], v[108:109], v[68:71]
    v_max3_f32 v26, v32, v33, v34
    v_max3_f32 v26, v26, v35, v36
    v_max3_f32 v26, v26, v37, v38
    v_max3_f32 v26, v26, v39, v40
    v_max3_f32 v26, v26, v41, v42
    v_max3_f32 v26, v26, v43, v44
    v_max3_f32 v26, v26, v45, v46
    v_max3_f32 v26, v26, v47, v48
    v_max_f32 v26, v26, v49
    v_mul_f32 v26, 0xbfb8aa3b, v26
    v_pk_fma_f32 v[32:33], v[32:33], s[72:73], v[26:27] op_sel_hi:[1,1,0]
    v_pk_fma_f32 v[34:35], v[34:35], s[72:73], v[26:27] op_sel_hi:[1,1,0]
    v_pk_fma_f32 v[36:37], v[36:37], s[72:73], v[26:27] op_sel_hi:[1,1,0]
    v_pk_fma_f32 v[38:39], v[38:39], s[72:73], v[26:27] op_sel_hi:[1,1,0]
    v_pk_fma_f32 v[40:41], v[40:41], s[72:73], v[26:27] op_sel_hi:[1,1,0]
    v_pk_fma_f32 v[42:43], v[42:43], s[72:73], v[26:27] op_sel_hi:[1,1,0]
    v_pk_fma_f32 v[44:45], v[44:45], s[72:73], v[26:27] op_sel_hi:[1,1,0]
    v_pk_fma_f32 v[46:47], v[46:47], s[72:73], v[26:27] op_sel_hi:[1,1,0]
    v_pk_fma_f32 v[48:49], v[48:49], s[72:73], v[26:27] op_sel_hi:[1,1,0]
    v_exp_f32 v32, v32
    v_exp_f32 v33, v33
    v_exp_f32 v34, v34
    v_exp_f32 v35, v35
    v_exp_f32 v36, v36
    v_exp_f32 v37, v37
    v_exp_f32 v38, v38
    v_exp_f32 v39, v39
    v_exp_f32 v40, v40
    v_exp_f32 v41, v41
    v_exp_f32 v42, v42
    v_exp_f32 v43, v43
    v_exp_f32 v44, v44
    v_exp_f32 v45, v45
    v_exp_f32 v46, v46
    v_exp_f32 v47, v47
    v_exp_f32 v48, v48
    v_exp_f32 v49, v49
    v_pk_add_f32 v[20:21], v[32:33], v[34:35]
    v_pk_add_f32 v[20:21], v[20:21], v[36:37]
    v_pk_add_f32 v[20:21], v[20:21], v[38:39]
    v_pk_add_f32 v[20:21], v[20:21], v[40:41]
    v_pk_add_f32 v[20:21], v[20:21], v[42:43]
    v_pk_add_f32 v[20:21], v[20:21], v[44:45]
    v_pk_add_f32 v[20:21], v[20:21], v[46:47]
    v_pk_add_f32 v[20:21], v[20:21], v[48:49]
    v_add_f32 v20, v20, v21
    v_rcp_f32 v20, v20
    s_nop 0
    v_pk_mul_f32 v[32:33], v[32:33], v[20:21] op_sel_hi:[1,0]
    v_pk_mul_f32 v[34:35], v[34:35], v[20:21] op_sel_hi:[1,0]
    v_pk_mul_f32 v[36:37], v[36:37], v[20:21] op_sel_hi:[1,0]
    v_pk_mul_f32 v[38:39], v[38:39], v[20:21] op_sel_hi:[1,0]
    v_pk_mul_f32 v[40:41], v[40:41], v[20:21] op_sel_hi:[1,0]
    v_pk_mul_f32 v[42:43], v[42:43], v[20:21] op_sel_hi:[1,0]
    v_pk_mul_f32 v[44:45], v[44:45], v[20:21] op_sel_hi:[1,0]
    v_pk_mul_f32 v[46:47], v[46:47], v[20:21] op_sel_hi:[1,0]
    v_pk_mul_f32 v[48:49], v[48:49], v[20:21] op_sel_hi:[1,0]
    v_cvt_pk_bf16_f32 v32, v32, v33
    v_cvt_pk_bf16_f32 v33, v34, v35
    v_cvt_pk_bf16_f32 v36, v36, v37
    v_cvt_pk_bf16_f32 v37, v38, v39
    v_cvt_pk_bf16_f32 v40, v40, v41
    v_cvt_pk_bf16_f32 v41, v42, v43
    v_cvt_pk_bf16_f32 v44, v44, v45
    v_cvt_pk_bf16_f32 v45, v46, v47
    v_cvt_pk_bf16_f32 v48, v48, v49
    v_mov_b32 v49, 0
    ds_write_b64 v200, v[32:33] offset:0
    ds_write_b64 v200, v[36:37] offset:8
    ds_write_b64 v200, v[40:41] offset:16
    ds_write_b64 v200, v[44:45] offset:24
    ds_write_b64 v200, v[48:49] offset:32
    v_max3_f32 v26, v52, v53, v54
    v_max3_f32 v26, v26, v55, v56
    v_max3_f32 v26, v26, v57, v58
    v_max3_f32 v26, v26, v59, v60
    v_max3_f32 v26, v26, v61, v62
    v_max3_f32 v26, v26, v63, v64
    v_max3_f32 v26, v26, v65, v66
    v_max3_f32 v26, v26, v67, v68
    v_max_f32 v26, v26, v69
    v_mul_f32 v26, 0xbfb8aa3b, v26
    v_pk_fma_f32 v[52:53], v[52:53], s[72:73], v[26:27] op_sel_hi:[1,1,0]
    v_pk_fma_f32 v[54:55], v[54:55], s[72:73], v[26:27] op_sel_hi:[1,1,0]
    v_pk_fma_f32 v[56:57], v[56:57], s[72:73], v[26:27] op_sel_hi:[1,1,0]
    v_pk_fma_f32 v[58:59], v[58:59], s[72:73], v[26:27] op_sel_hi:[1,1,0]
    v_pk_fma_f32 v[60:61], v[60:61], s[72:73], v[26:27] op_sel_hi:[1,1,0]
    v_pk_fma_f32 v[62:63], v[62:63], s[72:73], v[26:27] op_sel_hi:[1,1,0]
    v_pk_fma_f32 v[64:65], v[64:65], s[72:73], v[26:27] op_sel_hi:[1,1,0]
    v_pk_fma_f32 v[66:67], v[66:67], s[72:73], v[26:27] op_sel_hi:[1,1,0]
    v_pk_fma_f32 v[68:69], v[68:69], s[72:73], v[26:27] op_sel_hi:[1,1,0]
    v_exp_f32 v52, v52
    v_exp_f32 v53, v53
    v_exp_f32 v54, v54
    v_exp_f32 v55, v55
    v_exp_f32 v56, v56
    v_exp_f32 v57, v57
    v_exp_f32 v58, v58
    v_exp_f32 v59, v59
    v_exp_f32 v60, v60
    v_exp_f32 v61, v61
    v_exp_f32 v62, v62
    v_exp_f32 v63, v63
    v_exp_f32 v64, v64
    v_exp_f32 v65, v65
    v_exp_f32 v66, v66
    v_exp_f32 v67, v67
    v_exp_f32 v68, v68
    v_exp_f32 v69, v69
    v_pk_add_f32 v[20:21], v[52:53], v[54:55]
    v_pk_add_f32 v[20:21], v[20:21], v[56:57]
    v_pk_add_f32 v[20:21], v[20:21], v[58:59]
    v_pk_add_f32 v[20:21], v[20:21], v[60:61]
    v_pk_add_f32 v[20:21], v[20:21], v[62:63]
    v_pk_add_f32 v[20:21], v[20:21], v[64:65]
    v_pk_add_f32 v[20:21], v[20:21], v[66:67]
    v_pk_add_f32 v[20:21], v[20:21], v[68:69]
    v_add_f32 v20, v20, v21
    v_rcp_f32 v20, v20
    s_nop 0
    v_pk_mul_f32 v[52:53], v[52:53], v[20:21] op_sel_hi:[1,0]
    v_pk_mul_f32 v[54:55], v[54:55], v[20:21] op_sel_hi:[1,0]
    v_pk_mul_f32 v[56:57], v[56:57], v[20:21] op_sel_hi:[1,0]
    v_pk_mul_f32 v[58:59], v[58:59], v[20:21] op_sel_hi:[1,0]
    v_pk_mul_f32 v[60:61], v[60:61], v[20:21] op_sel_hi:[1,0]
    v_pk_mul_f32 v[62:63], v[62:63], v[20:21] op_sel_hi:[1,0]
    v_pk_mul_f32 v[64:65], v[64:65], v[20:21] op_sel_hi:[1,0]
    v_pk_mul_f32 v[66:67], v[66:67], v[20:21] op_sel_hi:[1,0]
    v_pk_mul_f32 v[68:69], v[68:69], v[20:21] op_sel_hi:[1,0]
    v_cvt_pk_bf16_f32 v52, v52, v53
    v_cvt_pk_bf16_f32 v53, v54, v55
    v_cvt_pk_bf16_f32 v56, v56, v57
    v_cvt_pk_bf16_f32 v57, v58, v59
    v_cvt_pk_bf16_f32 v60, v60, v61
    v_cvt_pk_bf16_f32 v61, v62, v63
    v_cvt_pk_bf16_f32 v64, v64, v65
    v_cvt_pk_bf16_f32 v65, v66, v67
    v_cvt_pk_bf16_f32 v68, v68, v69
    v_mov_b32 v69, 0
    ds_write_b64 v200, v[52:53] offset:2688
    ds_write_b64 v200, v[56:57] offset:2696
    ds_write_b64 v200, v[60:61] offset:2704
    ds_write_b64 v200, v[64:65] offset:2712
    ds_write_b64 v200, v[68:69] offset:2720
    s_waitcnt vmcnt(0)
    s_movk_i32 s77, 20000
    v_readfirstlane_b32 s9, v18
    s_nop 0
    s_cmp_lg_u32 s9, 0
    s_cbranch_scc1 B_nonce_ok
B_nonce_poll:
    s_sleep 1
    global_load_dword v18, v30, s[40:41] sc1
    s_waitcnt vmcnt(0)
    v_readfirstlane_b32 s9, v18
    s_sub_u32 s77, s77, 1
    s_cbranch_scc1 B_nonce_ok
    s_cmp_eq_u32 s9, 0
    s_cbranch_scc1 B_nonce_poll

B_nonce_ok:
    s_mov_b64 s[64:65], exec
    s_branch B_qx
    v_cmp_ne_u32 vcc, s9, v29
    s_nop 0
    s_mov_b64 s[64:65], vcc
    s_cbranch_vccnz B_qlate
    s_movk_i32 s74, 18432
    buffer_load_dwordx4 v[168:171], v231, s[52:55], 0 offen sc1
    buffer_load_dwordx2 v[172:173], v232, s[52:55], 0 offen sc1
    buffer_load_dwordx4 v[176:179], v231, s[52:55], s74 offen sc1
    buffer_load_dwordx2 v[180:181], v232, s[52:55], s74 offen sc1
    s_branch B_qx
B_qlate:
    buffer_load_dword v29, v233, s[52:55], 0 offen sc1
B_qx:
    s_waitcnt lgkmcnt(0)
    s_barrier
    v_mov_b32 v17, s9
    s_cmp_lg_u32 s6, 7
    s_cbranch_scc1 B_nofl
    s_mov_b64 exec, 1
    buffer_store_dword v17, v211, s[52:55], 0 offen sc1
    s_mov_b64 exec, -1

B_nofl:
    buffer_load_dword v29, v233, s[52:55], 0 offen sc1
    ds_read_b64_tr_b16 v[32:33], v205 offset:0
    ds_read_b64_tr_b16 v[34:35], v205 offset:88
    ds_read_b64_tr_b16 v[36:37], v203 offset:0
    ds_read_b64_tr_b16 v[38:39], v203 offset:168
    ds_read_b64_tr_b16 v[40:41], v206 offset:0
    ds_read_b64_tr_b16 v[42:43], v206 offset:88
    ds_read_b64_tr_b16 v[44:45], v204 offset:0
    ds_read_b64_tr_b16 v[46:47], v204 offset:168
    ds_read_b64_tr_b16 v[48:49], v205 offset:2816
    ds_read_b64_tr_b16 v[50:51], v205 offset:2904
    ds_read_b64_tr_b16 v[52:53], v203 offset:5376
    ds_read_b64_tr_b16 v[54:55], v203 offset:5544
    ds_read_b64_tr_b16 v[56:57], v206 offset:2816
    ds_read_b64_tr_b16 v[58:59], v206 offset:2904
    ds_read_b64_tr_b16 v[60:61], v204 offset:5376
    ds_read_b64_tr_b16 v[62:63], v204 offset:5544
    s_waitcnt lgkmcnt(8)
    v_mfma_f32_16x16x32_bf16 v[96:99], v[32:35], v[36:39], 0
    v_mfma_f32_16x16x32_bf16 v[100:103], v[40:43], v[36:39], 0
    v_mfma_f32_16x16x32_bf16 v[104:107], v[32:35], v[44:47], 0
    v_mfma_f32_16x16x32_bf16 v[108:111], v[40:43], v[44:47], 0
    ds_read_b64_tr_b16 v[64:65], v205 offset:5632
    ds_read_b64_tr_b16 v[66:67], v205 offset:5720
    ds_read_b64_tr_b16 v[68:69], v203 offset:10752
    ds_read_b64_tr_b16 v[70:71], v203 offset:10920
    ds_read_b64_tr_b16 v[72:73], v206 offset:5632
    ds_read_b64_tr_b16 v[74:75], v206 offset:5720
    ds_read_b64_tr_b16 v[76:77], v204 offset:10752
    ds_read_b64_tr_b16 v[78:79], v204 offset:10920
    s_waitcnt lgkmcnt(8)
    v_mfma_f32_16x16x32_bf16 v[96:99], v[48:51], v[52:55], v[96:99]
    v_mfma_f32_16x16x32_bf16 v[100:103], v[56:59], v[52:55], v[100:103]
    v_mfma_f32_16x16x32_bf16 v[104:107], v[48:51], v[60:63], v[104:107]
    v_mfma_f32_16x16x32_bf16 v[108:111], v[56:59], v[60:63], v[108:111]
    ds_read_b64_tr_b16 v[80:81], v205 offset:8448
    ds_read_b64_tr_b16 v[82:83], v205 offset:8536
    ds_read_b64_tr_b16 v[84:85], v203 offset:16128
    ds_read_b64_tr_b16 v[86:87], v203 offset:16296
    ds_read_b64_tr_b16 v[88:89], v206 offset:8448
    ds_read_b64_tr_b16 v[90:91], v206 offset:8536
    ds_read_b64_tr_b16 v[92:93], v204 offset:16128
    ds_read_b64_tr_b16 v[94:95], v204 offset:16296
    s_waitcnt lgkmcnt(8)
    v_mfma_f32_16x16x32_bf16 v[96:99], v[64:67], v[68:71], v[96:99]
    v_mfma_f32_16x16x32_bf16 v[100:103], v[72:75], v[68:71], v[100:103]
    v_mfma_f32_16x16x32_bf16 v[104:107], v[64:67], v[76:79], v[104:107]
    v_mfma_f32_16x16x32_bf16 v[108:111], v[72:75], v[76:79], v[108:111]
    s_waitcnt lgkmcnt(0)
    v_mfma_f32_16x16x32_bf16 v[96:99], v[80:83], v[84:87], v[96:99]
    v_mfma_f32_16x16x32_bf16 v[100:103], v[88:91], v[84:87], v[100:103]
    v_mfma_f32_16x16x32_bf16 v[104:107], v[80:83], v[92:95], v[104:107]
    v_mfma_f32_16x16x32_bf16 v[108:111], v[88:91], v[92:95], v[108:111]
    s_cmp_eq_u64 s[64:65], 0
    s_nop 2
    s_cbranch_scc1 B_q2
    s_waitcnt vmcnt(0)
    v_cmp_ne_u32 vcc, s9, v29
    s_nop 0
    s_mov_b64 s[64:65], vcc
    s_cbranch_vccnz B_q2
    s_movk_i32 s74, 18432
    buffer_load_dwordx4 v[168:171], v231, s[52:55], 0 offen sc1
    buffer_load_dwordx2 v[172:173], v232, s[52:55], 0 offen sc1
    buffer_load_dwordx4 v[176:179], v231, s[52:55], s74 offen sc1
    buffer_load_dwordx2 v[180:181], v232, s[52:55], s74 offen sc1
B_q2:
    v_cvt_pk_bf16_f32 v96, v96, v97
    v_cvt_pk_bf16_f32 v97, v98, v99
    buffer_store_dwordx2 v[96:97], v207, s[52:55], 0 offen sc1
    v_cvt_pk_bf16_f32 v100, v100, v101
    v_cvt_pk_bf16_f32 v101, v102, v103
    buffer_store_dwordx2 v[100:101], v208, s[52:55], 0 offen sc1
    v_cvt_pk_bf16_f32 v104, v104, v105
    v_cvt_pk_bf16_f32 v105, v106, v107
    buffer_store_dwordx2 v[104:105], v209, s[52:55], 0 offen sc1
    v_cvt_pk_bf16_f32 v108, v108, v109
    v_cvt_pk_bf16_f32 v109, v110, v111
    buffer_store_dwordx2 v[108:109], v210, s[52:55], 0 offen sc1
    ds_read_b64_tr_b16 v[128:129], v234 offset:0
    ds_read_b64_tr_b16 v[130:131], v235 offset:0
    ds_read_b64_tr_b16 v[132:133], v234 offset:8
    ds_read_b64_tr_b16 v[134:135], v235 offset:8
    ds_read_b64_tr_b16 v[136:137], v234 offset:16
    ds_read_b64_tr_b16 v[138:139], v235 offset:16
    ds_read_b64_tr_b16 v[140:141], v234 offset:24
    ds_read_b64_tr_b16 v[142:143], v235 offset:24
    ds_read_b64_tr_b16 v[144:145], v234 offset:32
    ds_read_b64_tr_b16 v[146:147], v235 offset:32
    s_cmp_eq_u64 s[64:65], 0
    s_cbranch_scc1 B_qhave
    s_movk_i32 s77, 30000
B_q_poll:
    buffer_load_dword v29, v233, s[52:55], 0 offen sc1
    s_waitcnt vmcnt(0)
    v_cmp_ne_u32 vcc, s9, v29
    s_cbranch_vccz B_q_done

    s_sleep 2
    s_sub_u32 s77, s77, 1
    s_cbranch_scc0 B_q_poll
B_q_done:
    s_movk_i32 s74, 18432
    buffer_load_dwordx4 v[168:171], v231, s[52:55], 0 offen sc1
    buffer_load_dwordx2 v[172:173], v232, s[52:55], 0 offen sc1
    buffer_load_dwordx4 v[176:179], v231, s[52:55], s74 offen sc1
    buffer_load_dwordx2 v[180:181], v232, s[52:55], s74 offen sc1
    s_waitcnt vmcnt(0)
B_qhave:
    s_waitcnt vmcnt(4) lgkmcnt(0)
    v_mfma_f32_16x16x32_bf16 v[32:35], v[128:131], v[168:171], 0
    v_mfma_f32_16x16x32_bf16 v[36:39], v[132:135], v[168:171], 0
    v_mfma_f32_16x16x32_bf16 v[40:43], v[136:139], v[168:171], 0
    v_mfma_f32_16x16x32_bf16 v[44:47], v[140:143], v[168:171], 0
    v_mfma_f32_16x16x32_bf16 v[48:51], v[144:147], v[168:171], 0
    v_mfma_f32_16x16x16_bf16 v[32:35], v[158:159], v[172:173], v[32:35]
    v_mfma_f32_16x16x16_bf16 v[36:39], v[160:161], v[172:173], v[36:39]
    v_mfma_f32_16x16x16_bf16 v[40:43], v[162:163], v[172:173], v[40:43]
    v_mfma_f32_16x16x16_bf16 v[44:47], v[164:165], v[172:173], v[44:47]
    v_mfma_f32_16x16x16_bf16 v[48:51], v[166:167], v[172:173], v[48:51]
    v_mfma_f32_16x16x32_bf16 v[52:55], v[128:131], v[176:179], 0
    v_mfma_f32_16x16x32_bf16 v[56:59], v[132:135], v[176:179], 0
    v_mfma_f32_16x16x32_bf16 v[60:63], v[136:139], v[176:179], 0
    v_mfma_f32_16x16x32_bf16 v[64:67], v[140:143], v[176:179], 0
    v_mfma_f32_16x16x32_bf16 v[68:71], v[144:147], v[176:179], 0
    v_mfma_f32_16x16x16_bf16 v[52:55], v[158:159], v[180:181], v[52:55]
    v_mfma_f32_16x16x16_bf16 v[56:59], v[160:161], v[180:181], v[56:59]
    v_mfma_f32_16x16x16_bf16 v[60:63], v[162:163], v[180:181], v[60:63]
    v_mfma_f32_16x16x16_bf16 v[64:67], v[164:165], v[180:181], v[64:67]
    v_mfma_f32_16x16x16_bf16 v[68:71], v[166:167], v[180:181], v[68:71]
    s_cmp_eq_u32 s6, 3
    s_cbranch_scc1 B_nopz
    s_movk_i32 s75, 18432
    buffer_store_dwordx4 v[252:255], v228, s[52:55], 0 offen sc1
    buffer_store_dwordx2 v[252:253], v229, s[52:55], 0 offen sc1
    buffer_store_dwordx4 v[252:255], v228, s[52:55], s75 offen sc1
    buffer_store_dwordx2 v[252:253], v229, s[52:55], s75 offen sc1
B_nopz:
    v_max3_f32 v26, v32, v33, v34
    v_max3_f32 v26, v26, v35, v36
    v_max3_f32 v26, v26, v37, v38
    v_max3_f32 v26, v26, v39, v40
    v_max3_f32 v26, v26, v41, v42
    s_cmp_lg_u32 s6, 3
    s_cbranch_scc1 B_nop1
    buffer_load_dword v29, v212, s[52:55], 0 offen sc1
B_nop1:
    v_max3_f32 v26, v26, v43, v44
    v_max3_f32 v26, v26, v45, v46
    v_max3_f32 v26, v26, v47, v48
    v_max_f32 v26, v26, v49
    v_mul_f32 v26, 0xbfb8aa3b, v26
    v_pk_fma_f32 v[32:33], v[32:33], s[72:73], v[26:27] op_sel_hi:[1,1,0]
    v_pk_fma_f32 v[34:35], v[34:35], s[72:73], v[26:27] op_sel_hi:[1,1,0]
    v_pk_fma_f32 v[36:37], v[36:37], s[72:73], v[26:27] op_sel_hi:[1,1,0]
    v_pk_fma_f32 v[38:39], v[38:39], s[72:73], v[26:27] op_sel_hi:[1,1,0]
    v_pk_fma_f32 v[40:41], v[40:41], s[72:73], v[26:27] op_sel_hi:[1,1,0]
    v_pk_fma_f32 v[42:43], v[42:43], s[72:73], v[26:27] op_sel_hi:[1,1,0]
    v_pk_fma_f32 v[44:45], v[44:45], s[72:73], v[26:27] op_sel_hi:[1,1,0]
    v_pk_fma_f32 v[46:47], v[46:47], s[72:73], v[26:27] op_sel_hi:[1,1,0]
    v_pk_fma_f32 v[48:49], v[48:49], s[72:73], v[26:27] op_sel_hi:[1,1,0]
    v_exp_f32 v32, v32
    v_exp_f32 v33, v33
    v_exp_f32 v34, v34
    v_exp_f32 v35, v35
    v_exp_f32 v36, v36
    v_exp_f32 v37, v37
    v_exp_f32 v38, v38
    v_exp_f32 v39, v39
    v_exp_f32 v40, v40
    v_exp_f32 v41, v41
    v_exp_f32 v42, v42
    v_exp_f32 v43, v43
    v_exp_f32 v44, v44
    v_exp_f32 v45, v45
    v_exp_f32 v46, v46
    v_exp_f32 v47, v47
    v_exp_f32 v48, v48
    v_exp_f32 v49, v49
    v_pk_add_f32 v[20:21], v[32:33], v[34:35]
    v_pk_add_f32 v[20:21], v[20:21], v[36:37]
    v_pk_add_f32 v[20:21], v[20:21], v[38:39]
    v_pk_add_f32 v[20:21], v[20:21], v[40:41]
    v_pk_add_f32 v[20:21], v[20:21], v[42:43]
    v_pk_add_f32 v[20:21], v[20:21], v[44:45]
    v_pk_add_f32 v[20:21], v[20:21], v[46:47]
    v_pk_add_f32 v[20:21], v[20:21], v[48:49]
    s_cmp_lg_u32 s6, 3
    s_cbranch_scc1 B_h1_done
    s_waitcnt vmcnt(0)
    v_cmp_ne_u32 vcc, s9, v29
    s_cbranch_vccz B_h1x_done
    s_movk_i32 s77, 30000
B_h1x_poll:
    buffer_load_dword v29, v212, s[52:55], 0 offen sc1
    s_waitcnt vmcnt(0)
    v_cmp_ne_u32 vcc, s9, v29
    s_cbranch_vccz B_h1x_done

    s_sub_u32 s77, s77, 1
    s_cbranch_scc0 B_h1x_poll
B_h1x_done:
    s_movk_i32 s75, 18432
    buffer_store_dwordx4 v[252:255], v228, s[52:55], 0 offen sc1
    buffer_store_dwordx2 v[252:253], v229, s[52:55], 0 offen sc1
    buffer_store_dwordx4 v[252:255], v228, s[52:55], s75 offen sc1
    buffer_store_dwordx2 v[252:253], v229, s[52:55], s75 offen sc1
B_h1_done:
    s_barrier
    s_movk_i32 s77, 30000
    s_mov_b32 s74, 0
    buffer_load_dwordx4 v[96:99], v213, s[52:55], s74 offen sc1
    s_mov_b32 s74, 6400
    buffer_load_dwordx4 v[100:103], v213, s[52:55], s74 offen sc1
    s_mov_b32 s74, 12800
    buffer_load_dwordx4 v[104:107], v213, s[52:55], s74 offen sc1
    s_mov_b32 s74, 19200
    buffer_load_dwordx4 v[108:111], v213, s[52:55], s74 offen sc1
    s_mov_b32 s74, 25600
    buffer_load_dwordx4 v[112:115], v213, s[52:55], s74 offen sc1
    s_mov_b32 s74, 32000
    buffer_load_dwordx4 v[116:119], v213, s[52:55], s74 offen sc1
    s_mov_b32 s74, 38400
    buffer_load_dwordx4 v[120:123], v213, s[52:55], s74 offen sc1
    s_mov_b32 s74, 44800
    buffer_load_dwordx4 v[124:127], v213, s[52:55], s74 offen sc1
    s_cmp_eq_u32 s13, 1
    s_cbranch_scc1 B_wo2
    s_mov_b32 s88, 456192
    s_add_u32 m0, s71, 45056
    s_nop 0
    buffer_load_dwordx4 v240, s[60:63], s88 offen lds
    s_mov_b32 s88, 497664
    s_add_u32 m0, s71, 49152
    s_nop 0
    buffer_load_dwordx4 v240, s[60:63], s88 offen lds
    s_mov_b32 s88, 539136
    s_add_u32 m0, s71, 53248
    s_nop 0
    buffer_load_dwordx4 v240, s[60:63], s88 offen lds
    s_mov_b32 s88, 580608
    s_add_u32 m0, s71, 57344
    s_nop 0
    buffer_load_dwordx4 v240, s[60:63], s88 offen lds
    s_branch B_wo3
B_wo2:
    s_mov_b32 s88, 580608
    s_add_u32 m0, s71, 57344
    s_nop 0
    buffer_load_dwordx4 v240, s[60:63], s88 offen lds
    s_mov_b32 s88, 622080
    s_add_u32 m0, s71, 61440
    s_nop 0
    buffer_load_dwordx4 v240, s[60:63], s88 offen lds
    s_mov_b32 s88, 0
    s_add_u32 m0, s71, 65536
    s_nop 0
    buffer_load_dwordx4 v241, s[60:63], s88 offen lds
    s_mov_b32 s88, 331776
    s_add_u32 m0, s71, 69632
    s_nop 0
    buffer_load_dwordx4 v241, s[60:63], s88 offen lds
B_wo3:
    v_add_f32 v20, v20, v21
    v_rcp_f32 v20, v20
    s_nop 0
    v_pk_mul_f32 v[32:33], v[32:33], v[20:21] op_sel_hi:[1,0]
    v_pk_mul_f32 v[34:35], v[34:35], v[20:21] op_sel_hi:[1,0]
    v_pk_mul_f32 v[36:37], v[36:37], v[20:21] op_sel_hi:[1,0]
    v_pk_mul_f32 v[38:39], v[38:39], v[20:21] op_sel_hi:[1,0]
    v_pk_mul_f32 v[40:41], v[40:41], v[20:21] op_sel_hi:[1,0]
    v_pk_mul_f32 v[42:43], v[42:43], v[20:21] op_sel_hi:[1,0]
    v_pk_mul_f32 v[44:45], v[44:45], v[20:21] op_sel_hi:[1,0]
    v_pk_mul_f32 v[46:47], v[46:47], v[20:21] op_sel_hi:[1,0]
    v_pk_mul_f32 v[48:49], v[48:49], v[20:21] op_sel_hi:[1,0]
    v_cvt_pk_bf16_f32 v72, v32, v33
    v_cvt_pk_bf16_f32 v73, v34, v35
    v_cvt_pk_bf16_f32 v74, v36, v37
    v_cvt_pk_bf16_f32 v75, v38, v39
    v_cvt_pk_bf16_f32 v76, v40, v41
    v_cvt_pk_bf16_f32 v77, v42, v43
    v_cvt_pk_bf16_f32 v78, v44, v45
    v_cvt_pk_bf16_f32 v79, v46, v47
    v_cvt_pk_bf16_f32 v80, v48, v49
    v_mov_b32 v81, 0
    v_max3_f32 v26, v52, v53, v54
    v_max3_f32 v26, v26, v55, v56
    v_max3_f32 v26, v26, v57, v58
    v_max3_f32 v26, v26, v59, v60
    v_max3_f32 v26, v26, v61, v62
    v_max3_f32 v26, v26, v63, v64
    v_max3_f32 v26, v26, v65, v66
    v_max3_f32 v26, v26, v67, v68
    v_max_f32 v26, v26, v69
    v_mul_f32 v26, 0xbfb8aa3b, v26
    v_pk_fma_f32 v[52:53], v[52:53], s[72:73], v[26:27] op_sel_hi:[1,1,0]
    v_pk_fma_f32 v[54:55], v[54:55], s[72:73], v[26:27] op_sel_hi:[1,1,0]
    v_pk_fma_f32 v[56:57], v[56:57], s[72:73], v[26:27] op_sel_hi:[1,1,0]
    v_pk_fma_f32 v[58:59], v[58:59], s[72:73], v[26:27] op_sel_hi:[1,1,0]
    v_pk_fma_f32 v[60:61], v[60:61], s[72:73], v[26:27] op_sel_hi:[1,1,0]
    v_pk_fma_f32 v[62:63], v[62:63], s[72:73], v[26:27] op_sel_hi:[1,1,0]
    v_pk_fma_f32 v[64:65], v[64:65], s[72:73], v[26:27] op_sel_hi:[1,1,0]
    v_pk_fma_f32 v[66:67], v[66:67], s[72:73], v[26:27] op_sel_hi:[1,1,0]
    v_pk_fma_f32 v[68:69], v[68:69], s[72:73], v[26:27] op_sel_hi:[1,1,0]
    v_exp_f32 v52, v52
    v_exp_f32 v53, v53
    v_exp_f32 v54, v54
    v_exp_f32 v55, v55
    v_exp_f32 v56, v56
    v_exp_f32 v57, v57
    v_exp_f32 v58, v58
    v_exp_f32 v59, v59
    v_exp_f32 v60, v60
    v_exp_f32 v61, v61
    v_exp_f32 v62, v62
    v_exp_f32 v63, v63
    v_exp_f32 v64, v64
    v_exp_f32 v65, v65
    v_exp_f32 v66, v66
    v_exp_f32 v67, v67
    v_exp_f32 v68, v68
    v_exp_f32 v69, v69
    v_pk_add_f32 v[20:21], v[52:53], v[54:55]
    v_pk_add_f32 v[20:21], v[20:21], v[56:57]
    v_pk_add_f32 v[20:21], v[20:21], v[58:59]
    v_pk_add_f32 v[20:21], v[20:21], v[60:61]
    v_pk_add_f32 v[20:21], v[20:21], v[62:63]
    v_pk_add_f32 v[20:21], v[20:21], v[64:65]
    v_pk_add_f32 v[20:21], v[20:21], v[66:67]
    v_pk_add_f32 v[20:21], v[20:21], v[68:69]
    v_add_f32 v20, v20, v21
    v_rcp_f32 v20, v20
    s_nop 0
    v_pk_mul_f32 v[52:53], v[52:53], v[20:21] op_sel_hi:[1,0]
    v_pk_mul_f32 v[54:55], v[54:55], v[20:21] op_sel_hi:[1,0]
    v_pk_mul_f32 v[56:57], v[56:57], v[20:21] op_sel_hi:[1,0]
    v_pk_mul_f32 v[58:59], v[58:59], v[20:21] op_sel_hi:[1,0]
    v_pk_mul_f32 v[60:61], v[60:61], v[20:21] op_sel_hi:[1,0]
    v_pk_mul_f32 v[62:63], v[62:63], v[20:21] op_sel_hi:[1,0]
    v_pk_mul_f32 v[64:65], v[64:65], v[20:21] op_sel_hi:[1,0]
    v_pk_mul_f32 v[66:67], v[66:67], v[20:21] op_sel_hi:[1,0]
    v_pk_mul_f32 v[68:69], v[68:69], v[20:21] op_sel_hi:[1,0]
    v_cvt_pk_bf16_f32 v84, v52, v53
    v_cvt_pk_bf16_f32 v85, v54, v55
    v_cvt_pk_bf16_f32 v86, v56, v57
    v_cvt_pk_bf16_f32 v87, v58, v59
    v_cvt_pk_bf16_f32 v88, v60, v61
    v_cvt_pk_bf16_f32 v89, v62, v63
    v_cvt_pk_bf16_f32 v90, v64, v65
    v_cvt_pk_bf16_f32 v91, v66, v67
    v_cvt_pk_bf16_f32 v92, v68, v69
    v_mov_b32 v93, 0
    v_mov_b32 v60, 0
    v_mov_b32 v61, 0
    s_branch B_red
B_pl:
    s_mov_b32 s74, 0
    buffer_load_dwordx4 v[96:99], v213, s[52:55], s74 offen sc1
    s_mov_b32 s74, 6400
    buffer_load_dwordx4 v[100:103], v213, s[52:55], s74 offen sc1
    s_mov_b32 s74, 12800
    buffer_load_dwordx4 v[104:107], v213, s[52:55], s74 offen sc1
    s_mov_b32 s74, 19200
    buffer_load_dwordx4 v[108:111], v213, s[52:55], s74 offen sc1
    s_mov_b32 s74, 25600
    buffer_load_dwordx4 v[112:115], v213, s[52:55], s74 offen sc1
    s_mov_b32 s74, 32000
    buffer_load_dwordx4 v[116:119], v213, s[52:55], s74 offen sc1
    s_mov_b32 s74, 38400
    buffer_load_dwordx4 v[120:123], v213, s[52:55], s74 offen sc1
    s_mov_b32 s74, 44800
    buffer_load_dwordx4 v[124:127], v213, s[52:55], s74 offen sc1
    s_waitcnt vmcnt(0)
B_red:
    s_waitcnt vmcnt(11)
    v_mfma_f32_16x16x32_bf16 v[32:35], v[216:219], v[96:99], 0
    v_max3_u32 v28, v96, v97, v98
    v_max_u32 v28, v28, v99
    s_waitcnt vmcnt(10)
    v_mfma_f32_16x16x32_bf16 v[32:35], v[216:219], v[100:103], v[32:35]
    v_max3_u32 v28, v28, v100, v101
    v_max3_u32 v28, v28, v102, v103
    s_waitcnt vmcnt(9)
    v_mfma_f32_16x16x32_bf16 v[32:35], v[216:219], v[104:107], v[32:35]
    v_max3_u32 v28, v28, v104, v105
    v_max3_u32 v28, v28, v106, v107
    s_waitcnt vmcnt(8)
    v_mfma_f32_16x16x32_bf16 v[32:35], v[216:219], v[108:111], v[32:35]
    v_max3_u32 v28, v28, v108, v109
    v_max3_u32 v28, v28, v110, v111
    s_waitcnt vmcnt(7)
    v_mfma_f32_16x16x32_bf16 v[32:35], v[216:219], v[112:115], v[32:35]
    v_max3_u32 v28, v28, v112, v113
    v_max3_u32 v28, v28, v114, v115
    s_waitcnt vmcnt(6)
    v_mfma_f32_16x16x32_bf16 v[32:35], v[216:219], v[116:119], v[32:35]
    v_max3_u32 v28, v28, v116, v117
    v_max3_u32 v28, v28, v118, v119
    s_waitcnt vmcnt(5)
    v_mfma_f32_16x16x32_bf16 v[32:35], v[216:219], v[120:123], v[32:35]
    v_max3_u32 v28, v28, v120, v121
    v_max3_u32 v28, v28, v122, v123
    s_waitcnt vmcnt(4)
    v_mfma_f32_16x16x32_bf16 v[32:35], v[216:219], v[124:127], v[32:35]
    v_max3_u32 v28, v28, v124, v125
    v_max3_u32 v28, v28, v126, v127
B_redd:
    s_nop 3
    v_cmp_eq_u32 vcc, -1, v28
    s_cbranch_vccz B_pok
    s_sub_u32 s77, s77, 1
    s_cbranch_scc0 B_pl

B_pok:
    v_cvt_pk_bf16_f32 v50, v32, v33
    v_cvt_pk_bf16_f32 v51, v34, v35
    ds_write_b64 v220, v[50:51]
    v_cndmask_b32 v56, 0, v50, s[86:87]
    v_cndmask_b32 v57, v51, 0, s[86:87]
    v_cndmask_b32 v58, 0, v51, s[86:87]
    v_cndmask_b32 v59, v50, 0, s[86:87]
    ds_write2_b64 v222, v[56:57], v[58:59] offset0:0 offset1:1
    ds_write_b64 v222, v[60:61] offset:16
    s_waitcnt lgkmcnt(0)
    s_barrier

    ds_read_b64_tr_b16 v[148:149], v227 offset:0
    ds_read_b64_tr_b16 v[112:113], v224 offset:0
    ds_read_b64_tr_b16 v[124:125], v225 offset:0
    ds_read_b64_tr_b16 v[136:137], v226 offset:0
    ds_read_b64_tr_b16 v[150:151], v227 offset:224
    ds_read_b64_tr_b16 v[114:115], v224 offset:224
    ds_read_b64_tr_b16 v[126:127], v225 offset:224
    ds_read_b64_tr_b16 v[138:139], v226 offset:224
    ds_read_b64_tr_b16 v[152:153], v227 offset:448
    ds_read_b64_tr_b16 v[116:117], v224 offset:448
    ds_read_b64_tr_b16 v[128:129], v225 offset:448
    ds_read_b64_tr_b16 v[140:141], v226 offset:448
    ds_read_b64_tr_b16 v[154:155], v227 offset:672
    ds_read_b64_tr_b16 v[118:119], v224 offset:672
    ds_read_b64_tr_b16 v[130:131], v225 offset:672
    ds_read_b64_tr_b16 v[142:143], v226 offset:672
    ds_read_b64_tr_b16 v[156:157], v227 offset:896
    ds_read_b64_tr_b16 v[120:121], v224 offset:896
    ds_read_b64_tr_b16 v[132:133], v225 offset:896
    ds_read_b64_tr_b16 v[144:145], v226 offset:896
    s_movk_i32 s75, 18432
    s_waitcnt lgkmcnt(12)
    v_mfma_f32_16x16x32_bf16 v[44:47], v[148:151], v[72:75], 0
    v_mfma_f32_16x16x32_bf16 v[32:35], v[112:115], v[72:75], 0
    v_mfma_f32_16x16x32_bf16 v[36:39], v[124:127], v[72:75], 0
    v_mfma_f32_16x16x32_bf16 v[40:43], v[136:139], v[72:75], 0
    v_mfma_f32_16x16x32_bf16 v[60:63], v[148:151], v[84:87], 0
    v_mfma_f32_16x16x32_bf16 v[48:51], v[112:115], v[84:87], 0
    v_mfma_f32_16x16x32_bf16 v[52:55], v[124:127], v[84:87], 0
    v_mfma_f32_16x16x32_bf16 v[56:59], v[136:139], v[84:87], 0
    s_waitcnt lgkmcnt(4)
    v_mfma_f32_16x16x32_bf16 v[44:47], v[152:155], v[76:79], v[44:47]
    v_mfma_f32_16x16x32_bf16 v[32:35], v[116:119], v[76:79], v[32:35]
    v_mfma_f32_16x16x32_bf16 v[36:39], v[128:131], v[76:79], v[36:39]
    v_mfma_f32_16x16x32_bf16 v[40:43], v[140:143], v[76:79], v[40:43]
    v_mfma_f32_16x16x32_bf16 v[60:63], v[152:155], v[88:91], v[60:63]
    v_mfma_f32_16x16x32_bf16 v[48:51], v[116:119], v[88:91], v[48:51]
    v_mfma_f32_16x16x32_bf16 v[52:55], v[128:131], v[88:91], v[52:55]
    v_mfma_f32_16x16x32_bf16 v[56:59], v[140:143], v[88:91], v[56:59]
    s_waitcnt lgkmcnt(0)
    v_mfma_f32_16x16x16_bf16 v[44:47], v[156:157], v[80:81], v[44:47]
    v_mfma_f32_16x16x16_bf16 v[32:35], v[120:121], v[80:81], v[32:35]
    v_mfma_f32_16x16x16_bf16 v[36:39], v[132:133], v[80:81], v[36:39]
    v_mfma_f32_16x16x16_bf16 v[40:43], v[144:145], v[80:81], v[40:43]
    v_mfma_f32_16x16x16_bf16 v[60:63], v[156:157], v[92:93], v[60:63]
    v_mfma_f32_16x16x16_bf16 v[48:51], v[120:121], v[92:93], v[48:51]
    v_mfma_f32_16x16x16_bf16 v[52:55], v[132:133], v[92:93], v[52:55]
    v_mfma_f32_16x16x16_bf16 v[56:59], v[144:145], v[92:93], v[56:59]
    s_cmp_lg_u32 s6, 7
    s_cbranch_scc1 B_nofl2
    s_mov_b64 exec, 1
    buffer_store_dword v17, v230, s[52:55], 0 offen sc1
    s_mov_b64 exec, -1

B_nofl2:
    v_add_f32 v44, 0x358637bd, v44
    v_add_f32 v46, 0x358637bd, v46
    v_rcp_f32 v44, v44
    v_rcp_f32 v46, v46
    s_nop 0
    v_cndmask_b32 v26, v46, v44, s[84:85]
    v_cndmask_b32 v27, v46, v44, s[78:79]
    v_mul_f32 v32, v32, v26
    v_mul_f32 v33, v33, v26
    v_mul_f32 v34, v34, v27
    v_mul_f32 v35, v35, v27
    v_mul_f32 v36, v36, v27
    v_mul_f32 v37, v37, v27
    v_mul_f32 v38, v38, v27
    v_mul_f32 v39, v39, v27
    v_mul_f32 v40, v40, v46
    v_mul_f32 v41, v41, v46
    v_mul_f32 v42, v42, v46
    v_mul_f32 v43, v43, v46
    v_cvt_pk_bf16_f32 v96, v32, v33
    v_cvt_pk_bf16_f32 v97, v34, v35
    v_cvt_pk_bf16_f32 v98, v36, v37
    v_cvt_pk_bf16_f32 v99, v38, v39
    v_cvt_pk_bf16_f32 v100, v40, v41
    v_cvt_pk_bf16_f32 v101, v42, v43
    buffer_store_dwordx4 v[96:99], v228, s[52:55], 0 offen sc1
    buffer_store_dwordx2 v[100:101], v229, s[52:55], 0 offen sc1
    v_add_f32 v60, 0x358637bd, v60
    v_add_f32 v62, 0x358637bd, v62
    v_rcp_f32 v60, v60
    v_rcp_f32 v62, v62
    s_nop 0
    v_cndmask_b32 v26, v62, v60, s[84:85]
    v_cndmask_b32 v27, v62, v60, s[78:79]
    v_mul_f32 v48, v48, v26
    v_mul_f32 v49, v49, v26
    v_mul_f32 v50, v50, v27
    v_mul_f32 v51, v51, v27
    v_mul_f32 v52, v52, v27
    v_mul_f32 v53, v53, v27
    v_mul_f32 v54, v54, v27
    v_mul_f32 v55, v55, v27
    v_mul_f32 v56, v56, v62
    v_mul_f32 v57, v57, v62
    v_mul_f32 v58, v58, v62
    v_mul_f32 v59, v59, v62
    v_cvt_pk_bf16_f32 v104, v48, v49
    v_cvt_pk_bf16_f32 v105, v50, v51
    v_cvt_pk_bf16_f32 v106, v52, v53
    v_cvt_pk_bf16_f32 v107, v54, v55
    v_cvt_pk_bf16_f32 v108, v56, v57
    v_cvt_pk_bf16_f32 v109, v58, v59
    buffer_store_dwordx4 v[104:107], v228, s[52:55], s75 offen sc1
    buffer_store_dwordx2 v[108:109], v229, s[52:55], s75 offen sc1
OUT_entry:
    s_mov_b32 s95, 0
    v_and_b32 v29, 1, v19
    v_lshl_add_u32 v28, v19, 3, v23
    v_lshrrev_b32 v21, 1, v23
    v_lshl_or_b32 v21, v29, 1, v21
    v_lshlrev_b32 v21, 1, v21
    v_lshrrev_b32 v18, 1, v24
    v_and_b32 v20, 1, v24
    v_lshlrev_b32 v20, 3, v20
    v_lshl_add_u32 v20, v28, 7, v20
    v_add_u32 v20, 49152, v20
    v_mov_b32 v15, v20

    v_add_u32 v6, 0, v18
    v_xor_b32 v6, v6, v21
    v_lshl_add_u32 v10, v6, 4, v20
    v_add_u32 v6, 2, v18
    v_xor_b32 v6, v6, v21
    v_lshl_add_u32 v11, v6, 4, v20
    v_add_u32 v6, 4, v18
    v_xor_b32 v6, v6, v21
    v_lshl_add_u32 v12, v6, 4, v20
    v_add_u32 v6, 6, v18
    v_xor_b32 v6, v6, v21
    v_lshl_add_u32 v13, v6, 4, v20
    s_mul_i32 s74, s7, 7
    s_min_u32 s75, s6, 7
    s_add_u32 s74, s74, s75
    s_mul_i32 s75, s7, 7
    s_lshr_b32 s76, s75, 4
    s_add_u32 s75, s75, 6
    s_lshr_b32 s75, s75, 4
    s_min_u32 s75, s75, 7
    s_min_u32 s76, s76, 7
    v_mov_b32 v20, s76
    v_mov_b32 v26, s75
    v_cmp_gt_u32 vcc, 16, v2
    s_nop 1
    v_cndmask_b32 v20, v26, v20, vcc
    v_lshl_add_u32 v20, v20, 4, v22
    v_lshlrev_b32 v20, 7, v20
    v_add_u32 v20, 0xd8000, v20
    s_mul_i32 s75, s74, 18432
    s_add_u32 s75, s75, 0x100000
    v_lshl_add_u32 v8, v2, 4, s75
    v_lshlrev_b32 v9, 8, v19
    v_lshl_add_u32 v9, v22, 3, v9
    s_add_u32 s75, s75, 16384
    v_add_u32 v9, s75, v9
    s_lshl_b32 s75, s74, 4
    v_add_u32 v25, s75, v22
    v_mul_u32_u24 v25, 2304, v25
    s_lshl_b32 s75, s8, 7
    s_add_u32 s75, s75, 1152
    v_add_u32 v25, s75, v25
    s_lshl_b32 s75, s12, 5
    v_lshl_add_u32 v14, v19, 3, v25
    v_add_u32 v14, s75, v14
    v_lshl_add_u32 v25, v29, 5, v25
    v_lshrrev_b32 v27, 1, v19
    v_lshl_add_u32 v25, v27, 4, v25

    v_add_u32 v3, 0x10000, v10
    v_add_u32 v4, 0x10000, v11
    v_add_u32 v5, 0x10000, v12
    v_add_u32 v6, 0x10000, v13
    s_cmp_eq_u32 s6, 7
    s_cbranch_scc1 h2_start
    ds_read_b64_tr_b16 v[32:33], v10 offset:0
    ds_read_b64_tr_b16 v[34:35], v10 offset:512
    ds_read_b64_tr_b16 v[36:37], v11 offset:0
    ds_read_b64_tr_b16 v[38:39], v11 offset:512
    ds_read_b64_tr_b16 v[40:41], v12 offset:0
    ds_read_b64_tr_b16 v[42:43], v12 offset:512
    ds_read_b64_tr_b16 v[44:45], v13 offset:0
    ds_read_b64_tr_b16 v[46:47], v13 offset:512
    ds_read_b64_tr_b16 v[48:49], v10 offset:4096
    ds_read_b64_tr_b16 v[50:51], v10 offset:4608
    ds_read_b64_tr_b16 v[52:53], v11 offset:4096
    ds_read_b64_tr_b16 v[54:55], v11 offset:4608
    ds_read_b64_tr_b16 v[56:57], v12 offset:4096
    ds_read_b64_tr_b16 v[58:59], v12 offset:4608
    ds_read_b64_tr_b16 v[60:61], v13 offset:4096
    ds_read_b64_tr_b16 v[62:63], v13 offset:4608
    ds_read_b64_tr_b16 v[64:65], v10 offset:8192
    ds_read_b64_tr_b16 v[66:67], v10 offset:8704
    ds_read_b64_tr_b16 v[68:69], v11 offset:8192
    ds_read_b64_tr_b16 v[70:71], v11 offset:8704
    ds_read_b64_tr_b16 v[72:73], v12 offset:8192
    ds_read_b64_tr_b16 v[74:75], v12 offset:8704
    ds_read_b64_tr_b16 v[76:77], v13 offset:8192
    ds_read_b64_tr_b16 v[78:79], v13 offset:8704
    ds_read_b64_tr_b16 v[80:81], v10 offset:12288
    ds_read_b64_tr_b16 v[82:83], v10 offset:12800
    ds_read_b64_tr_b16 v[84:85], v11 offset:12288
    ds_read_b64_tr_b16 v[86:87], v11 offset:12800
    ds_read_b64_tr_b16 v[88:89], v12 offset:12288
    ds_read_b64_tr_b16 v[90:91], v12 offset:12800
    ds_read_b64_tr_b16 v[92:93], v13 offset:12288
    ds_read_b64_tr_b16 v[94:95], v13 offset:12800
    ds_read_b64_tr_b16 v[96:97], v10 offset:16384
    ds_read_b64_tr_b16 v[98:99], v10 offset:16896
    ds_read_b64_tr_b16 v[100:101], v11 offset:16384
    ds_read_b64_tr_b16 v[102:103], v11 offset:16896
    ds_read_b64_tr_b16 v[104:105], v12 offset:16384
    ds_read_b64_tr_b16 v[106:107], v12 offset:16896
    ds_read_b64_tr_b16 v[108:109], v13 offset:16384
    ds_read_b64_tr_b16 v[110:111], v13 offset:16896
    ds_read_b64_tr_b16 v[112:113], v10 offset:20480
    ds_read_b64_tr_b16 v[114:115], v10 offset:20992
    ds_read_b64_tr_b16 v[116:117], v11 offset:20480
    ds_read_b64_tr_b16 v[118:119], v11 offset:20992
    ds_read_b64_tr_b16 v[120:121], v12 offset:20480
    ds_read_b64_tr_b16 v[122:123], v12 offset:20992
    ds_read_b64_tr_b16 v[124:125], v13 offset:20480
    ds_read_b64_tr_b16 v[126:127], v13 offset:20992
    ds_read_b64_tr_b16 v[128:129], v10 offset:24576
    ds_read_b64_tr_b16 v[130:131], v10 offset:25088
    ds_read_b64_tr_b16 v[132:133], v11 offset:24576
    ds_read_b64_tr_b16 v[134:135], v11 offset:25088
    ds_read_b64_tr_b16 v[136:137], v12 offset:24576
    ds_read_b64_tr_b16 v[138:139], v12 offset:25088
    ds_read_b64_tr_b16 v[140:141], v13 offset:24576
    ds_read_b64_tr_b16 v[142:143], v13 offset:25088
    ds_read_b64_tr_b16 v[144:145], v10 offset:28672
    ds_read_b64_tr_b16 v[146:147], v10 offset:29184
    ds_read_b64_tr_b16 v[148:149], v11 offset:28672
    ds_read_b64_tr_b16 v[150:151], v11 offset:29184
    ds_read_b64_tr_b16 v[152:153], v12 offset:28672
    ds_read_b64_tr_b16 v[154:155], v12 offset:29184
    ds_read_b64_tr_b16 v[156:157], v13 offset:28672
    ds_read_b64_tr_b16 v[158:159], v13 offset:29184
    s_waitcnt vmcnt(4)
    s_branch h2_done
h2_start:
    s_movk_i32 s77, 30000
h2_poll:
    buffer_load_dword v26, v20, s[52:55], 0 offen sc1
    s_waitcnt vmcnt(0)
    v_cmp_ne_u32 vcc, s9, v26
    s_cbranch_vccz h2_done

    s_sub_u32 s77, s77, 1
    s_cbranch_scc0 h2_poll
h2_done:
    s_barrier
    s_cmp_ge_u32 s6, 7
    s_cbranch_scc1 OUT_end
    s_cmp_ge_u32 s74, 128
    s_cbranch_scc1 OUT_end

    s_movk_i32 s74, 4096
    s_movk_i32 s75, 8192
    s_movk_i32 s76, 12288
    s_movk_i32 s77, 30000
    buffer_load_dwordx4 v[208:211], v8, s[52:55], 0 offen offset:0 sc1
    buffer_load_dwordx4 v[212:215], v8, s[52:55], 0 offen offset:1024 sc1
    ds_read_b64_tr_b16 v[160:161], v10 offset:32768
    ds_read_b64_tr_b16 v[162:163], v10 offset:33280
    ds_read_b64_tr_b16 v[164:165], v11 offset:32768
    buffer_load_dwordx4 v[216:219], v8, s[52:55], 0 offen offset:2048 sc1
    ds_read_b64_tr_b16 v[166:167], v11 offset:33280
    ds_read_b64_tr_b16 v[168:169], v12 offset:32768
    ds_read_b64_tr_b16 v[170:171], v12 offset:33280
    buffer_load_dwordx4 v[220:223], v8, s[52:55], 0 offen offset:3072 sc1
    ds_read_b64_tr_b16 v[172:173], v13 offset:32768
    ds_read_b64_tr_b16 v[174:175], v13 offset:33280
    ds_read_b64_tr_b16 v[176:177], v10 offset:36864
    buffer_load_dwordx4 v[224:227], v8, s[52:55], s74 offen offset:0 sc1
    ds_read_b64_tr_b16 v[178:179], v10 offset:37376
    ds_read_b64_tr_b16 v[180:181], v11 offset:36864
    ds_read_b64_tr_b16 v[182:183], v11 offset:37376
    buffer_load_dwordx4 v[228:231], v8, s[52:55], s74 offen offset:1024 sc1
    ds_read_b64_tr_b16 v[184:185], v12 offset:36864
    ds_read_b64_tr_b16 v[186:187], v12 offset:37376
    ds_read_b64_tr_b16 v[188:189], v13 offset:36864
    buffer_load_dwordx4 v[232:235], v8, s[52:55], s74 offen offset:2048 sc1
    ds_read_b64_tr_b16 v[190:191], v13 offset:37376
    ds_read_b64_tr_b16 v[192:193], v10 offset:40960
    ds_read_b64_tr_b16 v[194:195], v10 offset:41472
    buffer_load_dwordx4 v[236:239], v8, s[52:55], s74 offen offset:3072 sc1
    ds_read_b64_tr_b16 v[196:197], v11 offset:40960
    ds_read_b64_tr_b16 v[198:199], v11 offset:41472
    ds_read_b64_tr_b16 v[200:201], v12 offset:40960
    ds_read_b64_tr_b16 v[202:203], v12 offset:41472
    ds_read_b64_tr_b16 v[204:205], v13 offset:40960
    ds_read_b64_tr_b16 v[206:207], v13 offset:41472
    s_waitcnt vmcnt(7) lgkmcnt(0)
OC0:
    v_max3_u32 v28, v208, v209, v210
    v_max_u32 v28, v28, v211
    v_cmp_eq_u32 vcc, -1, v28
    s_cbranch_vccnz OR0
OK0:
    v_mfma_f32_16x16x32_bf16 v[240:243], v[32:35], v[208:211], 0
    v_mfma_f32_16x16x32_bf16 v[244:247], v[36:39], v[208:211], 0
    v_mfma_f32_16x16x32_bf16 v[248:251], v[40:43], v[208:211], 0
    v_mfma_f32_16x16x32_bf16 v[252:255], v[44:47], v[208:211], 0
    buffer_load_dwordx4 v[208:211], v8, s[52:55], s75 offen offset:0 sc1
    s_waitcnt vmcnt(7)
OC1:
    v_max3_u32 v28, v212, v213, v214
    v_max_u32 v28, v28, v215
    v_cmp_eq_u32 vcc, -1, v28
    s_cbranch_vccnz OR1
OK1:
    v_mfma_f32_16x16x32_bf16 v[240:243], v[48:51], v[212:215], v[240:243]
    ds_read_b64_tr_b16 v[32:33], v10 offset:45056
    ds_read_b64_tr_b16 v[34:35], v10 offset:45568
    v_mfma_f32_16x16x32_bf16 v[244:247], v[52:55], v[212:215], v[244:247]
    ds_read_b64_tr_b16 v[36:37], v11 offset:45056
    ds_read_b64_tr_b16 v[38:39], v11 offset:45568
    v_mfma_f32_16x16x32_bf16 v[248:251], v[56:59], v[212:215], v[248:251]
    ds_read_b64_tr_b16 v[40:41], v12 offset:45056
    ds_read_b64_tr_b16 v[42:43], v12 offset:45568
    v_mfma_f32_16x16x32_bf16 v[252:255], v[60:63], v[212:215], v[252:255]
    ds_read_b64_tr_b16 v[44:45], v13 offset:45056
    ds_read_b64_tr_b16 v[46:47], v13 offset:45568
    buffer_load_dwordx4 v[212:215], v8, s[52:55], s75 offen offset:1024 sc1
    s_waitcnt vmcnt(7)
OC2:
    v_max3_u32 v28, v216, v217, v218
    v_max_u32 v28, v28, v219
    v_cmp_eq_u32 vcc, -1, v28
    s_cbranch_vccnz OR2
OK2:
    v_mfma_f32_16x16x32_bf16 v[240:243], v[64:67], v[216:219], v[240:243]
    ds_read_b64_tr_b16 v[48:49], v10 offset:49152
    ds_read_b64_tr_b16 v[50:51], v10 offset:49664
    v_mfma_f32_16x16x32_bf16 v[244:247], v[68:71], v[216:219], v[244:247]
    ds_read_b64_tr_b16 v[52:53], v11 offset:49152
    ds_read_b64_tr_b16 v[54:55], v11 offset:49664
    v_mfma_f32_16x16x32_bf16 v[248:251], v[72:75], v[216:219], v[248:251]
    ds_read_b64_tr_b16 v[56:57], v12 offset:49152
    ds_read_b64_tr_b16 v[58:59], v12 offset:49664
    v_mfma_f32_16x16x32_bf16 v[252:255], v[76:79], v[216:219], v[252:255]
    ds_read_b64_tr_b16 v[60:61], v13 offset:49152
    ds_read_b64_tr_b16 v[62:63], v13 offset:49664
    buffer_load_dwordx4 v[216:219], v8, s[52:55], s75 offen offset:2048 sc1
    s_waitcnt vmcnt(7)
OC3:
    v_max3_u32 v28, v220, v221, v222
    v_max_u32 v28, v28, v223
    v_cmp_eq_u32 vcc, -1, v28
    s_cbranch_vccnz OR3
OK3:
    v_mfma_f32_16x16x32_bf16 v[240:243], v[80:83], v[220:223], v[240:243]
    ds_read_b64_tr_b16 v[64:65], v10 offset:53248
    ds_read_b64_tr_b16 v[66:67], v10 offset:53760
    v_mfma_f32_16x16x32_bf16 v[244:247], v[84:87], v[220:223], v[244:247]
    ds_read_b64_tr_b16 v[68:69], v11 offset:53248
    ds_read_b64_tr_b16 v[70:71], v11 offset:53760
    v_mfma_f32_16x16x32_bf16 v[248:251], v[88:91], v[220:223], v[248:251]
    ds_read_b64_tr_b16 v[72:73], v12 offset:53248
    ds_read_b64_tr_b16 v[74:75], v12 offset:53760
    v_mfma_f32_16x16x32_bf16 v[252:255], v[92:95], v[220:223], v[252:255]
    ds_read_b64_tr_b16 v[76:77], v13 offset:53248
    ds_read_b64_tr_b16 v[78:79], v13 offset:53760
    buffer_load_dwordx4 v[220:223], v8, s[52:55], s75 offen offset:3072 sc1
    s_waitcnt vmcnt(7)
OC4:
    v_max3_u32 v28, v224, v225, v226
    v_max_u32 v28, v28, v227
    v_cmp_eq_u32 vcc, -1, v28
    s_cbranch_vccnz OR4
OK4:
    v_mfma_f32_16x16x32_bf16 v[240:243], v[96:99], v[224:227], v[240:243]
    ds_read_b64_tr_b16 v[80:81], v10 offset:57344
    ds_read_b64_tr_b16 v[82:83], v10 offset:57856
    v_mfma_f32_16x16x32_bf16 v[244:247], v[100:103], v[224:227], v[244:247]
    ds_read_b64_tr_b16 v[84:85], v11 offset:57344
    ds_read_b64_tr_b16 v[86:87], v11 offset:57856
    v_mfma_f32_16x16x32_bf16 v[248:251], v[104:107], v[224:227], v[248:251]
    ds_read_b64_tr_b16 v[88:89], v12 offset:57344
    ds_read_b64_tr_b16 v[90:91], v12 offset:57856
    v_mfma_f32_16x16x32_bf16 v[252:255], v[108:111], v[224:227], v[252:255]
    ds_read_b64_tr_b16 v[92:93], v13 offset:57344
    ds_read_b64_tr_b16 v[94:95], v13 offset:57856
    buffer_load_dwordx4 v[224:227], v8, s[52:55], s76 offen offset:0 sc1
    s_waitcnt vmcnt(7)
OC5:
    v_max3_u32 v28, v228, v229, v230
    v_max_u32 v28, v28, v231
    v_cmp_eq_u32 vcc, -1, v28
    s_cbranch_vccnz OR5
OK5:
    v_mfma_f32_16x16x32_bf16 v[240:243], v[112:115], v[228:231], v[240:243]
    ds_read_b64_tr_b16 v[96:97], v10 offset:61440
    ds_read_b64_tr_b16 v[98:99], v10 offset:61952
    v_mfma_f32_16x16x32_bf16 v[244:247], v[116:119], v[228:231], v[244:247]
    ds_read_b64_tr_b16 v[100:101], v11 offset:61440
    ds_read_b64_tr_b16 v[102:103], v11 offset:61952
    v_mfma_f32_16x16x32_bf16 v[248:251], v[120:123], v[228:231], v[248:251]
    ds_read_b64_tr_b16 v[104:105], v12 offset:61440
    ds_read_b64_tr_b16 v[106:107], v12 offset:61952
    v_mfma_f32_16x16x32_bf16 v[252:255], v[124:127], v[228:231], v[252:255]
    ds_read_b64_tr_b16 v[108:109], v13 offset:61440
    ds_read_b64_tr_b16 v[110:111], v13 offset:61952
    buffer_load_dwordx4 v[228:231], v8, s[52:55], s76 offen offset:1024 sc1
    s_waitcnt vmcnt(7)
OC6:
    v_max3_u32 v28, v232, v233, v234
    v_max_u32 v28, v28, v235
    v_cmp_eq_u32 vcc, -1, v28
    s_cbranch_vccnz OR6
OK6:
    v_mfma_f32_16x16x32_bf16 v[240:243], v[128:131], v[232:235], v[240:243]
    ds_read_b64_tr_b16 v[112:113], v3 offset:0
    ds_read_b64_tr_b16 v[114:115], v3 offset:512
    v_mfma_f32_16x16x32_bf16 v[244:247], v[132:135], v[232:235], v[244:247]
    ds_read_b64_tr_b16 v[116:117], v4 offset:0
    ds_read_b64_tr_b16 v[118:119], v4 offset:512
    v_mfma_f32_16x16x32_bf16 v[248:251], v[136:139], v[232:235], v[248:251]
    ds_read_b64_tr_b16 v[120:121], v5 offset:0
    ds_read_b64_tr_b16 v[122:123], v5 offset:512
    v_mfma_f32_16x16x32_bf16 v[252:255], v[140:143], v[232:235], v[252:255]
    ds_read_b64_tr_b16 v[124:125], v6 offset:0
    ds_read_b64_tr_b16 v[126:127], v6 offset:512
    buffer_load_dwordx4 v[232:235], v8, s[52:55], s76 offen offset:2048 sc1
    s_waitcnt vmcnt(7)
OC7:
    v_max3_u32 v28, v236, v237, v238
    v_max_u32 v28, v28, v239
    v_cmp_eq_u32 vcc, -1, v28
    s_cbranch_vccnz OR7
OK7:
    v_mfma_f32_16x16x32_bf16 v[240:243], v[144:147], v[236:239], v[240:243]
    ds_read_b64_tr_b16 v[128:129], v3 offset:4096
    ds_read_b64_tr_b16 v[130:131], v3 offset:4608
    v_mfma_f32_16x16x32_bf16 v[244:247], v[148:151], v[236:239], v[244:247]
    ds_read_b64_tr_b16 v[132:133], v4 offset:4096
    ds_read_b64_tr_b16 v[134:135], v4 offset:4608
    v_mfma_f32_16x16x32_bf16 v[248:251], v[152:155], v[236:239], v[248:251]
    ds_read_b64_tr_b16 v[136:137], v5 offset:4096
    ds_read_b64_tr_b16 v[138:139], v5 offset:4608
    v_mfma_f32_16x16x32_bf16 v[252:255], v[156:159], v[236:239], v[252:255]
    ds_read_b64_tr_b16 v[140:141], v6 offset:4096
    ds_read_b64_tr_b16 v[142:143], v6 offset:4608
    buffer_load_dwordx4 v[236:239], v8, s[52:55], s76 offen offset:3072 sc1
    s_waitcnt vmcnt(7)
OC8:
    v_max3_u32 v28, v208, v209, v210
    v_max_u32 v28, v28, v211
    v_cmp_eq_u32 vcc, -1, v28
    s_cbranch_vccnz OR8
OK8:
    v_mfma_f32_16x16x32_bf16 v[240:243], v[160:163], v[208:211], v[240:243]
    v_mfma_f32_16x16x32_bf16 v[244:247], v[164:167], v[208:211], v[244:247]
    v_mfma_f32_16x16x32_bf16 v[248:251], v[168:171], v[208:211], v[248:251]
    v_mfma_f32_16x16x32_bf16 v[252:255], v[172:175], v[208:211], v[252:255]
    buffer_load_dwordx2 v[208:209], v9, s[52:55], 0 offen offset:0 sc1
    buffer_load_dwordx2 v[210:211], v9, s[52:55], 0 offen offset:128 sc1
    s_waitcnt vmcnt(8)
OC9:
    v_max3_u32 v28, v212, v213, v214
    v_max_u32 v28, v28, v215
    v_cmp_eq_u32 vcc, -1, v28
    s_cbranch_vccnz OR9
OK9:
    v_mfma_f32_16x16x32_bf16 v[240:243], v[176:179], v[212:215], v[240:243]
    v_mfma_f32_16x16x32_bf16 v[244:247], v[180:183], v[212:215], v[244:247]
    v_mfma_f32_16x16x32_bf16 v[248:251], v[184:187], v[212:215], v[248:251]
    v_mfma_f32_16x16x32_bf16 v[252:255], v[188:191], v[212:215], v[252:255]
    buffer_load_dwordx2 v[212:213], v9, s[52:55], 0 offen offset:1024 sc1
    buffer_load_dwordx2 v[214:215], v9, s[52:55], 0 offen offset:1152 sc1
    s_waitcnt vmcnt(9)
OC10:
    v_max3_u32 v28, v216, v217, v218
    v_max_u32 v28, v28, v219
    v_cmp_eq_u32 vcc, -1, v28
    s_cbranch_vccnz OR10
OK10:
    v_mfma_f32_16x16x32_bf16 v[240:243], v[192:195], v[216:219], v[240:243]
    v_mfma_f32_16x16x32_bf16 v[244:247], v[196:199], v[216:219], v[244:247]
    v_mfma_f32_16x16x32_bf16 v[248:251], v[200:203], v[216:219], v[248:251]
    v_mfma_f32_16x16x32_bf16 v[252:255], v[204:207], v[216:219], v[252:255]
    s_waitcnt vmcnt(8) lgkmcnt(0)
OC11:
    v_max3_u32 v28, v220, v221, v222
    v_max_u32 v28, v28, v223
    v_cmp_eq_u32 vcc, -1, v28
    s_cbranch_vccnz OR11
OK11:
    v_mfma_f32_16x16x32_bf16 v[240:243], v[32:35], v[220:223], v[240:243]
    v_mfma_f32_16x16x32_bf16 v[244:247], v[36:39], v[220:223], v[244:247]
    v_mfma_f32_16x16x32_bf16 v[248:251], v[40:43], v[220:223], v[248:251]
    v_mfma_f32_16x16x32_bf16 v[252:255], v[44:47], v[220:223], v[252:255]
    s_waitcnt vmcnt(7)
OC12:
    v_max3_u32 v28, v224, v225, v226
    v_max_u32 v28, v28, v227
    v_cmp_eq_u32 vcc, -1, v28
    s_cbranch_vccnz OR12
OK12:
    v_mfma_f32_16x16x32_bf16 v[240:243], v[48:51], v[224:227], v[240:243]
    v_mfma_f32_16x16x32_bf16 v[244:247], v[52:55], v[224:227], v[244:247]
    v_mfma_f32_16x16x32_bf16 v[248:251], v[56:59], v[224:227], v[248:251]
    v_mfma_f32_16x16x32_bf16 v[252:255], v[60:63], v[224:227], v[252:255]
    s_waitcnt vmcnt(6)
OC13:
    v_max3_u32 v28, v228, v229, v230
    v_max_u32 v28, v28, v231
    v_cmp_eq_u32 vcc, -1, v28
    s_cbranch_vccnz OR13
OK13:
    v_mfma_f32_16x16x32_bf16 v[240:243], v[64:67], v[228:231], v[240:243]
    v_mfma_f32_16x16x32_bf16 v[244:247], v[68:71], v[228:231], v[244:247]
    v_mfma_f32_16x16x32_bf16 v[248:251], v[72:75], v[228:231], v[248:251]
    v_mfma_f32_16x16x32_bf16 v[252:255], v[76:79], v[228:231], v[252:255]
    s_waitcnt vmcnt(5)
OC14:
    v_max3_u32 v28, v232, v233, v234
    v_max_u32 v28, v28, v235
    v_cmp_eq_u32 vcc, -1, v28
    s_cbranch_vccnz OR14
OK14:
    v_mfma_f32_16x16x32_bf16 v[240:243], v[80:83], v[232:235], v[240:243]
    v_mfma_f32_16x16x32_bf16 v[244:247], v[84:87], v[232:235], v[244:247]
    v_mfma_f32_16x16x32_bf16 v[248:251], v[88:91], v[232:235], v[248:251]
    v_mfma_f32_16x16x32_bf16 v[252:255], v[92:95], v[232:235], v[252:255]
    s_waitcnt vmcnt(4)
OC15:
    v_max3_u32 v28, v236, v237, v238
    v_max_u32 v28, v28, v239
    v_cmp_eq_u32 vcc, -1, v28
    s_cbranch_vccnz OR15
OK15:
    v_mfma_f32_16x16x32_bf16 v[240:243], v[96:99], v[236:239], v[240:243]
    v_mfma_f32_16x16x32_bf16 v[244:247], v[100:103], v[236:239], v[244:247]
    v_mfma_f32_16x16x32_bf16 v[248:251], v[104:107], v[236:239], v[248:251]
    v_mfma_f32_16x16x32_bf16 v[252:255], v[108:111], v[236:239], v[252:255]
    s_waitcnt vmcnt(2)
OC16:
    v_max3_u32 v28, v208, v209, v210
    v_max_u32 v28, v28, v211
    v_cmp_eq_u32 vcc, -1, v28
    s_cbranch_vccnz OR16
OK16:
    v_mfma_f32_16x16x32_bf16 v[240:243], v[112:115], v[208:211], v[240:243]
    v_mfma_f32_16x16x32_bf16 v[244:247], v[116:119], v[208:211], v[244:247]
    v_mfma_f32_16x16x32_bf16 v[248:251], v[120:123], v[208:211], v[248:251]
    v_mfma_f32_16x16x32_bf16 v[252:255], v[124:127], v[208:211], v[252:255]
    s_waitcnt vmcnt(0)
OC17:
    v_max3_u32 v28, v212, v213, v214
    v_max_u32 v28, v28, v215
    v_cmp_eq_u32 vcc, -1, v28
    s_cbranch_vccnz OR17
OK17:
    v_mfma_f32_16x16x32_bf16 v[240:243], v[128:131], v[212:215], v[240:243]
    v_mfma_f32_16x16x32_bf16 v[244:247], v[132:135], v[212:215], v[244:247]
    v_mfma_f32_16x16x32_bf16 v[248:251], v[136:139], v[212:215], v[248:251]
    v_mfma_f32_16x16x32_bf16 v[252:255], v[140:143], v[212:215], v[252:255]
    s_nop 3
    s_nop 0
    v_cvt_pk_bf16_f32 v96, v240, v241
    v_cvt_pk_bf16_f32 v97, v242, v243
    v_cvt_pk_bf16_f32 v98, v244, v245
    v_cvt_pk_bf16_f32 v99, v246, v247
    v_cvt_pk_bf16_f32 v100, v248, v249
    v_cvt_pk_bf16_f32 v101, v250, v251
    v_cvt_pk_bf16_f32 v102, v252, v253
    v_cvt_pk_bf16_f32 v103, v254, v255
    v_permlane16_swap_b32 v96, v98
    v_permlane16_swap_b32 v97, v99
    buffer_store_dwordx4 v[96:99], v25, s[56:59], 0 offen offset:0 nt
    v_permlane16_swap_b32 v100, v102
    v_permlane16_swap_b32 v101, v103
    buffer_store_dwordx4 v[100:103], v25, s[56:59], 0 offen offset:64 nt
    s_branch OUT_end
OR0:
    s_sub_u32 s77, s77, 1
    s_cbranch_scc1 OK0
    buffer_load_dwordx4 v[208:211], v8, s[52:55], 0 offen offset:0 sc1
    s_waitcnt vmcnt(0)
    s_branch OC0
OR1:
    s_sub_u32 s77, s77, 1
    s_cbranch_scc1 OK1
    buffer_load_dwordx4 v[212:215], v8, s[52:55], 0 offen offset:1024 sc1
    s_waitcnt vmcnt(0)
    s_branch OC1
OR2:
    s_sub_u32 s77, s77, 1
    s_cbranch_scc1 OK2
    buffer_load_dwordx4 v[216:219], v8, s[52:55], 0 offen offset:2048 sc1
    s_waitcnt vmcnt(0)
    s_branch OC2
OR3:
    s_sub_u32 s77, s77, 1
    s_cbranch_scc1 OK3
    buffer_load_dwordx4 v[220:223], v8, s[52:55], 0 offen offset:3072 sc1
    s_waitcnt vmcnt(0)
    s_branch OC3
OR4:
    s_sub_u32 s77, s77, 1
    s_cbranch_scc1 OK4
    buffer_load_dwordx4 v[224:227], v8, s[52:55], s74 offen offset:0 sc1
    s_waitcnt vmcnt(0)
    s_branch OC4
OR5:
    s_sub_u32 s77, s77, 1
    s_cbranch_scc1 OK5
    buffer_load_dwordx4 v[228:231], v8, s[52:55], s74 offen offset:1024 sc1
    s_waitcnt vmcnt(0)
    s_branch OC5
OR6:
    s_sub_u32 s77, s77, 1
    s_cbranch_scc1 OK6
    buffer_load_dwordx4 v[232:235], v8, s[52:55], s74 offen offset:2048 sc1
    s_waitcnt vmcnt(0)
    s_branch OC6
OR7:
    s_sub_u32 s77, s77, 1
    s_cbranch_scc1 OK7
    buffer_load_dwordx4 v[236:239], v8, s[52:55], s74 offen offset:3072 sc1
    s_waitcnt vmcnt(0)
    s_branch OC7
OR8:
    s_sub_u32 s77, s77, 1
    s_cbranch_scc1 OK8
    buffer_load_dwordx4 v[208:211], v8, s[52:55], s75 offen offset:0 sc1
    s_waitcnt vmcnt(0)
    s_branch OC8
OR9:
    s_sub_u32 s77, s77, 1
    s_cbranch_scc1 OK9
    buffer_load_dwordx4 v[212:215], v8, s[52:55], s75 offen offset:1024 sc1
    s_waitcnt vmcnt(0)
    s_branch OC9
OR10:
    s_sub_u32 s77, s77, 1
    s_cbranch_scc1 OK10
    buffer_load_dwordx4 v[216:219], v8, s[52:55], s75 offen offset:2048 sc1
    s_waitcnt vmcnt(0)
    s_branch OC10
OR11:
    s_sub_u32 s77, s77, 1
    s_cbranch_scc1 OK11
    buffer_load_dwordx4 v[220:223], v8, s[52:55], s75 offen offset:3072 sc1
    s_waitcnt vmcnt(0)
    s_branch OC11
OR12:
    s_sub_u32 s77, s77, 1
    s_cbranch_scc1 OK12
    buffer_load_dwordx4 v[224:227], v8, s[52:55], s76 offen offset:0 sc1
    s_waitcnt vmcnt(0)
    s_branch OC12
OR13:
    s_sub_u32 s77, s77, 1
    s_cbranch_scc1 OK13
    buffer_load_dwordx4 v[228:231], v8, s[52:55], s76 offen offset:1024 sc1
    s_waitcnt vmcnt(0)
    s_branch OC13
OR14:
    s_sub_u32 s77, s77, 1
    s_cbranch_scc1 OK14
    buffer_load_dwordx4 v[232:235], v8, s[52:55], s76 offen offset:2048 sc1
    s_waitcnt vmcnt(0)
    s_branch OC14
OR15:
    s_sub_u32 s77, s77, 1
    s_cbranch_scc1 OK15
    buffer_load_dwordx4 v[236:239], v8, s[52:55], s76 offen offset:3072 sc1
    s_waitcnt vmcnt(0)
    s_branch OC15
OR16:
    s_sub_u32 s77, s77, 1
    s_cbranch_scc1 OK16
    buffer_load_dwordx2 v[208:209], v9, s[52:55], 0 offen offset:0 sc1
    buffer_load_dwordx2 v[210:211], v9, s[52:55], 0 offen offset:128 sc1
    s_waitcnt vmcnt(0)
    s_branch OC16
OR17:
    s_sub_u32 s77, s77, 1
    s_cbranch_scc1 OK17
    buffer_load_dwordx2 v[212:213], v9, s[52:55], 0 offen offset:1024 sc1
    buffer_load_dwordx2 v[214:215], v9, s[52:55], 0 offen offset:1152 sc1
    s_waitcnt vmcnt(0)
    s_branch OC17
OUT_end:
    s_endpgm
Q_v0:
    v_mov_b32 v30, 0
    v_lshrrev_b32 v21, 1, v22
    v_xor_b32 v21, v21, v19
    v_lshlrev_b32 v21, 4, v21
    v_lshl_add_u32 v8, v22, 7, v21
    s_lshl_b32 s14, s68, 11
    v_add_u32 v8, s14, v8
    v_xor_b32 v9, 64, v8
    v_lshlrev_b32 v21, 1, v23
    v_lshl_add_u32 v21, v19, 3, v21
    v_mul_u32_u24 v21, 144, v21
    v_add_u32 v21, 61440, v21
    v_lshl_add_u32 v10, v24, 3, v21
    v_and_b32 v20, 1, v24
    v_mul_u32_u24 v20, 9216, v20
    v_add3_u32 v11, v21, v20, 64

    v_lshrrev_b32 v20, 1, v24
    v_mul_u32_u24 v20, 72, v20
    v_add_u32 v11, v11, v20
    v_subrev_u32 v11, 0, v11
    s_mul_i32 s14, s4, 10
    s_add_u32 s14, s14, s68
    s_mul_i32 s74, s14, 18432
    s_add_u32 s74, s74, 0x401000
    s_lshl_b32 s75, s5, 2
    s_add_u32 s75, s75, s13
    s_lshl_b32 s75, s75, 10
    s_add_u32 s75, s75, s74
    v_lshl_add_u32 v200, v2, 4, s75
    s_lshl_b32 s75, s5, 9
    s_add_u32 s75, s75, s74
    s_add_u32 s75, s75, 16384
    v_lshl_add_u32 v201, v2, 3, s75
    s_lshl_b32 s74, s3, 7
    s_add_u32 s74, s74, 0xdc000
    v_mov_b32 v202, s74

    s_add_u32 s66, s89, 1
    s_sub_u32 s15, s66, 3
    s_cmp_ge_u32 s66, 3
    s_cselect_b32 s66, s15, s66
    s_add_u32 s66, s66, 0
    s_mul_i32 s66, s66, 221184
    s_add_u32 s67, s66, s92
    s_add_u32 m0, s70, 36864
    s_mov_b32 exec_hi, 0x7fffffff
    buffer_load_dwordx4 v5, s[48:51], s67 offen lds
    s_mov_b64 exec, -1
    s_add_u32 m0, s70, 37872
    s_mov_b32 exec_hi, 0x7fffffff
    buffer_load_dwordx4 v6, s[48:51], s67 offen lds
    s_mov_b64 exec, -1
    s_add_u32 m0, s70, 38880
    s_mov_b64 exec, 0x3ffff
    buffer_load_dwordx4 v7, s[48:51], s67 offen lds
    s_mov_b64 exec, -1
    s_add_u32 s67, s66, s93
    s_add_u32 m0, s70, 46080
    s_mov_b32 exec_hi, 0x7fffffff
    buffer_load_dwordx4 v5, s[48:51], s67 offen lds
    s_mov_b64 exec, -1
    s_add_u32 m0, s70, 47088
    s_mov_b32 exec_hi, 0x7fffffff
    buffer_load_dwordx4 v6, s[48:51], s67 offen lds
    s_mov_b64 exec, -1
    s_add_u32 m0, s70, 48096
    s_mov_b64 exec, 0x3ffff
    buffer_load_dwordx4 v7, s[48:51], s67 offen lds
    s_mov_b64 exec, -1
    s_waitcnt vmcnt(6) lgkmcnt(0)
    s_barrier
    ds_read_b128 v[132:135], v8 offset:0
    ds_read_b128 v[136:139], v8 offset:2048
    ds_read_b128 v[140:143], v8 offset:4096
    ds_read_b64_tr_b16 v[32:33], v10 offset:18432
    ds_read_b64_tr_b16 v[34:35], v10 offset:18576
    ds_read_b64_tr_b16 v[36:37], v10 offset:18464
    ds_read_b64_tr_b16 v[38:39], v10 offset:18608
    ds_read_b64_tr_b16 v[40:41], v10 offset:27648
    ds_read_b64_tr_b16 v[42:43], v10 offset:27792
    ds_read_b64_tr_b16 v[44:45], v10 offset:27680
    ds_read_b64_tr_b16 v[46:47], v10 offset:27824
    ds_read_b64_tr_b16 v[48:49], v11 offset:18432
    ds_read_b64_tr_b16 v[50:51], v11 offset:18576
    s_waitcnt lgkmcnt(8)
    v_mfma_f32_16x16x32_bf16 v[72:75], v[32:35], v[132:135], 0
    ds_read_b128 v[144:147], v9 offset:0
    ds_read_b128 v[148:151], v9 offset:2048
    v_mfma_f32_16x16x32_bf16 v[76:79], v[32:35], v[136:139], 0
    ds_read_b128 v[152:155], v9 offset:4096
    v_mfma_f32_16x16x32_bf16 v[80:83], v[32:35], v[140:143], 0
    ds_read_b64_tr_b16 v[52:53], v10 offset:23040
    s_waitcnt lgkmcnt(10)
    v_mfma_f32_16x16x32_bf16 v[84:87], v[36:39], v[132:135], 0
    ds_read_b64_tr_b16 v[54:55], v10 offset:23184
    v_mfma_f32_16x16x32_bf16 v[88:91], v[36:39], v[136:139], 0
    ds_read_b64_tr_b16 v[56:57], v10 offset:23072
    v_mfma_f32_16x16x32_bf16 v[92:95], v[36:39], v[140:143], 0
    ds_read_b64_tr_b16 v[58:59], v10 offset:23216
    s_waitcnt lgkmcnt(11)
    v_mfma_f32_16x16x32_bf16 v[96:99], v[40:43], v[132:135], 0
    ds_read_b64_tr_b16 v[60:61], v10 offset:32256
    v_mfma_f32_16x16x32_bf16 v[100:103], v[40:43], v[136:139], 0
    ds_read_b64_tr_b16 v[62:63], v10 offset:32400
    v_mfma_f32_16x16x32_bf16 v[104:107], v[40:43], v[140:143], 0
    ds_read_b64_tr_b16 v[64:65], v10 offset:32288
    s_waitcnt lgkmcnt(12)
    v_mfma_f32_16x16x32_bf16 v[108:111], v[44:47], v[132:135], 0
    ds_read_b64_tr_b16 v[66:67], v10 offset:32432
    v_mfma_f32_16x16x32_bf16 v[112:115], v[44:47], v[136:139], 0
    ds_read_b64_tr_b16 v[68:69], v11 offset:23040
    v_mfma_f32_16x16x32_bf16 v[116:119], v[44:47], v[140:143], 0
    ds_read_b64_tr_b16 v[70:71], v11 offset:23184
    s_waitcnt lgkmcnt(13)
    v_mfma_f32_16x16x32_bf16 v[128:131], v[48:51], v[140:143], 0
    s_add_u32 s66, s89, 2
    s_sub_u32 s15, s66, 3
    s_cmp_ge_u32 s66, 3
    s_cselect_b32 s66, s15, s66
    s_add_u32 s66, s66, 0
    s_mul_i32 s66, s66, 221184
    s_add_u32 s67, s66, s92
    s_add_u32 m0, s70, 0
    s_mov_b32 exec_hi, 0x7fffffff
    buffer_load_dwordx4 v5, s[48:51], s67 offen lds
    s_mov_b64 exec, -1
    s_add_u32 m0, s70, 1008
    s_mov_b32 exec_hi, 0x7fffffff
    buffer_load_dwordx4 v6, s[48:51], s67 offen lds
    s_mov_b64 exec, -1
    s_add_u32 m0, s70, 2016
    s_mov_b64 exec, 0x3ffff
    buffer_load_dwordx4 v7, s[48:51], s67 offen lds
    s_mov_b64 exec, -1
    s_add_u32 s67, s66, s93
    s_add_u32 m0, s70, 9216
    s_mov_b32 exec_hi, 0x7fffffff
    buffer_load_dwordx4 v5, s[48:51], s67 offen lds
    s_mov_b64 exec, -1
    s_add_u32 m0, s70, 10224
    s_mov_b32 exec_hi, 0x7fffffff
    buffer_load_dwordx4 v6, s[48:51], s67 offen lds
    s_mov_b64 exec, -1
    s_add_u32 m0, s70, 11232
    s_mov_b64 exec, 0x3ffff
    buffer_load_dwordx4 v7, s[48:51], s67 offen lds
    s_mov_b64 exec, -1
    s_waitcnt vmcnt(6) lgkmcnt(0)
    s_barrier
    v_mfma_f32_16x16x32_bf16 v[72:75], v[52:55], v[144:147], v[72:75]
    ds_read_b128 v[132:135], v8 offset:20480
    ds_read_b128 v[136:139], v8 offset:22528
    v_mfma_f32_16x16x32_bf16 v[76:79], v[52:55], v[148:151], v[76:79]
    ds_read_b128 v[140:143], v8 offset:24576
    v_mfma_f32_16x16x32_bf16 v[80:83], v[52:55], v[152:155], v[80:83]
    ds_read_b64_tr_b16 v[32:33], v10 offset:36864
    v_mfma_f32_16x16x32_bf16 v[84:87], v[56:59], v[144:147], v[84:87]
    ds_read_b64_tr_b16 v[34:35], v10 offset:37008
    v_mfma_f32_16x16x32_bf16 v[88:91], v[56:59], v[148:151], v[88:91]
    ds_read_b64_tr_b16 v[36:37], v10 offset:36896
    v_mfma_f32_16x16x32_bf16 v[92:95], v[56:59], v[152:155], v[92:95]
    ds_read_b64_tr_b16 v[38:39], v10 offset:37040
    v_mfma_f32_16x16x32_bf16 v[96:99], v[60:63], v[144:147], v[96:99]
    ds_read_b64_tr_b16 v[40:41], v10 offset:46080
    v_mfma_f32_16x16x32_bf16 v[100:103], v[60:63], v[148:151], v[100:103]
    ds_read_b64_tr_b16 v[42:43], v10 offset:46224
    v_mfma_f32_16x16x32_bf16 v[104:107], v[60:63], v[152:155], v[104:107]
    ds_read_b64_tr_b16 v[44:45], v10 offset:46112
    v_mfma_f32_16x16x32_bf16 v[108:111], v[64:67], v[144:147], v[108:111]
    ds_read_b64_tr_b16 v[46:47], v10 offset:46256
    v_mfma_f32_16x16x32_bf16 v[112:115], v[64:67], v[148:151], v[112:115]
    ds_read_b64_tr_b16 v[48:49], v11 offset:36864
    v_mfma_f32_16x16x32_bf16 v[116:119], v[64:67], v[152:155], v[116:119]
    ds_read_b64_tr_b16 v[50:51], v11 offset:37008
    v_mfma_f32_16x16x32_bf16 v[128:131], v[68:71], v[152:155], v[128:131]
    s_waitcnt lgkmcnt(8)
    v_mfma_f32_16x16x32_bf16 v[72:75], v[32:35], v[132:135], v[72:75]
    ds_read_b128 v[144:147], v9 offset:20480
    ds_read_b128 v[148:151], v9 offset:22528
    v_mfma_f32_16x16x32_bf16 v[76:79], v[32:35], v[136:139], v[76:79]
    ds_read_b128 v[152:155], v9 offset:24576
    v_mfma_f32_16x16x32_bf16 v[80:83], v[32:35], v[140:143], v[80:83]
    ds_read_b64_tr_b16 v[52:53], v10 offset:41472
    s_waitcnt lgkmcnt(10)
    v_mfma_f32_16x16x32_bf16 v[84:87], v[36:39], v[132:135], v[84:87]
    ds_read_b64_tr_b16 v[54:55], v10 offset:41616
    v_mfma_f32_16x16x32_bf16 v[88:91], v[36:39], v[136:139], v[88:91]
    ds_read_b64_tr_b16 v[56:57], v10 offset:41504
    v_mfma_f32_16x16x32_bf16 v[92:95], v[36:39], v[140:143], v[92:95]
    ds_read_b64_tr_b16 v[58:59], v10 offset:41648
    s_waitcnt lgkmcnt(11)
    v_mfma_f32_16x16x32_bf16 v[96:99], v[40:43], v[132:135], v[96:99]
    ds_read_b64_tr_b16 v[60:61], v10 offset:50688
    v_mfma_f32_16x16x32_bf16 v[100:103], v[40:43], v[136:139], v[100:103]
    ds_read_b64_tr_b16 v[62:63], v10 offset:50832
    v_mfma_f32_16x16x32_bf16 v[104:107], v[40:43], v[140:143], v[104:107]
    ds_read_b64_tr_b16 v[64:65], v10 offset:50720
    s_waitcnt lgkmcnt(12)
    v_mfma_f32_16x16x32_bf16 v[108:111], v[44:47], v[132:135], v[108:111]
    ds_read_b64_tr_b16 v[66:67], v10 offset:50864
    v_mfma_f32_16x16x32_bf16 v[112:115], v[44:47], v[136:139], v[112:115]
    ds_read_b64_tr_b16 v[68:69], v11 offset:41472
    v_mfma_f32_16x16x32_bf16 v[116:119], v[44:47], v[140:143], v[116:119]
    ds_read_b64_tr_b16 v[70:71], v11 offset:41616
    s_waitcnt lgkmcnt(13)
    v_mfma_f32_16x16x32_bf16 v[128:131], v[48:51], v[140:143], v[128:131]
    s_add_u32 s66, s89, 0
    s_sub_u32 s15, s66, 3
    s_cmp_ge_u32 s66, 3
    s_cselect_b32 s66, s15, s66
    s_add_u32 s66, s66, 3
    s_mul_i32 s66, s66, 221184
    s_add_u32 s67, s66, s92
    s_add_u32 m0, s70, 18432
    s_mov_b32 exec_hi, 0x7fffffff
    buffer_load_dwordx4 v5, s[48:51], s67 offen lds
    s_mov_b64 exec, -1
    s_add_u32 m0, s70, 19440
    s_mov_b32 exec_hi, 0x7fffffff
    buffer_load_dwordx4 v6, s[48:51], s67 offen lds
    s_mov_b64 exec, -1
    s_add_u32 m0, s70, 20448
    s_mov_b64 exec, 0x3ffff
    buffer_load_dwordx4 v7, s[48:51], s67 offen lds
    s_mov_b64 exec, -1
    s_add_u32 s67, s66, s93
    s_add_u32 m0, s70, 27648
    s_mov_b32 exec_hi, 0x7fffffff
    buffer_load_dwordx4 v5, s[48:51], s67 offen lds
    s_mov_b64 exec, -1
    s_add_u32 m0, s70, 28656
    s_mov_b32 exec_hi, 0x7fffffff
    buffer_load_dwordx4 v6, s[48:51], s67 offen lds
    s_mov_b64 exec, -1
    s_add_u32 m0, s70, 29664
    s_mov_b64 exec, 0x3ffff
    buffer_load_dwordx4 v7, s[48:51], s67 offen lds
    s_mov_b64 exec, -1
    s_waitcnt vmcnt(6) lgkmcnt(0)
    s_barrier
    v_mfma_f32_16x16x32_bf16 v[72:75], v[52:55], v[144:147], v[72:75]
    ds_read_b128 v[132:135], v8 offset:40960
    ds_read_b128 v[136:139], v8 offset:43008
    v_mfma_f32_16x16x32_bf16 v[76:79], v[52:55], v[148:151], v[76:79]
    ds_read_b128 v[140:143], v8 offset:45056
    v_mfma_f32_16x16x32_bf16 v[80:83], v[52:55], v[152:155], v[80:83]
    ds_read_b64_tr_b16 v[32:33], v10 offset:0
    v_mfma_f32_16x16x32_bf16 v[84:87], v[56:59], v[144:147], v[84:87]
    ds_read_b64_tr_b16 v[34:35], v10 offset:144
    v_mfma_f32_16x16x32_bf16 v[88:91], v[56:59], v[148:151], v[88:91]
    ds_read_b64_tr_b16 v[36:37], v10 offset:32
    v_mfma_f32_16x16x32_bf16 v[92:95], v[56:59], v[152:155], v[92:95]
    ds_read_b64_tr_b16 v[38:39], v10 offset:176
    v_mfma_f32_16x16x32_bf16 v[96:99], v[60:63], v[144:147], v[96:99]
    ds_read_b64_tr_b16 v[40:41], v10 offset:9216
    v_mfma_f32_16x16x32_bf16 v[100:103], v[60:63], v[148:151], v[100:103]
    ds_read_b64_tr_b16 v[42:43], v10 offset:9360
    v_mfma_f32_16x16x32_bf16 v[104:107], v[60:63], v[152:155], v[104:107]
    ds_read_b64_tr_b16 v[44:45], v10 offset:9248
    v_mfma_f32_16x16x32_bf16 v[108:111], v[64:67], v[144:147], v[108:111]
    ds_read_b64_tr_b16 v[46:47], v10 offset:9392
    v_mfma_f32_16x16x32_bf16 v[112:115], v[64:67], v[148:151], v[112:115]
    ds_read_b64_tr_b16 v[48:49], v11 offset:0
    v_mfma_f32_16x16x32_bf16 v[116:119], v[64:67], v[152:155], v[116:119]
    ds_read_b64_tr_b16 v[50:51], v11 offset:144
    v_mfma_f32_16x16x32_bf16 v[128:131], v[68:71], v[152:155], v[128:131]
    s_waitcnt lgkmcnt(8)
    v_mfma_f32_16x16x32_bf16 v[72:75], v[32:35], v[132:135], v[72:75]
    ds_read_b128 v[144:147], v9 offset:40960
    ds_read_b128 v[148:151], v9 offset:43008
    v_mfma_f32_16x16x32_bf16 v[76:79], v[32:35], v[136:139], v[76:79]
    ds_read_b128 v[152:155], v9 offset:45056
    v_mfma_f32_16x16x32_bf16 v[80:83], v[32:35], v[140:143], v[80:83]
    ds_read_b64_tr_b16 v[52:53], v10 offset:4608
    s_waitcnt lgkmcnt(10)
    v_mfma_f32_16x16x32_bf16 v[84:87], v[36:39], v[132:135], v[84:87]
    ds_read_b64_tr_b16 v[54:55], v10 offset:4752
    v_mfma_f32_16x16x32_bf16 v[88:91], v[36:39], v[136:139], v[88:91]
    ds_read_b64_tr_b16 v[56:57], v10 offset:4640
    v_mfma_f32_16x16x32_bf16 v[92:95], v[36:39], v[140:143], v[92:95]
    ds_read_b64_tr_b16 v[58:59], v10 offset:4784
    s_waitcnt lgkmcnt(11)
    v_mfma_f32_16x16x32_bf16 v[96:99], v[40:43], v[132:135], v[96:99]
    ds_read_b64_tr_b16 v[60:61], v10 offset:13824
    v_mfma_f32_16x16x32_bf16 v[100:103], v[40:43], v[136:139], v[100:103]
    ds_read_b64_tr_b16 v[62:63], v10 offset:13968
    v_mfma_f32_16x16x32_bf16 v[104:107], v[40:43], v[140:143], v[104:107]
    ds_read_b64_tr_b16 v[64:65], v10 offset:13856
    s_waitcnt lgkmcnt(12)
    v_mfma_f32_16x16x32_bf16 v[108:111], v[44:47], v[132:135], v[108:111]
    ds_read_b64_tr_b16 v[66:67], v10 offset:14000
    v_mfma_f32_16x16x32_bf16 v[112:115], v[44:47], v[136:139], v[112:115]
    ds_read_b64_tr_b16 v[68:69], v11 offset:4608
    v_mfma_f32_16x16x32_bf16 v[116:119], v[44:47], v[140:143], v[116:119]
    ds_read_b64_tr_b16 v[70:71], v11 offset:4752
    s_waitcnt lgkmcnt(13)
    v_mfma_f32_16x16x32_bf16 v[128:131], v[48:51], v[140:143], v[128:131]
    s_add_u32 s66, s89, 1
    s_sub_u32 s15, s66, 3
    s_cmp_ge_u32 s66, 3
    s_cselect_b32 s66, s15, s66
    s_add_u32 s66, s66, 3
    s_mul_i32 s66, s66, 221184
    s_add_u32 s67, s66, s92
    s_add_u32 m0, s70, 36864
    s_mov_b32 exec_hi, 0x7fffffff
    buffer_load_dwordx4 v5, s[48:51], s67 offen lds
    s_mov_b64 exec, -1
    s_add_u32 m0, s70, 37872
    s_mov_b32 exec_hi, 0x7fffffff
    buffer_load_dwordx4 v6, s[48:51], s67 offen lds
    s_mov_b64 exec, -1
    s_add_u32 m0, s70, 38880
    s_mov_b64 exec, 0x3ffff
    buffer_load_dwordx4 v7, s[48:51], s67 offen lds
    s_mov_b64 exec, -1
    s_add_u32 s67, s66, s93
    s_add_u32 m0, s70, 46080
    s_mov_b32 exec_hi, 0x7fffffff
    buffer_load_dwordx4 v5, s[48:51], s67 offen lds
    s_mov_b64 exec, -1
    s_add_u32 m0, s70, 47088
    s_mov_b32 exec_hi, 0x7fffffff
    buffer_load_dwordx4 v6, s[48:51], s67 offen lds
    s_mov_b64 exec, -1
    s_add_u32 m0, s70, 48096
    s_mov_b64 exec, 0x3ffff
    buffer_load_dwordx4 v7, s[48:51], s67 offen lds
    s_mov_b64 exec, -1
    s_waitcnt vmcnt(6) lgkmcnt(0)
    s_barrier
    v_mfma_f32_16x16x32_bf16 v[72:75], v[52:55], v[144:147], v[72:75]
    ds_read_b128 v[132:135], v8 offset:0
    ds_read_b128 v[136:139], v8 offset:2048
    v_mfma_f32_16x16x32_bf16 v[76:79], v[52:55], v[148:151], v[76:79]
    ds_read_b128 v[140:143], v8 offset:4096
    v_mfma_f32_16x16x32_bf16 v[80:83], v[52:55], v[152:155], v[80:83]
    ds_read_b64_tr_b16 v[32:33], v10 offset:18432
    v_mfma_f32_16x16x32_bf16 v[84:87], v[56:59], v[144:147], v[84:87]
    ds_read_b64_tr_b16 v[34:35], v10 offset:18576
    v_mfma_f32_16x16x32_bf16 v[88:91], v[56:59], v[148:151], v[88:91]
    ds_read_b64_tr_b16 v[36:37], v10 offset:18464
    v_mfma_f32_16x16x32_bf16 v[92:95], v[56:59], v[152:155], v[92:95]
    ds_read_b64_tr_b16 v[38:39], v10 offset:18608
    v_mfma_f32_16x16x32_bf16 v[96:99], v[60:63], v[144:147], v[96:99]
    ds_read_b64_tr_b16 v[40:41], v10 offset:27648
    v_mfma_f32_16x16x32_bf16 v[100:103], v[60:63], v[148:151], v[100:103]
    ds_read_b64_tr_b16 v[42:43], v10 offset:27792
    v_mfma_f32_16x16x32_bf16 v[104:107], v[60:63], v[152:155], v[104:107]
    ds_read_b64_tr_b16 v[44:45], v10 offset:27680
    v_mfma_f32_16x16x32_bf16 v[108:111], v[64:67], v[144:147], v[108:111]
    ds_read_b64_tr_b16 v[46:47], v10 offset:27824
    v_mfma_f32_16x16x32_bf16 v[112:115], v[64:67], v[148:151], v[112:115]
    ds_read_b64_tr_b16 v[48:49], v11 offset:18432
    v_mfma_f32_16x16x32_bf16 v[116:119], v[64:67], v[152:155], v[116:119]
    ds_read_b64_tr_b16 v[50:51], v11 offset:18576
    v_mfma_f32_16x16x32_bf16 v[128:131], v[68:71], v[152:155], v[128:131]
    s_waitcnt lgkmcnt(8)
    v_mfma_f32_16x16x32_bf16 v[72:75], v[32:35], v[132:135], v[72:75]
    ds_read_b128 v[144:147], v9 offset:0
    ds_read_b128 v[148:151], v9 offset:2048
    v_mfma_f32_16x16x32_bf16 v[76:79], v[32:35], v[136:139], v[76:79]
    ds_read_b128 v[152:155], v9 offset:4096
    v_mfma_f32_16x16x32_bf16 v[80:83], v[32:35], v[140:143], v[80:83]
    ds_read_b64_tr_b16 v[52:53], v10 offset:23040
    s_waitcnt lgkmcnt(10)
    v_mfma_f32_16x16x32_bf16 v[84:87], v[36:39], v[132:135], v[84:87]
    ds_read_b64_tr_b16 v[54:55], v10 offset:23184
    v_mfma_f32_16x16x32_bf16 v[88:91], v[36:39], v[136:139], v[88:91]
    ds_read_b64_tr_b16 v[56:57], v10 offset:23072
    v_mfma_f32_16x16x32_bf16 v[92:95], v[36:39], v[140:143], v[92:95]
    ds_read_b64_tr_b16 v[58:59], v10 offset:23216
    s_waitcnt lgkmcnt(11)
    v_mfma_f32_16x16x32_bf16 v[96:99], v[40:43], v[132:135], v[96:99]
    ds_read_b64_tr_b16 v[60:61], v10 offset:32256
    v_mfma_f32_16x16x32_bf16 v[100:103], v[40:43], v[136:139], v[100:103]
    ds_read_b64_tr_b16 v[62:63], v10 offset:32400
    v_mfma_f32_16x16x32_bf16 v[104:107], v[40:43], v[140:143], v[104:107]
    ds_read_b64_tr_b16 v[64:65], v10 offset:32288
    s_waitcnt lgkmcnt(12)
    v_mfma_f32_16x16x32_bf16 v[108:111], v[44:47], v[132:135], v[108:111]
    ds_read_b64_tr_b16 v[66:67], v10 offset:32432
    v_mfma_f32_16x16x32_bf16 v[112:115], v[44:47], v[136:139], v[112:115]
    ds_read_b64_tr_b16 v[68:69], v11 offset:23040
    v_mfma_f32_16x16x32_bf16 v[116:119], v[44:47], v[140:143], v[116:119]
    ds_read_b64_tr_b16 v[70:71], v11 offset:23184
    s_waitcnt lgkmcnt(13)
    v_mfma_f32_16x16x32_bf16 v[128:131], v[48:51], v[140:143], v[128:131]
    s_add_u32 s66, s89, 2
    s_sub_u32 s15, s66, 3
    s_cmp_ge_u32 s66, 3
    s_cselect_b32 s66, s15, s66
    s_add_u32 s66, s66, 3
    s_mul_i32 s66, s66, 221184
    s_add_u32 s67, s66, s92
    s_add_u32 m0, s70, 0
    s_mov_b32 exec_hi, 0x7fffffff
    buffer_load_dwordx4 v5, s[48:51], s67 offen lds
    s_mov_b64 exec, -1
    s_add_u32 m0, s70, 1008
    s_mov_b32 exec_hi, 0x7fffffff
    buffer_load_dwordx4 v6, s[48:51], s67 offen lds
    s_mov_b64 exec, -1
    s_add_u32 m0, s70, 2016
    s_mov_b64 exec, 0x3ffff
    buffer_load_dwordx4 v7, s[48:51], s67 offen lds
    s_mov_b64 exec, -1
    s_add_u32 s67, s66, s93
    s_add_u32 m0, s70, 9216
    s_mov_b32 exec_hi, 0x7fffffff
    buffer_load_dwordx4 v5, s[48:51], s67 offen lds
    s_mov_b64 exec, -1
    s_add_u32 m0, s70, 10224
    s_mov_b32 exec_hi, 0x7fffffff
    buffer_load_dwordx4 v6, s[48:51], s67 offen lds
    s_mov_b64 exec, -1
    s_add_u32 m0, s70, 11232
    s_mov_b64 exec, 0x3ffff
    buffer_load_dwordx4 v7, s[48:51], s67 offen lds
    s_mov_b64 exec, -1
    s_waitcnt vmcnt(6) lgkmcnt(0)
    s_barrier
    v_mfma_f32_16x16x32_bf16 v[72:75], v[52:55], v[144:147], v[72:75]
    ds_read_b128 v[132:135], v8 offset:20480
    ds_read_b128 v[136:139], v8 offset:22528
    v_mfma_f32_16x16x32_bf16 v[76:79], v[52:55], v[148:151], v[76:79]
    ds_read_b128 v[140:143], v8 offset:24576
    v_mfma_f32_16x16x32_bf16 v[80:83], v[52:55], v[152:155], v[80:83]
    ds_read_b64_tr_b16 v[32:33], v10 offset:36864
    v_mfma_f32_16x16x32_bf16 v[84:87], v[56:59], v[144:147], v[84:87]
    ds_read_b64_tr_b16 v[34:35], v10 offset:37008
    v_mfma_f32_16x16x32_bf16 v[88:91], v[56:59], v[148:151], v[88:91]
    ds_read_b64_tr_b16 v[36:37], v10 offset:36896
    v_mfma_f32_16x16x32_bf16 v[92:95], v[56:59], v[152:155], v[92:95]
    ds_read_b64_tr_b16 v[38:39], v10 offset:37040
    v_mfma_f32_16x16x32_bf16 v[96:99], v[60:63], v[144:147], v[96:99]
    ds_read_b64_tr_b16 v[40:41], v10 offset:46080
    v_mfma_f32_16x16x32_bf16 v[100:103], v[60:63], v[148:151], v[100:103]
    ds_read_b64_tr_b16 v[42:43], v10 offset:46224
    v_mfma_f32_16x16x32_bf16 v[104:107], v[60:63], v[152:155], v[104:107]
    ds_read_b64_tr_b16 v[44:45], v10 offset:46112
    v_mfma_f32_16x16x32_bf16 v[108:111], v[64:67], v[144:147], v[108:111]
    ds_read_b64_tr_b16 v[46:47], v10 offset:46256
    v_mfma_f32_16x16x32_bf16 v[112:115], v[64:67], v[148:151], v[112:115]
    ds_read_b64_tr_b16 v[48:49], v11 offset:36864
    v_mfma_f32_16x16x32_bf16 v[116:119], v[64:67], v[152:155], v[116:119]
    ds_read_b64_tr_b16 v[50:51], v11 offset:37008
    v_mfma_f32_16x16x32_bf16 v[128:131], v[68:71], v[152:155], v[128:131]
    s_waitcnt lgkmcnt(8)
    v_mfma_f32_16x16x32_bf16 v[72:75], v[32:35], v[132:135], v[72:75]
    ds_read_b128 v[144:147], v9 offset:20480
    ds_read_b128 v[148:151], v9 offset:22528
    v_mfma_f32_16x16x32_bf16 v[76:79], v[32:35], v[136:139], v[76:79]
    ds_read_b128 v[152:155], v9 offset:24576
    v_mfma_f32_16x16x32_bf16 v[80:83], v[32:35], v[140:143], v[80:83]
    ds_read_b64_tr_b16 v[52:53], v10 offset:41472
    s_waitcnt lgkmcnt(10)
    v_mfma_f32_16x16x32_bf16 v[84:87], v[36:39], v[132:135], v[84:87]
    ds_read_b64_tr_b16 v[54:55], v10 offset:41616
    v_mfma_f32_16x16x32_bf16 v[88:91], v[36:39], v[136:139], v[88:91]
    ds_read_b64_tr_b16 v[56:57], v10 offset:41504
    v_mfma_f32_16x16x32_bf16 v[92:95], v[36:39], v[140:143], v[92:95]
    ds_read_b64_tr_b16 v[58:59], v10 offset:41648
    s_waitcnt lgkmcnt(11)
    v_mfma_f32_16x16x32_bf16 v[96:99], v[40:43], v[132:135], v[96:99]
    ds_read_b64_tr_b16 v[60:61], v10 offset:50688
    v_mfma_f32_16x16x32_bf16 v[100:103], v[40:43], v[136:139], v[100:103]
    ds_read_b64_tr_b16 v[62:63], v10 offset:50832
    v_mfma_f32_16x16x32_bf16 v[104:107], v[40:43], v[140:143], v[104:107]
    ds_read_b64_tr_b16 v[64:65], v10 offset:50720
    s_waitcnt lgkmcnt(12)
    v_mfma_f32_16x16x32_bf16 v[108:111], v[44:47], v[132:135], v[108:111]
    ds_read_b64_tr_b16 v[66:67], v10 offset:50864
    v_mfma_f32_16x16x32_bf16 v[112:115], v[44:47], v[136:139], v[112:115]
    ds_read_b64_tr_b16 v[68:69], v11 offset:41472
    v_mfma_f32_16x16x32_bf16 v[116:119], v[44:47], v[140:143], v[116:119]
    ds_read_b64_tr_b16 v[70:71], v11 offset:41616
    s_waitcnt lgkmcnt(13)
    v_mfma_f32_16x16x32_bf16 v[128:131], v[48:51], v[140:143], v[128:131]
    s_add_u32 s66, s89, 0
    s_sub_u32 s15, s66, 3
    s_cmp_ge_u32 s66, 3
    s_cselect_b32 s66, s15, s66
    s_add_u32 s66, s66, 6
    s_mul_i32 s66, s66, 221184
    s_add_u32 s67, s66, s92
    s_add_u32 m0, s70, 18432
    s_mov_b32 exec_hi, 0x7fffffff
    buffer_load_dwordx4 v5, s[48:51], s67 offen lds
    s_mov_b64 exec, -1
    s_add_u32 m0, s70, 19440
    s_mov_b32 exec_hi, 0x7fffffff
    buffer_load_dwordx4 v6, s[48:51], s67 offen lds
    s_mov_b64 exec, -1
    s_add_u32 m0, s70, 20448
    s_mov_b64 exec, 0x3ffff
    buffer_load_dwordx4 v7, s[48:51], s67 offen lds
    s_mov_b64 exec, -1
    s_add_u32 s67, s66, s93
    s_add_u32 m0, s70, 27648
    s_mov_b32 exec_hi, 0x7fffffff
    buffer_load_dwordx4 v5, s[48:51], s67 offen lds
    s_mov_b64 exec, -1
    s_add_u32 m0, s70, 28656
    s_mov_b32 exec_hi, 0x7fffffff
    buffer_load_dwordx4 v6, s[48:51], s67 offen lds
    s_mov_b64 exec, -1
    s_add_u32 m0, s70, 29664
    s_mov_b64 exec, 0x3ffff
    buffer_load_dwordx4 v7, s[48:51], s67 offen lds
    s_mov_b64 exec, -1
    s_waitcnt vmcnt(6) lgkmcnt(0)
    s_barrier
    v_mfma_f32_16x16x32_bf16 v[72:75], v[52:55], v[144:147], v[72:75]
    ds_read_b128 v[132:135], v8 offset:40960
    ds_read_b128 v[136:139], v8 offset:43008
    v_mfma_f32_16x16x32_bf16 v[76:79], v[52:55], v[148:151], v[76:79]
    ds_read_b128 v[140:143], v8 offset:45056
    v_mfma_f32_16x16x32_bf16 v[80:83], v[52:55], v[152:155], v[80:83]
    ds_read_b64_tr_b16 v[32:33], v10 offset:0
    v_mfma_f32_16x16x32_bf16 v[84:87], v[56:59], v[144:147], v[84:87]
    ds_read_b64_tr_b16 v[34:35], v10 offset:144
    v_mfma_f32_16x16x32_bf16 v[88:91], v[56:59], v[148:151], v[88:91]
    ds_read_b64_tr_b16 v[36:37], v10 offset:32
    v_mfma_f32_16x16x32_bf16 v[92:95], v[56:59], v[152:155], v[92:95]
    ds_read_b64_tr_b16 v[38:39], v10 offset:176
    v_mfma_f32_16x16x32_bf16 v[96:99], v[60:63], v[144:147], v[96:99]
    ds_read_b64_tr_b16 v[40:41], v10 offset:9216
    v_mfma_f32_16x16x32_bf16 v[100:103], v[60:63], v[148:151], v[100:103]
    ds_read_b64_tr_b16 v[42:43], v10 offset:9360
    v_mfma_f32_16x16x32_bf16 v[104:107], v[60:63], v[152:155], v[104:107]
    ds_read_b64_tr_b16 v[44:45], v10 offset:9248
    v_mfma_f32_16x16x32_bf16 v[108:111], v[64:67], v[144:147], v[108:111]
    ds_read_b64_tr_b16 v[46:47], v10 offset:9392
    v_mfma_f32_16x16x32_bf16 v[112:115], v[64:67], v[148:151], v[112:115]
    ds_read_b64_tr_b16 v[48:49], v11 offset:0
    v_mfma_f32_16x16x32_bf16 v[116:119], v[64:67], v[152:155], v[116:119]
    ds_read_b64_tr_b16 v[50:51], v11 offset:144
    v_mfma_f32_16x16x32_bf16 v[128:131], v[68:71], v[152:155], v[128:131]
    s_waitcnt lgkmcnt(8)
    v_mfma_f32_16x16x32_bf16 v[72:75], v[32:35], v[132:135], v[72:75]
    ds_read_b128 v[144:147], v9 offset:40960
    ds_read_b128 v[148:151], v9 offset:43008
    v_mfma_f32_16x16x32_bf16 v[76:79], v[32:35], v[136:139], v[76:79]
    ds_read_b128 v[152:155], v9 offset:45056
    v_mfma_f32_16x16x32_bf16 v[80:83], v[32:35], v[140:143], v[80:83]
    ds_read_b64_tr_b16 v[52:53], v10 offset:4608
    s_waitcnt lgkmcnt(10)
    v_mfma_f32_16x16x32_bf16 v[84:87], v[36:39], v[132:135], v[84:87]
    ds_read_b64_tr_b16 v[54:55], v10 offset:4752
    v_mfma_f32_16x16x32_bf16 v[88:91], v[36:39], v[136:139], v[88:91]
    ds_read_b64_tr_b16 v[56:57], v10 offset:4640
    v_mfma_f32_16x16x32_bf16 v[92:95], v[36:39], v[140:143], v[92:95]
    ds_read_b64_tr_b16 v[58:59], v10 offset:4784
    s_waitcnt lgkmcnt(11)
    v_mfma_f32_16x16x32_bf16 v[96:99], v[40:43], v[132:135], v[96:99]
    ds_read_b64_tr_b16 v[60:61], v10 offset:13824
    v_mfma_f32_16x16x32_bf16 v[100:103], v[40:43], v[136:139], v[100:103]
    ds_read_b64_tr_b16 v[62:63], v10 offset:13968
    v_mfma_f32_16x16x32_bf16 v[104:107], v[40:43], v[140:143], v[104:107]
    ds_read_b64_tr_b16 v[64:65], v10 offset:13856
    s_waitcnt lgkmcnt(12)
    v_mfma_f32_16x16x32_bf16 v[108:111], v[44:47], v[132:135], v[108:111]
    ds_read_b64_tr_b16 v[66:67], v10 offset:14000
    v_mfma_f32_16x16x32_bf16 v[112:115], v[44:47], v[136:139], v[112:115]
    ds_read_b64_tr_b16 v[68:69], v11 offset:4608
    v_mfma_f32_16x16x32_bf16 v[116:119], v[44:47], v[140:143], v[116:119]
    ds_read_b64_tr_b16 v[70:71], v11 offset:4752
    s_waitcnt lgkmcnt(13)
    v_mfma_f32_16x16x32_bf16 v[128:131], v[48:51], v[140:143], v[128:131]
    s_add_u32 s66, s89, 1
    s_sub_u32 s15, s66, 3
    s_cmp_ge_u32 s66, 3
    s_cselect_b32 s66, s15, s66
    s_add_u32 s66, s66, 6
    s_mul_i32 s66, s66, 221184
    s_add_u32 s67, s66, s92
    s_add_u32 m0, s70, 36864
    s_mov_b32 exec_hi, 0x7fffffff
    buffer_load_dwordx4 v5, s[48:51], s67 offen lds
    s_mov_b64 exec, -1
    s_add_u32 m0, s70, 37872
    s_mov_b32 exec_hi, 0x7fffffff
    buffer_load_dwordx4 v6, s[48:51], s67 offen lds
    s_mov_b64 exec, -1
    s_add_u32 m0, s70, 38880
    s_mov_b64 exec, 0x3ffff
    buffer_load_dwordx4 v7, s[48:51], s67 offen lds
    s_mov_b64 exec, -1
    s_add_u32 s67, s66, s93
    s_add_u32 m0, s70, 46080
    s_mov_b32 exec_hi, 0x7fffffff
    buffer_load_dwordx4 v5, s[48:51], s67 offen lds
    s_mov_b64 exec, -1
    s_add_u32 m0, s70, 47088
    s_mov_b32 exec_hi, 0x7fffffff
    buffer_load_dwordx4 v6, s[48:51], s67 offen lds
    s_mov_b64 exec, -1
    s_add_u32 m0, s70, 48096
    s_mov_b64 exec, 0x3ffff
    buffer_load_dwordx4 v7, s[48:51], s67 offen lds
    s_mov_b64 exec, -1
    s_waitcnt vmcnt(6) lgkmcnt(0)
    s_barrier
    global_load_dword v18, v30, s[40:41] sc1
    v_mfma_f32_16x16x32_bf16 v[72:75], v[52:55], v[144:147], v[72:75]
    ds_read_b128 v[132:135], v8 offset:0
    ds_read_b128 v[136:139], v8 offset:2048
    v_mfma_f32_16x16x32_bf16 v[76:79], v[52:55], v[148:151], v[76:79]
    ds_read_b128 v[140:143], v8 offset:4096
    v_mfma_f32_16x16x32_bf16 v[80:83], v[52:55], v[152:155], v[80:83]
    ds_read_b64_tr_b16 v[32:33], v10 offset:18432
    v_mfma_f32_16x16x32_bf16 v[84:87], v[56:59], v[144:147], v[84:87]
    ds_read_b64_tr_b16 v[34:35], v10 offset:18576
    v_mfma_f32_16x16x32_bf16 v[88:91], v[56:59], v[148:151], v[88:91]
    ds_read_b64_tr_b16 v[36:37], v10 offset:18464
    v_mfma_f32_16x16x32_bf16 v[92:95], v[56:59], v[152:155], v[92:95]
    ds_read_b64_tr_b16 v[38:39], v10 offset:18608
    v_mfma_f32_16x16x32_bf16 v[96:99], v[60:63], v[144:147], v[96:99]
    ds_read_b64_tr_b16 v[40:41], v10 offset:27648
    v_mfma_f32_16x16x32_bf16 v[100:103], v[60:63], v[148:151], v[100:103]
    ds_read_b64_tr_b16 v[42:43], v10 offset:27792
    v_mfma_f32_16x16x32_bf16 v[104:107], v[60:63], v[152:155], v[104:107]
    ds_read_b64_tr_b16 v[44:45], v10 offset:27680
    v_mfma_f32_16x16x32_bf16 v[108:111], v[64:67], v[144:147], v[108:111]
    ds_read_b64_tr_b16 v[46:47], v10 offset:27824
    v_mfma_f32_16x16x32_bf16 v[112:115], v[64:67], v[148:151], v[112:115]
    ds_read_b64_tr_b16 v[48:49], v11 offset:18432
    v_mfma_f32_16x16x32_bf16 v[116:119], v[64:67], v[152:155], v[116:119]
    ds_read_b64_tr_b16 v[50:51], v11 offset:18576
    v_mfma_f32_16x16x32_bf16 v[128:131], v[68:71], v[152:155], v[128:131]
    s_waitcnt lgkmcnt(8)
    v_mfma_f32_16x16x32_bf16 v[72:75], v[32:35], v[132:135], v[72:75]
    ds_read_b128 v[144:147], v9 offset:0
    ds_read_b128 v[148:151], v9 offset:2048
    v_mfma_f32_16x16x32_bf16 v[76:79], v[32:35], v[136:139], v[76:79]
    ds_read_b128 v[152:155], v9 offset:4096
    v_mfma_f32_16x16x32_bf16 v[80:83], v[32:35], v[140:143], v[80:83]
    ds_read_b64_tr_b16 v[52:53], v10 offset:23040
    s_waitcnt lgkmcnt(10)
    v_mfma_f32_16x16x32_bf16 v[84:87], v[36:39], v[132:135], v[84:87]
    ds_read_b64_tr_b16 v[54:55], v10 offset:23184
    v_mfma_f32_16x16x32_bf16 v[88:91], v[36:39], v[136:139], v[88:91]
    ds_read_b64_tr_b16 v[56:57], v10 offset:23072
    v_mfma_f32_16x16x32_bf16 v[92:95], v[36:39], v[140:143], v[92:95]
    ds_read_b64_tr_b16 v[58:59], v10 offset:23216
    s_waitcnt lgkmcnt(11)
    v_mfma_f32_16x16x32_bf16 v[96:99], v[40:43], v[132:135], v[96:99]
    ds_read_b64_tr_b16 v[60:61], v10 offset:32256
    v_mfma_f32_16x16x32_bf16 v[100:103], v[40:43], v[136:139], v[100:103]
    ds_read_b64_tr_b16 v[62:63], v10 offset:32400
    v_mfma_f32_16x16x32_bf16 v[104:107], v[40:43], v[140:143], v[104:107]
    ds_read_b64_tr_b16 v[64:65], v10 offset:32288
    s_waitcnt lgkmcnt(12)
    v_mfma_f32_16x16x32_bf16 v[108:111], v[44:47], v[132:135], v[108:111]
    ds_read_b64_tr_b16 v[66:67], v10 offset:32432
    v_mfma_f32_16x16x32_bf16 v[112:115], v[44:47], v[136:139], v[112:115]
    ds_read_b64_tr_b16 v[68:69], v11 offset:23040
    v_mfma_f32_16x16x32_bf16 v[116:119], v[44:47], v[140:143], v[116:119]
    ds_read_b64_tr_b16 v[70:71], v11 offset:23184
    s_waitcnt lgkmcnt(13)
    v_mfma_f32_16x16x32_bf16 v[128:131], v[48:51], v[140:143], v[128:131]
    s_add_u32 s66, s89, 2
    s_sub_u32 s15, s66, 3
    s_cmp_ge_u32 s66, 3
    s_cselect_b32 s66, s15, s66
    s_add_u32 s66, s66, 6
    s_mul_i32 s66, s66, 221184
    s_add_u32 s67, s66, s92
    s_add_u32 m0, s70, 0
    s_mov_b32 exec_hi, 0x7fffffff
    buffer_load_dwordx4 v5, s[48:51], s67 offen lds
    s_mov_b64 exec, -1
    s_add_u32 m0, s70, 1008
    s_mov_b32 exec_hi, 0x7fffffff
    buffer_load_dwordx4 v6, s[48:51], s67 offen lds
    s_mov_b64 exec, -1
    s_add_u32 m0, s70, 2016
    s_mov_b64 exec, 0x3ffff
    buffer_load_dwordx4 v7, s[48:51], s67 offen lds
    s_mov_b64 exec, -1
    s_add_u32 s67, s66, s93
    s_add_u32 m0, s70, 9216
    s_mov_b32 exec_hi, 0x7fffffff
    buffer_load_dwordx4 v5, s[48:51], s67 offen lds
    s_mov_b64 exec, -1
    s_add_u32 m0, s70, 10224
    s_mov_b32 exec_hi, 0x7fffffff
    buffer_load_dwordx4 v6, s[48:51], s67 offen lds
    s_mov_b64 exec, -1
    s_add_u32 m0, s70, 11232
    s_mov_b64 exec, 0x3ffff
    buffer_load_dwordx4 v7, s[48:51], s67 offen lds
    s_mov_b64 exec, -1
    s_waitcnt vmcnt(7) lgkmcnt(0)
    s_barrier
    v_mfma_f32_16x16x32_bf16 v[72:75], v[52:55], v[144:147], v[72:75]
    ds_read_b128 v[132:135], v8 offset:20480
    ds_read_b128 v[136:139], v8 offset:22528
    v_mfma_f32_16x16x32_bf16 v[76:79], v[52:55], v[148:151], v[76:79]
    ds_read_b128 v[140:143], v8 offset:24576
    v_mfma_f32_16x16x32_bf16 v[80:83], v[52:55], v[152:155], v[80:83]
    ds_read_b64_tr_b16 v[32:33], v10 offset:36864
    v_mfma_f32_16x16x32_bf16 v[84:87], v[56:59], v[144:147], v[84:87]
    ds_read_b64_tr_b16 v[34:35], v10 offset:37008
    v_mfma_f32_16x16x32_bf16 v[88:91], v[56:59], v[148:151], v[88:91]
    ds_read_b64_tr_b16 v[36:37], v10 offset:36896
    v_mfma_f32_16x16x32_bf16 v[92:95], v[56:59], v[152:155], v[92:95]
    ds_read_b64_tr_b16 v[38:39], v10 offset:37040
    v_mfma_f32_16x16x32_bf16 v[96:99], v[60:63], v[144:147], v[96:99]
    ds_read_b64_tr_b16 v[40:41], v10 offset:46080
    v_mfma_f32_16x16x32_bf16 v[100:103], v[60:63], v[148:151], v[100:103]
    ds_read_b64_tr_b16 v[42:43], v10 offset:46224
    v_mfma_f32_16x16x32_bf16 v[104:107], v[60:63], v[152:155], v[104:107]
    ds_read_b64_tr_b16 v[44:45], v10 offset:46112
    v_mfma_f32_16x16x32_bf16 v[108:111], v[64:67], v[144:147], v[108:111]
    ds_read_b64_tr_b16 v[46:47], v10 offset:46256
    v_mfma_f32_16x16x32_bf16 v[112:115], v[64:67], v[148:151], v[112:115]
    ds_read_b64_tr_b16 v[48:49], v11 offset:36864
    v_mfma_f32_16x16x32_bf16 v[116:119], v[64:67], v[152:155], v[116:119]
    ds_read_b64_tr_b16 v[50:51], v11 offset:37008
    v_mfma_f32_16x16x32_bf16 v[128:131], v[68:71], v[152:155], v[128:131]
    s_waitcnt lgkmcnt(8)
    v_mfma_f32_16x16x32_bf16 v[72:75], v[32:35], v[132:135], v[72:75]
    ds_read_b128 v[144:147], v9 offset:20480
    ds_read_b128 v[148:151], v9 offset:22528
    v_mfma_f32_16x16x32_bf16 v[76:79], v[32:35], v[136:139], v[76:79]
    ds_read_b128 v[152:155], v9 offset:24576
    v_mfma_f32_16x16x32_bf16 v[80:83], v[32:35], v[140:143], v[80:83]
    ds_read_b64_tr_b16 v[52:53], v10 offset:41472
    s_waitcnt lgkmcnt(10)
    v_mfma_f32_16x16x32_bf16 v[84:87], v[36:39], v[132:135], v[84:87]
    ds_read_b64_tr_b16 v[54:55], v10 offset:41616
    v_mfma_f32_16x16x32_bf16 v[88:91], v[36:39], v[136:139], v[88:91]
    ds_read_b64_tr_b16 v[56:57], v10 offset:41504
    v_mfma_f32_16x16x32_bf16 v[92:95], v[36:39], v[140:143], v[92:95]
    ds_read_b64_tr_b16 v[58:59], v10 offset:41648
    s_waitcnt lgkmcnt(11)
    v_mfma_f32_16x16x32_bf16 v[96:99], v[40:43], v[132:135], v[96:99]
    ds_read_b64_tr_b16 v[60:61], v10 offset:50688
    v_mfma_f32_16x16x32_bf16 v[100:103], v[40:43], v[136:139], v[100:103]
    ds_read_b64_tr_b16 v[62:63], v10 offset:50832
    v_mfma_f32_16x16x32_bf16 v[104:107], v[40:43], v[140:143], v[104:107]
    ds_read_b64_tr_b16 v[64:65], v10 offset:50720
    s_waitcnt lgkmcnt(12)
    v_mfma_f32_16x16x32_bf16 v[108:111], v[44:47], v[132:135], v[108:111]
    ds_read_b64_tr_b16 v[66:67], v10 offset:50864
    v_mfma_f32_16x16x32_bf16 v[112:115], v[44:47], v[136:139], v[112:115]
    ds_read_b64_tr_b16 v[68:69], v11 offset:41472
    v_mfma_f32_16x16x32_bf16 v[116:119], v[44:47], v[140:143], v[116:119]
    ds_read_b64_tr_b16 v[70:71], v11 offset:41616
    s_waitcnt lgkmcnt(13)
    v_mfma_f32_16x16x32_bf16 v[128:131], v[48:51], v[140:143], v[128:131]
    s_waitcnt vmcnt(0) lgkmcnt(0)
    s_barrier
    v_mfma_f32_16x16x32_bf16 v[72:75], v[52:55], v[144:147], v[72:75]
    ds_read_b128 v[132:135], v8 offset:40960
    ds_read_b128 v[136:139], v8 offset:43008
    v_mfma_f32_16x16x32_bf16 v[76:79], v[52:55], v[148:151], v[76:79]
    ds_read_b128 v[140:143], v8 offset:45056
    v_mfma_f32_16x16x32_bf16 v[80:83], v[52:55], v[152:155], v[80:83]
    ds_read_b64_tr_b16 v[32:33], v10 offset:0
    v_mfma_f32_16x16x32_bf16 v[84:87], v[56:59], v[144:147], v[84:87]
    ds_read_b64_tr_b16 v[34:35], v10 offset:144
    v_mfma_f32_16x16x32_bf16 v[88:91], v[56:59], v[148:151], v[88:91]
    ds_read_b64_tr_b16 v[36:37], v10 offset:32
    v_mfma_f32_16x16x32_bf16 v[92:95], v[56:59], v[152:155], v[92:95]
    ds_read_b64_tr_b16 v[38:39], v10 offset:176
    v_mfma_f32_16x16x32_bf16 v[96:99], v[60:63], v[144:147], v[96:99]
    ds_read_b64_tr_b16 v[40:41], v10 offset:9216
    v_mfma_f32_16x16x32_bf16 v[100:103], v[60:63], v[148:151], v[100:103]
    ds_read_b64_tr_b16 v[42:43], v10 offset:9360
    v_mfma_f32_16x16x32_bf16 v[104:107], v[60:63], v[152:155], v[104:107]
    ds_read_b64_tr_b16 v[44:45], v10 offset:9248
    v_mfma_f32_16x16x32_bf16 v[108:111], v[64:67], v[144:147], v[108:111]
    ds_read_b64_tr_b16 v[46:47], v10 offset:9392
    v_mfma_f32_16x16x32_bf16 v[112:115], v[64:67], v[148:151], v[112:115]
    ds_read_b64_tr_b16 v[48:49], v11 offset:0
    v_mfma_f32_16x16x32_bf16 v[116:119], v[64:67], v[152:155], v[116:119]
    ds_read_b64_tr_b16 v[50:51], v11 offset:144
    v_mfma_f32_16x16x32_bf16 v[128:131], v[68:71], v[152:155], v[128:131]
    s_waitcnt lgkmcnt(8)
    v_mfma_f32_16x16x32_bf16 v[72:75], v[32:35], v[132:135], v[72:75]
    ds_read_b128 v[144:147], v9 offset:40960
    ds_read_b128 v[148:151], v9 offset:43008
    v_mfma_f32_16x16x32_bf16 v[76:79], v[32:35], v[136:139], v[76:79]
    ds_read_b128 v[152:155], v9 offset:45056
    v_mfma_f32_16x16x32_bf16 v[80:83], v[32:35], v[140:143], v[80:83]
    ds_read_b64_tr_b16 v[52:53], v10 offset:4608
    s_waitcnt lgkmcnt(10)
    v_mfma_f32_16x16x32_bf16 v[84:87], v[36:39], v[132:135], v[84:87]
    ds_read_b64_tr_b16 v[54:55], v10 offset:4752
    v_mfma_f32_16x16x32_bf16 v[88:91], v[36:39], v[136:139], v[88:91]
    ds_read_b64_tr_b16 v[56:57], v10 offset:4640
    v_mfma_f32_16x16x32_bf16 v[92:95], v[36:39], v[140:143], v[92:95]
    ds_read_b64_tr_b16 v[58:59], v10 offset:4784
    s_waitcnt lgkmcnt(11)
    v_mfma_f32_16x16x32_bf16 v[96:99], v[40:43], v[132:135], v[96:99]
    ds_read_b64_tr_b16 v[60:61], v10 offset:13824
    v_mfma_f32_16x16x32_bf16 v[100:103], v[40:43], v[136:139], v[100:103]
    ds_read_b64_tr_b16 v[62:63], v10 offset:13968
    v_mfma_f32_16x16x32_bf16 v[104:107], v[40:43], v[140:143], v[104:107]
    ds_read_b64_tr_b16 v[64:65], v10 offset:13856
    s_waitcnt lgkmcnt(12)
    v_mfma_f32_16x16x32_bf16 v[108:111], v[44:47], v[132:135], v[108:111]
    ds_read_b64_tr_b16 v[66:67], v10 offset:14000
    v_mfma_f32_16x16x32_bf16 v[112:115], v[44:47], v[136:139], v[112:115]
    ds_read_b64_tr_b16 v[68:69], v11 offset:4608
    v_mfma_f32_16x16x32_bf16 v[116:119], v[44:47], v[140:143], v[116:119]
    ds_read_b64_tr_b16 v[70:71], v11 offset:4752
    s_waitcnt lgkmcnt(13)
    v_mfma_f32_16x16x32_bf16 v[128:131], v[48:51], v[140:143], v[128:131]
    s_waitcnt lgkmcnt(8)
    v_mfma_f32_16x16x32_bf16 v[72:75], v[52:55], v[144:147], v[72:75]
    v_mfma_f32_16x16x32_bf16 v[76:79], v[52:55], v[148:151], v[76:79]
    v_mfma_f32_16x16x32_bf16 v[80:83], v[52:55], v[152:155], v[80:83]
    s_waitcnt lgkmcnt(6)
    v_mfma_f32_16x16x32_bf16 v[84:87], v[56:59], v[144:147], v[84:87]
    v_mfma_f32_16x16x32_bf16 v[88:91], v[56:59], v[148:151], v[88:91]
    v_mfma_f32_16x16x32_bf16 v[92:95], v[56:59], v[152:155], v[92:95]
    s_waitcnt lgkmcnt(4)
    v_mfma_f32_16x16x32_bf16 v[96:99], v[60:63], v[144:147], v[96:99]
    v_mfma_f32_16x16x32_bf16 v[100:103], v[60:63], v[148:151], v[100:103]
    v_mfma_f32_16x16x32_bf16 v[104:107], v[60:63], v[152:155], v[104:107]
    s_waitcnt lgkmcnt(2)
    v_mfma_f32_16x16x32_bf16 v[108:111], v[64:67], v[144:147], v[108:111]
    v_mfma_f32_16x16x32_bf16 v[112:115], v[64:67], v[148:151], v[112:115]
    v_mfma_f32_16x16x32_bf16 v[116:119], v[64:67], v[152:155], v[116:119]
    s_waitcnt lgkmcnt(0)
    v_mfma_f32_16x16x32_bf16 v[128:131], v[68:71], v[152:155], v[128:131]
    s_mov_b32 s74, 0
    v_cvt_pk_bf16_f32 v72, v72, v73
    v_cvt_pk_bf16_f32 v73, v74, v75
    v_cvt_pk_bf16_f32 v74, v84, v85
    v_cvt_pk_bf16_f32 v75, v86, v87
    v_cvt_pk_bf16_f32 v96, v96, v97
    v_cvt_pk_bf16_f32 v97, v98, v99
    v_cvt_pk_bf16_f32 v98, v108, v109
    v_cvt_pk_bf16_f32 v99, v110, v111
    buffer_store_dwordx4 v[72:75], v200, s[52:55], s74 offen sc1
    buffer_store_dwordx4 v[96:99], v200, s[52:55], s74 offen offset:2048 sc1
    s_add_u32 s74, s74, 18432
    v_cvt_pk_bf16_f32 v76, v76, v77
    v_cvt_pk_bf16_f32 v77, v78, v79
    v_cvt_pk_bf16_f32 v78, v88, v89
    v_cvt_pk_bf16_f32 v79, v90, v91
    v_cvt_pk_bf16_f32 v100, v100, v101
    v_cvt_pk_bf16_f32 v101, v102, v103
    v_cvt_pk_bf16_f32 v102, v112, v113
    v_cvt_pk_bf16_f32 v103, v114, v115
    buffer_store_dwordx4 v[76:79], v200, s[52:55], s74 offen sc1
    buffer_store_dwordx4 v[100:103], v200, s[52:55], s74 offen offset:2048 sc1
    s_add_u32 s74, s74, 18432
    v_cvt_pk_bf16_f32 v80, v80, v81
    v_cvt_pk_bf16_f32 v81, v82, v83
    v_cvt_pk_bf16_f32 v82, v92, v93
    v_cvt_pk_bf16_f32 v83, v94, v95
    v_cvt_pk_bf16_f32 v104, v104, v105
    v_cvt_pk_bf16_f32 v105, v106, v107
    v_cvt_pk_bf16_f32 v106, v116, v117
    v_cvt_pk_bf16_f32 v107, v118, v119
    v_cvt_pk_bf16_f32 v128, v128, v129
    v_cvt_pk_bf16_f32 v129, v130, v131
    buffer_store_dwordx4 v[80:83], v200, s[52:55], s74 offen sc1
    buffer_store_dwordx4 v[104:107], v200, s[52:55], s74 offen offset:2048 sc1
    buffer_store_dwordx2 v[128:129], v201, s[52:55], s74 offen sc1
    s_add_u32 s74, s74, 18432
    s_branch Q_join
Q_v1:
    v_mov_b32 v30, 0
    v_lshrrev_b32 v21, 1, v22
    v_xor_b32 v21, v21, v19
    v_lshlrev_b32 v21, 4, v21
    v_lshl_add_u32 v8, v22, 7, v21
    s_lshl_b32 s14, s68, 11
    v_add_u32 v8, s14, v8
    v_xor_b32 v9, 64, v8
    v_lshlrev_b32 v21, 1, v23
    v_lshl_add_u32 v21, v19, 3, v21
    v_mul_u32_u24 v21, 144, v21
    v_add_u32 v21, 61440, v21
    v_lshl_add_u32 v10, v24, 3, v21
    v_and_b32 v20, 1, v24
    v_mul_u32_u24 v20, 9216, v20
    v_add3_u32 v11, v21, v20, 64

    v_lshrrev_b32 v20, 1, v24
    v_mul_u32_u24 v20, 72, v20
    v_add_u32 v11, v11, v20
    v_subrev_u32 v11, 0, v11
    s_mul_i32 s14, s4, 10
    s_add_u32 s14, s14, s68
    s_mul_i32 s74, s14, 18432
    s_add_u32 s74, s74, 0x401000
    s_lshl_b32 s75, s5, 2
    s_add_u32 s75, s75, s13
    s_lshl_b32 s75, s75, 10
    s_add_u32 s75, s75, s74
    v_lshl_add_u32 v200, v2, 4, s75
    s_lshl_b32 s75, s5, 9
    s_add_u32 s75, s75, s74
    s_add_u32 s75, s75, 16384
    v_lshl_add_u32 v201, v2, 3, s75
    s_lshl_b32 s74, s3, 7
    s_add_u32 s74, s74, 0xdc000
    v_mov_b32 v202, s74

    s_add_u32 s66, s89, 1
    s_sub_u32 s15, s66, 3
    s_cmp_ge_u32 s66, 3
    s_cselect_b32 s66, s15, s66
    s_add_u32 s66, s66, 0
    s_mul_i32 s66, s66, 221184
    s_add_u32 s67, s66, s92
    s_add_u32 m0, s70, 36864
    s_mov_b32 exec_hi, 0x7fffffff
    buffer_load_dwordx4 v5, s[48:51], s67 offen lds
    s_mov_b64 exec, -1
    s_add_u32 m0, s70, 37872
    s_mov_b32 exec_hi, 0x7fffffff
    buffer_load_dwordx4 v6, s[48:51], s67 offen lds
    s_mov_b64 exec, -1
    s_add_u32 m0, s70, 38880
    s_mov_b64 exec, 0x3ffff
    buffer_load_dwordx4 v7, s[48:51], s67 offen lds
    s_mov_b64 exec, -1
    s_add_u32 s67, s66, s93
    s_add_u32 m0, s70, 46080
    s_mov_b32 exec_hi, 0x7fffffff
    buffer_load_dwordx4 v5, s[48:51], s67 offen lds
    s_mov_b64 exec, -1
    s_add_u32 m0, s70, 47088
    s_mov_b32 exec_hi, 0x7fffffff
    buffer_load_dwordx4 v6, s[48:51], s67 offen lds
    s_mov_b64 exec, -1
    s_add_u32 m0, s70, 48096
    s_mov_b64 exec, 0x3ffff
    buffer_load_dwordx4 v7, s[48:51], s67 offen lds
    s_mov_b64 exec, -1
    s_waitcnt vmcnt(6) lgkmcnt(0)
    s_barrier
    ds_read_b128 v[112:115], v8 offset:0
    ds_read_b128 v[116:119], v8 offset:2048
    ds_read_b64_tr_b16 v[32:33], v10 offset:18432
    ds_read_b64_tr_b16 v[34:35], v10 offset:18576
    ds_read_b64_tr_b16 v[36:37], v10 offset:18464
    ds_read_b64_tr_b16 v[38:39], v10 offset:18608
    ds_read_b64_tr_b16 v[40:41], v10 offset:27648
    ds_read_b64_tr_b16 v[42:43], v10 offset:27792
    ds_read_b64_tr_b16 v[44:45], v10 offset:27680
    ds_read_b64_tr_b16 v[46:47], v10 offset:27824
    ds_read_b64_tr_b16 v[48:49], v11 offset:18432
    ds_read_b64_tr_b16 v[50:51], v11 offset:18576
    s_waitcnt lgkmcnt(8)
    v_mfma_f32_16x16x32_bf16 v[72:75], v[32:35], v[112:115], 0
    ds_read_b128 v[120:123], v9 offset:0
    ds_read_b128 v[124:127], v9 offset:2048
    v_mfma_f32_16x16x32_bf16 v[76:79], v[32:35], v[116:119], 0
    ds_read_b64_tr_b16 v[52:53], v10 offset:23040
    ds_read_b64_tr_b16 v[54:55], v10 offset:23184
    s_waitcnt lgkmcnt(10)
    v_mfma_f32_16x16x32_bf16 v[80:83], v[36:39], v[112:115], 0
    ds_read_b64_tr_b16 v[56:57], v10 offset:23072
    ds_read_b64_tr_b16 v[58:59], v10 offset:23216
    v_mfma_f32_16x16x32_bf16 v[84:87], v[36:39], v[116:119], 0
    ds_read_b64_tr_b16 v[60:61], v10 offset:32256
    s_waitcnt lgkmcnt(11)
    v_mfma_f32_16x16x32_bf16 v[88:91], v[40:43], v[112:115], 0
    ds_read_b64_tr_b16 v[62:63], v10 offset:32400
    v_mfma_f32_16x16x32_bf16 v[92:95], v[40:43], v[116:119], 0
    ds_read_b64_tr_b16 v[64:65], v10 offset:32288
    s_waitcnt lgkmcnt(11)
    v_mfma_f32_16x16x32_bf16 v[96:99], v[44:47], v[112:115], 0
    ds_read_b64_tr_b16 v[66:67], v10 offset:32432
    v_mfma_f32_16x16x32_bf16 v[100:103], v[44:47], v[116:119], 0
    ds_read_b64_tr_b16 v[68:69], v11 offset:23040
    s_waitcnt lgkmcnt(11)
    v_mfma_f32_16x16x32_bf16 v[104:107], v[48:51], v[112:115], 0
    ds_read_b64_tr_b16 v[70:71], v11 offset:23184
    v_mfma_f32_16x16x32_bf16 v[108:111], v[48:51], v[116:119], 0
    s_add_u32 s66, s89, 2
    s_sub_u32 s15, s66, 3
    s_cmp_ge_u32 s66, 3
    s_cselect_b32 s66, s15, s66
    s_add_u32 s66, s66, 0
    s_mul_i32 s66, s66, 221184
    s_add_u32 s67, s66, s92
    s_add_u32 m0, s70, 0
    s_mov_b32 exec_hi, 0x7fffffff
    buffer_load_dwordx4 v5, s[48:51], s67 offen lds
    s_mov_b64 exec, -1
    s_add_u32 m0, s70, 1008
    s_mov_b32 exec_hi, 0x7fffffff
    buffer_load_dwordx4 v6, s[48:51], s67 offen lds
    s_mov_b64 exec, -1
    s_add_u32 m0, s70, 2016
    s_mov_b64 exec, 0x3ffff
    buffer_load_dwordx4 v7, s[48:51], s67 offen lds
    s_mov_b64 exec, -1
    s_add_u32 s67, s66, s93
    s_add_u32 m0, s70, 9216
    s_mov_b32 exec_hi, 0x7fffffff
    buffer_load_dwordx4 v5, s[48:51], s67 offen lds
    s_mov_b64 exec, -1
    s_add_u32 m0, s70, 10224
    s_mov_b32 exec_hi, 0x7fffffff
    buffer_load_dwordx4 v6, s[48:51], s67 offen lds
    s_mov_b64 exec, -1
    s_add_u32 m0, s70, 11232
    s_mov_b64 exec, 0x3ffff
    buffer_load_dwordx4 v7, s[48:51], s67 offen lds
    s_mov_b64 exec, -1
    s_waitcnt vmcnt(6) lgkmcnt(0)
    s_barrier
    v_mfma_f32_16x16x32_bf16 v[72:75], v[52:55], v[120:123], v[72:75]
    ds_read_b128 v[112:115], v8 offset:20480
    ds_read_b128 v[116:119], v8 offset:22528
    v_mfma_f32_16x16x32_bf16 v[76:79], v[52:55], v[124:127], v[76:79]
    ds_read_b64_tr_b16 v[32:33], v10 offset:36864
    ds_read_b64_tr_b16 v[34:35], v10 offset:37008
    v_mfma_f32_16x16x32_bf16 v[80:83], v[56:59], v[120:123], v[80:83]
    ds_read_b64_tr_b16 v[36:37], v10 offset:36896
    ds_read_b64_tr_b16 v[38:39], v10 offset:37040
    v_mfma_f32_16x16x32_bf16 v[84:87], v[56:59], v[124:127], v[84:87]
    ds_read_b64_tr_b16 v[40:41], v10 offset:46080
    v_mfma_f32_16x16x32_bf16 v[88:91], v[60:63], v[120:123], v[88:91]
    ds_read_b64_tr_b16 v[42:43], v10 offset:46224
    v_mfma_f32_16x16x32_bf16 v[92:95], v[60:63], v[124:127], v[92:95]
    ds_read_b64_tr_b16 v[44:45], v10 offset:46112
    v_mfma_f32_16x16x32_bf16 v[96:99], v[64:67], v[120:123], v[96:99]
    ds_read_b64_tr_b16 v[46:47], v10 offset:46256
    v_mfma_f32_16x16x32_bf16 v[100:103], v[64:67], v[124:127], v[100:103]
    ds_read_b64_tr_b16 v[48:49], v11 offset:36864
    v_mfma_f32_16x16x32_bf16 v[104:107], v[68:71], v[120:123], v[104:107]
    ds_read_b64_tr_b16 v[50:51], v11 offset:37008
    v_mfma_f32_16x16x32_bf16 v[108:111], v[68:71], v[124:127], v[108:111]
    s_waitcnt lgkmcnt(8)
    v_mfma_f32_16x16x32_bf16 v[72:75], v[32:35], v[112:115], v[72:75]
    ds_read_b128 v[120:123], v9 offset:20480
    ds_read_b128 v[124:127], v9 offset:22528
    v_mfma_f32_16x16x32_bf16 v[76:79], v[32:35], v[116:119], v[76:79]
    ds_read_b64_tr_b16 v[52:53], v10 offset:41472
    ds_read_b64_tr_b16 v[54:55], v10 offset:41616
    s_waitcnt lgkmcnt(10)
    v_mfma_f32_16x16x32_bf16 v[80:83], v[36:39], v[112:115], v[80:83]
    ds_read_b64_tr_b16 v[56:57], v10 offset:41504
    ds_read_b64_tr_b16 v[58:59], v10 offset:41648
    v_mfma_f32_16x16x32_bf16 v[84:87], v[36:39], v[116:119], v[84:87]
    ds_read_b64_tr_b16 v[60:61], v10 offset:50688
    s_waitcnt lgkmcnt(11)
    v_mfma_f32_16x16x32_bf16 v[88:91], v[40:43], v[112:115], v[88:91]
    ds_read_b64_tr_b16 v[62:63], v10 offset:50832
    v_mfma_f32_16x16x32_bf16 v[92:95], v[40:43], v[116:119], v[92:95]
    ds_read_b64_tr_b16 v[64:65], v10 offset:50720
    s_waitcnt lgkmcnt(11)
    v_mfma_f32_16x16x32_bf16 v[96:99], v[44:47], v[112:115], v[96:99]
    ds_read_b64_tr_b16 v[66:67], v10 offset:50864
    v_mfma_f32_16x16x32_bf16 v[100:103], v[44:47], v[116:119], v[100:103]
    ds_read_b64_tr_b16 v[68:69], v11 offset:41472
    s_waitcnt lgkmcnt(11)
    v_mfma_f32_16x16x32_bf16 v[104:107], v[48:51], v[112:115], v[104:107]
    ds_read_b64_tr_b16 v[70:71], v11 offset:41616
    v_mfma_f32_16x16x32_bf16 v[108:111], v[48:51], v[116:119], v[108:111]
    s_add_u32 s66, s89, 0
    s_sub_u32 s15, s66, 3
    s_cmp_ge_u32 s66, 3
    s_cselect_b32 s66, s15, s66
    s_add_u32 s66, s66, 3
    s_mul_i32 s66, s66, 221184
    s_add_u32 s67, s66, s92
    s_add_u32 m0, s70, 18432
    s_mov_b32 exec_hi, 0x7fffffff
    buffer_load_dwordx4 v5, s[48:51], s67 offen lds
    s_mov_b64 exec, -1
    s_add_u32 m0, s70, 19440
    s_mov_b32 exec_hi, 0x7fffffff
    buffer_load_dwordx4 v6, s[48:51], s67 offen lds
    s_mov_b64 exec, -1
    s_add_u32 m0, s70, 20448
    s_mov_b64 exec, 0x3ffff
    buffer_load_dwordx4 v7, s[48:51], s67 offen lds
    s_mov_b64 exec, -1
    s_add_u32 s67, s66, s93
    s_add_u32 m0, s70, 27648
    s_mov_b32 exec_hi, 0x7fffffff
    buffer_load_dwordx4 v5, s[48:51], s67 offen lds
    s_mov_b64 exec, -1
    s_add_u32 m0, s70, 28656
    s_mov_b32 exec_hi, 0x7fffffff
    buffer_load_dwordx4 v6, s[48:51], s67 offen lds
    s_mov_b64 exec, -1
    s_add_u32 m0, s70, 29664
    s_mov_b64 exec, 0x3ffff
    buffer_load_dwordx4 v7, s[48:51], s67 offen lds
    s_mov_b64 exec, -1
    s_waitcnt vmcnt(6) lgkmcnt(0)
    s_barrier
    v_mfma_f32_16x16x32_bf16 v[72:75], v[52:55], v[120:123], v[72:75]
    ds_read_b128 v[112:115], v8 offset:40960
    ds_read_b128 v[116:119], v8 offset:43008
    v_mfma_f32_16x16x32_bf16 v[76:79], v[52:55], v[124:127], v[76:79]
    ds_read_b64_tr_b16 v[32:33], v10 offset:0
    ds_read_b64_tr_b16 v[34:35], v10 offset:144
    v_mfma_f32_16x16x32_bf16 v[80:83], v[56:59], v[120:123], v[80:83]
    ds_read_b64_tr_b16 v[36:37], v10 offset:32
    ds_read_b64_tr_b16 v[38:39], v10 offset:176
    v_mfma_f32_16x16x32_bf16 v[84:87], v[56:59], v[124:127], v[84:87]
    ds_read_b64_tr_b16 v[40:41], v10 offset:9216
    v_mfma_f32_16x16x32_bf16 v[88:91], v[60:63], v[120:123], v[88:91]
    ds_read_b64_tr_b16 v[42:43], v10 offset:9360
    v_mfma_f32_16x16x32_bf16 v[92:95], v[60:63], v[124:127], v[92:95]
    ds_read_b64_tr_b16 v[44:45], v10 offset:9248
    v_mfma_f32_16x16x32_bf16 v[96:99], v[64:67], v[120:123], v[96:99]
    ds_read_b64_tr_b16 v[46:47], v10 offset:9392
    v_mfma_f32_16x16x32_bf16 v[100:103], v[64:67], v[124:127], v[100:103]
    ds_read_b64_tr_b16 v[48:49], v11 offset:0
    v_mfma_f32_16x16x32_bf16 v[104:107], v[68:71], v[120:123], v[104:107]
    ds_read_b64_tr_b16 v[50:51], v11 offset:144
    v_mfma_f32_16x16x32_bf16 v[108:111], v[68:71], v[124:127], v[108:111]
    s_waitcnt lgkmcnt(8)
    v_mfma_f32_16x16x32_bf16 v[72:75], v[32:35], v[112:115], v[72:75]
    ds_read_b128 v[120:123], v9 offset:40960
    ds_read_b128 v[124:127], v9 offset:43008
    v_mfma_f32_16x16x32_bf16 v[76:79], v[32:35], v[116:119], v[76:79]
    ds_read_b64_tr_b16 v[52:53], v10 offset:4608
    ds_read_b64_tr_b16 v[54:55], v10 offset:4752
    s_waitcnt lgkmcnt(10)
    v_mfma_f32_16x16x32_bf16 v[80:83], v[36:39], v[112:115], v[80:83]
    ds_read_b64_tr_b16 v[56:57], v10 offset:4640
    ds_read_b64_tr_b16 v[58:59], v10 offset:4784
    v_mfma_f32_16x16x32_bf16 v[84:87], v[36:39], v[116:119], v[84:87]
    ds_read_b64_tr_b16 v[60:61], v10 offset:13824
    s_waitcnt lgkmcnt(11)
    v_mfma_f32_16x16x32_bf16 v[88:91], v[40:43], v[112:115], v[88:91]
    ds_read_b64_tr_b16 v[62:63], v10 offset:13968
    v_mfma_f32_16x16x32_bf16 v[92:95], v[40:43], v[116:119], v[92:95]
    ds_read_b64_tr_b16 v[64:65], v10 offset:13856
    s_waitcnt lgkmcnt(11)
    v_mfma_f32_16x16x32_bf16 v[96:99], v[44:47], v[112:115], v[96:99]
    ds_read_b64_tr_b16 v[66:67], v10 offset:14000
    v_mfma_f32_16x16x32_bf16 v[100:103], v[44:47], v[116:119], v[100:103]
    ds_read_b64_tr_b16 v[68:69], v11 offset:4608
    s_waitcnt lgkmcnt(11)
    v_mfma_f32_16x16x32_bf16 v[104:107], v[48:51], v[112:115], v[104:107]
    ds_read_b64_tr_b16 v[70:71], v11 offset:4752
    v_mfma_f32_16x16x32_bf16 v[108:111], v[48:51], v[116:119], v[108:111]
    s_add_u32 s66, s89, 1
    s_sub_u32 s15, s66, 3
    s_cmp_ge_u32 s66, 3
    s_cselect_b32 s66, s15, s66
    s_add_u32 s66, s66, 3
    s_mul_i32 s66, s66, 221184
    s_add_u32 s67, s66, s92
    s_add_u32 m0, s70, 36864
    s_mov_b32 exec_hi, 0x7fffffff
    buffer_load_dwordx4 v5, s[48:51], s67 offen lds
    s_mov_b64 exec, -1
    s_add_u32 m0, s70, 37872
    s_mov_b32 exec_hi, 0x7fffffff
    buffer_load_dwordx4 v6, s[48:51], s67 offen lds
    s_mov_b64 exec, -1
    s_add_u32 m0, s70, 38880
    s_mov_b64 exec, 0x3ffff
    buffer_load_dwordx4 v7, s[48:51], s67 offen lds
    s_mov_b64 exec, -1
    s_add_u32 s67, s66, s93
    s_add_u32 m0, s70, 46080
    s_mov_b32 exec_hi, 0x7fffffff
    buffer_load_dwordx4 v5, s[48:51], s67 offen lds
    s_mov_b64 exec, -1
    s_add_u32 m0, s70, 47088
    s_mov_b32 exec_hi, 0x7fffffff
    buffer_load_dwordx4 v6, s[48:51], s67 offen lds
    s_mov_b64 exec, -1
    s_add_u32 m0, s70, 48096
    s_mov_b64 exec, 0x3ffff
    buffer_load_dwordx4 v7, s[48:51], s67 offen lds
    s_mov_b64 exec, -1
    s_waitcnt vmcnt(6) lgkmcnt(0)
    s_barrier
    v_mfma_f32_16x16x32_bf16 v[72:75], v[52:55], v[120:123], v[72:75]
    ds_read_b128 v[112:115], v8 offset:0
    ds_read_b128 v[116:119], v8 offset:2048
    v_mfma_f32_16x16x32_bf16 v[76:79], v[52:55], v[124:127], v[76:79]
    ds_read_b64_tr_b16 v[32:33], v10 offset:18432
    ds_read_b64_tr_b16 v[34:35], v10 offset:18576
    v_mfma_f32_16x16x32_bf16 v[80:83], v[56:59], v[120:123], v[80:83]
    ds_read_b64_tr_b16 v[36:37], v10 offset:18464
    ds_read_b64_tr_b16 v[38:39], v10 offset:18608
    v_mfma_f32_16x16x32_bf16 v[84:87], v[56:59], v[124:127], v[84:87]
    ds_read_b64_tr_b16 v[40:41], v10 offset:27648
    v_mfma_f32_16x16x32_bf16 v[88:91], v[60:63], v[120:123], v[88:91]
    ds_read_b64_tr_b16 v[42:43], v10 offset:27792
    v_mfma_f32_16x16x32_bf16 v[92:95], v[60:63], v[124:127], v[92:95]
    ds_read_b64_tr_b16 v[44:45], v10 offset:27680
    v_mfma_f32_16x16x32_bf16 v[96:99], v[64:67], v[120:123], v[96:99]
    ds_read_b64_tr_b16 v[46:47], v10 offset:27824
    v_mfma_f32_16x16x32_bf16 v[100:103], v[64:67], v[124:127], v[100:103]
    ds_read_b64_tr_b16 v[48:49], v11 offset:18432
    v_mfma_f32_16x16x32_bf16 v[104:107], v[68:71], v[120:123], v[104:107]
    ds_read_b64_tr_b16 v[50:51], v11 offset:18576
    v_mfma_f32_16x16x32_bf16 v[108:111], v[68:71], v[124:127], v[108:111]
    s_waitcnt lgkmcnt(8)
    v_mfma_f32_16x16x32_bf16 v[72:75], v[32:35], v[112:115], v[72:75]
    ds_read_b128 v[120:123], v9 offset:0
    ds_read_b128 v[124:127], v9 offset:2048
    v_mfma_f32_16x16x32_bf16 v[76:79], v[32:35], v[116:119], v[76:79]
    ds_read_b64_tr_b16 v[52:53], v10 offset:23040
    ds_read_b64_tr_b16 v[54:55], v10 offset:23184
    s_waitcnt lgkmcnt(10)
    v_mfma_f32_16x16x32_bf16 v[80:83], v[36:39], v[112:115], v[80:83]
    ds_read_b64_tr_b16 v[56:57], v10 offset:23072
    ds_read_b64_tr_b16 v[58:59], v10 offset:23216
    v_mfma_f32_16x16x32_bf16 v[84:87], v[36:39], v[116:119], v[84:87]
    ds_read_b64_tr_b16 v[60:61], v10 offset:32256
    s_waitcnt lgkmcnt(11)
    v_mfma_f32_16x16x32_bf16 v[88:91], v[40:43], v[112:115], v[88:91]
    ds_read_b64_tr_b16 v[62:63], v10 offset:32400
    v_mfma_f32_16x16x32_bf16 v[92:95], v[40:43], v[116:119], v[92:95]
    ds_read_b64_tr_b16 v[64:65], v10 offset:32288
    s_waitcnt lgkmcnt(11)
    v_mfma_f32_16x16x32_bf16 v[96:99], v[44:47], v[112:115], v[96:99]
    ds_read_b64_tr_b16 v[66:67], v10 offset:32432
    v_mfma_f32_16x16x32_bf16 v[100:103], v[44:47], v[116:119], v[100:103]
    ds_read_b64_tr_b16 v[68:69], v11 offset:23040
    s_waitcnt lgkmcnt(11)
    v_mfma_f32_16x16x32_bf16 v[104:107], v[48:51], v[112:115], v[104:107]
    ds_read_b64_tr_b16 v[70:71], v11 offset:23184
    v_mfma_f32_16x16x32_bf16 v[108:111], v[48:51], v[116:119], v[108:111]
    s_add_u32 s66, s89, 2
    s_sub_u32 s15, s66, 3
    s_cmp_ge_u32 s66, 3
    s_cselect_b32 s66, s15, s66
    s_add_u32 s66, s66, 3
    s_mul_i32 s66, s66, 221184
    s_add_u32 s67, s66, s92
    s_add_u32 m0, s70, 0
    s_mov_b32 exec_hi, 0x7fffffff
    buffer_load_dwordx4 v5, s[48:51], s67 offen lds
    s_mov_b64 exec, -1
    s_add_u32 m0, s70, 1008
    s_mov_b32 exec_hi, 0x7fffffff
    buffer_load_dwordx4 v6, s[48:51], s67 offen lds
    s_mov_b64 exec, -1
    s_add_u32 m0, s70, 2016
    s_mov_b64 exec, 0x3ffff
    buffer_load_dwordx4 v7, s[48:51], s67 offen lds
    s_mov_b64 exec, -1
    s_add_u32 s67, s66, s93
    s_add_u32 m0, s70, 9216
    s_mov_b32 exec_hi, 0x7fffffff
    buffer_load_dwordx4 v5, s[48:51], s67 offen lds
    s_mov_b64 exec, -1
    s_add_u32 m0, s70, 10224
    s_mov_b32 exec_hi, 0x7fffffff
    buffer_load_dwordx4 v6, s[48:51], s67 offen lds
    s_mov_b64 exec, -1
    s_add_u32 m0, s70, 11232
    s_mov_b64 exec, 0x3ffff
    buffer_load_dwordx4 v7, s[48:51], s67 offen lds
    s_mov_b64 exec, -1
    s_waitcnt vmcnt(6) lgkmcnt(0)
    s_barrier
    v_mfma_f32_16x16x32_bf16 v[72:75], v[52:55], v[120:123], v[72:75]
    ds_read_b128 v[112:115], v8 offset:20480
    ds_read_b128 v[116:119], v8 offset:22528
    v_mfma_f32_16x16x32_bf16 v[76:79], v[52:55], v[124:127], v[76:79]
    ds_read_b64_tr_b16 v[32:33], v10 offset:36864
    ds_read_b64_tr_b16 v[34:35], v10 offset:37008
    v_mfma_f32_16x16x32_bf16 v[80:83], v[56:59], v[120:123], v[80:83]
    ds_read_b64_tr_b16 v[36:37], v10 offset:36896
    ds_read_b64_tr_b16 v[38:39], v10 offset:37040
    v_mfma_f32_16x16x32_bf16 v[84:87], v[56:59], v[124:127], v[84:87]
    ds_read_b64_tr_b16 v[40:41], v10 offset:46080
    v_mfma_f32_16x16x32_bf16 v[88:91], v[60:63], v[120:123], v[88:91]
    ds_read_b64_tr_b16 v[42:43], v10 offset:46224
    v_mfma_f32_16x16x32_bf16 v[92:95], v[60:63], v[124:127], v[92:95]
    ds_read_b64_tr_b16 v[44:45], v10 offset:46112
    v_mfma_f32_16x16x32_bf16 v[96:99], v[64:67], v[120:123], v[96:99]
    ds_read_b64_tr_b16 v[46:47], v10 offset:46256
    v_mfma_f32_16x16x32_bf16 v[100:103], v[64:67], v[124:127], v[100:103]
    ds_read_b64_tr_b16 v[48:49], v11 offset:36864
    v_mfma_f32_16x16x32_bf16 v[104:107], v[68:71], v[120:123], v[104:107]
    ds_read_b64_tr_b16 v[50:51], v11 offset:37008
    v_mfma_f32_16x16x32_bf16 v[108:111], v[68:71], v[124:127], v[108:111]
    s_waitcnt lgkmcnt(8)
    v_mfma_f32_16x16x32_bf16 v[72:75], v[32:35], v[112:115], v[72:75]
    ds_read_b128 v[120:123], v9 offset:20480
    ds_read_b128 v[124:127], v9 offset:22528
    v_mfma_f32_16x16x32_bf16 v[76:79], v[32:35], v[116:119], v[76:79]
    ds_read_b64_tr_b16 v[52:53], v10 offset:41472
    ds_read_b64_tr_b16 v[54:55], v10 offset:41616
    s_waitcnt lgkmcnt(10)
    v_mfma_f32_16x16x32_bf16 v[80:83], v[36:39], v[112:115], v[80:83]
    ds_read_b64_tr_b16 v[56:57], v10 offset:41504
    ds_read_b64_tr_b16 v[58:59], v10 offset:41648
    v_mfma_f32_16x16x32_bf16 v[84:87], v[36:39], v[116:119], v[84:87]
    ds_read_b64_tr_b16 v[60:61], v10 offset:50688
    s_waitcnt lgkmcnt(11)
    v_mfma_f32_16x16x32_bf16 v[88:91], v[40:43], v[112:115], v[88:91]
    ds_read_b64_tr_b16 v[62:63], v10 offset:50832
    v_mfma_f32_16x16x32_bf16 v[92:95], v[40:43], v[116:119], v[92:95]
    ds_read_b64_tr_b16 v[64:65], v10 offset:50720
    s_waitcnt lgkmcnt(11)
    v_mfma_f32_16x16x32_bf16 v[96:99], v[44:47], v[112:115], v[96:99]
    ds_read_b64_tr_b16 v[66:67], v10 offset:50864
    v_mfma_f32_16x16x32_bf16 v[100:103], v[44:47], v[116:119], v[100:103]
    ds_read_b64_tr_b16 v[68:69], v11 offset:41472
    s_waitcnt lgkmcnt(11)
    v_mfma_f32_16x16x32_bf16 v[104:107], v[48:51], v[112:115], v[104:107]
    ds_read_b64_tr_b16 v[70:71], v11 offset:41616
    v_mfma_f32_16x16x32_bf16 v[108:111], v[48:51], v[116:119], v[108:111]
    s_add_u32 s66, s89, 0
    s_sub_u32 s15, s66, 3
    s_cmp_ge_u32 s66, 3
    s_cselect_b32 s66, s15, s66
    s_add_u32 s66, s66, 6
    s_mul_i32 s66, s66, 221184
    s_add_u32 s67, s66, s92
    s_add_u32 m0, s70, 18432
    s_mov_b32 exec_hi, 0x7fffffff
    buffer_load_dwordx4 v5, s[48:51], s67 offen lds
    s_mov_b64 exec, -1
    s_add_u32 m0, s70, 19440
    s_mov_b32 exec_hi, 0x7fffffff
    buffer_load_dwordx4 v6, s[48:51], s67 offen lds
    s_mov_b64 exec, -1
    s_add_u32 m0, s70, 20448
    s_mov_b64 exec, 0x3ffff
    buffer_load_dwordx4 v7, s[48:51], s67 offen lds
    s_mov_b64 exec, -1
    s_add_u32 s67, s66, s93
    s_add_u32 m0, s70, 27648
    s_mov_b32 exec_hi, 0x7fffffff
    buffer_load_dwordx4 v5, s[48:51], s67 offen lds
    s_mov_b64 exec, -1
    s_add_u32 m0, s70, 28656
    s_mov_b32 exec_hi, 0x7fffffff
    buffer_load_dwordx4 v6, s[48:51], s67 offen lds
    s_mov_b64 exec, -1
    s_add_u32 m0, s70, 29664
    s_mov_b64 exec, 0x3ffff
    buffer_load_dwordx4 v7, s[48:51], s67 offen lds
    s_mov_b64 exec, -1
    s_waitcnt vmcnt(6) lgkmcnt(0)
    s_barrier
    v_mfma_f32_16x16x32_bf16 v[72:75], v[52:55], v[120:123], v[72:75]
    ds_read_b128 v[112:115], v8 offset:40960
    ds_read_b128 v[116:119], v8 offset:43008
    v_mfma_f32_16x16x32_bf16 v[76:79], v[52:55], v[124:127], v[76:79]
    ds_read_b64_tr_b16 v[32:33], v10 offset:0
    ds_read_b64_tr_b16 v[34:35], v10 offset:144
    v_mfma_f32_16x16x32_bf16 v[80:83], v[56:59], v[120:123], v[80:83]
    ds_read_b64_tr_b16 v[36:37], v10 offset:32
    ds_read_b64_tr_b16 v[38:39], v10 offset:176
    v_mfma_f32_16x16x32_bf16 v[84:87], v[56:59], v[124:127], v[84:87]
    ds_read_b64_tr_b16 v[40:41], v10 offset:9216
    v_mfma_f32_16x16x32_bf16 v[88:91], v[60:63], v[120:123], v[88:91]
    ds_read_b64_tr_b16 v[42:43], v10 offset:9360
    v_mfma_f32_16x16x32_bf16 v[92:95], v[60:63], v[124:127], v[92:95]
    ds_read_b64_tr_b16 v[44:45], v10 offset:9248
    v_mfma_f32_16x16x32_bf16 v[96:99], v[64:67], v[120:123], v[96:99]
    ds_read_b64_tr_b16 v[46:47], v10 offset:9392
    v_mfma_f32_16x16x32_bf16 v[100:103], v[64:67], v[124:127], v[100:103]
    ds_read_b64_tr_b16 v[48:49], v11 offset:0
    v_mfma_f32_16x16x32_bf16 v[104:107], v[68:71], v[120:123], v[104:107]
    ds_read_b64_tr_b16 v[50:51], v11 offset:144
    v_mfma_f32_16x16x32_bf16 v[108:111], v[68:71], v[124:127], v[108:111]
    s_waitcnt lgkmcnt(8)
    v_mfma_f32_16x16x32_bf16 v[72:75], v[32:35], v[112:115], v[72:75]
    ds_read_b128 v[120:123], v9 offset:40960
    ds_read_b128 v[124:127], v9 offset:43008
    v_mfma_f32_16x16x32_bf16 v[76:79], v[32:35], v[116:119], v[76:79]
    ds_read_b64_tr_b16 v[52:53], v10 offset:4608
    ds_read_b64_tr_b16 v[54:55], v10 offset:4752
    s_waitcnt lgkmcnt(10)
    v_mfma_f32_16x16x32_bf16 v[80:83], v[36:39], v[112:115], v[80:83]
    ds_read_b64_tr_b16 v[56:57], v10 offset:4640
    ds_read_b64_tr_b16 v[58:59], v10 offset:4784
    v_mfma_f32_16x16x32_bf16 v[84:87], v[36:39], v[116:119], v[84:87]
    ds_read_b64_tr_b16 v[60:61], v10 offset:13824
    s_waitcnt lgkmcnt(11)
    v_mfma_f32_16x16x32_bf16 v[88:91], v[40:43], v[112:115], v[88:91]
    ds_read_b64_tr_b16 v[62:63], v10 offset:13968
    v_mfma_f32_16x16x32_bf16 v[92:95], v[40:43], v[116:119], v[92:95]
    ds_read_b64_tr_b16 v[64:65], v10 offset:13856
    s_waitcnt lgkmcnt(11)
    v_mfma_f32_16x16x32_bf16 v[96:99], v[44:47], v[112:115], v[96:99]
    ds_read_b64_tr_b16 v[66:67], v10 offset:14000
    v_mfma_f32_16x16x32_bf16 v[100:103], v[44:47], v[116:119], v[100:103]
    ds_read_b64_tr_b16 v[68:69], v11 offset:4608
    s_waitcnt lgkmcnt(11)
    v_mfma_f32_16x16x32_bf16 v[104:107], v[48:51], v[112:115], v[104:107]
    ds_read_b64_tr_b16 v[70:71], v11 offset:4752
    v_mfma_f32_16x16x32_bf16 v[108:111], v[48:51], v[116:119], v[108:111]
    s_add_u32 s66, s89, 1
    s_sub_u32 s15, s66, 3
    s_cmp_ge_u32 s66, 3
    s_cselect_b32 s66, s15, s66
    s_add_u32 s66, s66, 6
    s_mul_i32 s66, s66, 221184
    s_add_u32 s67, s66, s92
    s_add_u32 m0, s70, 36864
    s_mov_b32 exec_hi, 0x7fffffff
    buffer_load_dwordx4 v5, s[48:51], s67 offen lds
    s_mov_b64 exec, -1
    s_add_u32 m0, s70, 37872
    s_mov_b32 exec_hi, 0x7fffffff
    buffer_load_dwordx4 v6, s[48:51], s67 offen lds
    s_mov_b64 exec, -1
    s_add_u32 m0, s70, 38880
    s_mov_b64 exec, 0x3ffff
    buffer_load_dwordx4 v7, s[48:51], s67 offen lds
    s_mov_b64 exec, -1
    s_add_u32 s67, s66, s93
    s_add_u32 m0, s70, 46080
    s_mov_b32 exec_hi, 0x7fffffff
    buffer_load_dwordx4 v5, s[48:51], s67 offen lds
    s_mov_b64 exec, -1
    s_add_u32 m0, s70, 47088
    s_mov_b32 exec_hi, 0x7fffffff
    buffer_load_dwordx4 v6, s[48:51], s67 offen lds
    s_mov_b64 exec, -1
    s_add_u32 m0, s70, 48096
    s_mov_b64 exec, 0x3ffff
    buffer_load_dwordx4 v7, s[48:51], s67 offen lds
    s_mov_b64 exec, -1
    s_waitcnt vmcnt(6) lgkmcnt(0)
    s_barrier
    global_load_dword v18, v30, s[40:41] sc1
    v_mfma_f32_16x16x32_bf16 v[72:75], v[52:55], v[120:123], v[72:75]
    ds_read_b128 v[112:115], v8 offset:0
    ds_read_b128 v[116:119], v8 offset:2048
    v_mfma_f32_16x16x32_bf16 v[76:79], v[52:55], v[124:127], v[76:79]
    ds_read_b64_tr_b16 v[32:33], v10 offset:18432
    ds_read_b64_tr_b16 v[34:35], v10 offset:18576
    v_mfma_f32_16x16x32_bf16 v[80:83], v[56:59], v[120:123], v[80:83]
    ds_read_b64_tr_b16 v[36:37], v10 offset:18464
    ds_read_b64_tr_b16 v[38:39], v10 offset:18608
    v_mfma_f32_16x16x32_bf16 v[84:87], v[56:59], v[124:127], v[84:87]
    ds_read_b64_tr_b16 v[40:41], v10 offset:27648
    v_mfma_f32_16x16x32_bf16 v[88:91], v[60:63], v[120:123], v[88:91]
    ds_read_b64_tr_b16 v[42:43], v10 offset:27792
    v_mfma_f32_16x16x32_bf16 v[92:95], v[60:63], v[124:127], v[92:95]
    ds_read_b64_tr_b16 v[44:45], v10 offset:27680
    v_mfma_f32_16x16x32_bf16 v[96:99], v[64:67], v[120:123], v[96:99]
    ds_read_b64_tr_b16 v[46:47], v10 offset:27824
    v_mfma_f32_16x16x32_bf16 v[100:103], v[64:67], v[124:127], v[100:103]
    ds_read_b64_tr_b16 v[48:49], v11 offset:18432
    v_mfma_f32_16x16x32_bf16 v[104:107], v[68:71], v[120:123], v[104:107]
    ds_read_b64_tr_b16 v[50:51], v11 offset:18576
    v_mfma_f32_16x16x32_bf16 v[108:111], v[68:71], v[124:127], v[108:111]
    s_waitcnt lgkmcnt(8)
    v_mfma_f32_16x16x32_bf16 v[72:75], v[32:35], v[112:115], v[72:75]
    ds_read_b128 v[120:123], v9 offset:0
    ds_read_b128 v[124:127], v9 offset:2048
    v_mfma_f32_16x16x32_bf16 v[76:79], v[32:35], v[116:119], v[76:79]
    ds_read_b64_tr_b16 v[52:53], v10 offset:23040
    ds_read_b64_tr_b16 v[54:55], v10 offset:23184
    s_waitcnt lgkmcnt(10)
    v_mfma_f32_16x16x32_bf16 v[80:83], v[36:39], v[112:115], v[80:83]
    ds_read_b64_tr_b16 v[56:57], v10 offset:23072
    ds_read_b64_tr_b16 v[58:59], v10 offset:23216
    v_mfma_f32_16x16x32_bf16 v[84:87], v[36:39], v[116:119], v[84:87]
    ds_read_b64_tr_b16 v[60:61], v10 offset:32256
    s_waitcnt lgkmcnt(11)
    v_mfma_f32_16x16x32_bf16 v[88:91], v[40:43], v[112:115], v[88:91]
    ds_read_b64_tr_b16 v[62:63], v10 offset:32400
    v_mfma_f32_16x16x32_bf16 v[92:95], v[40:43], v[116:119], v[92:95]
    ds_read_b64_tr_b16 v[64:65], v10 offset:32288
    s_waitcnt lgkmcnt(11)
    v_mfma_f32_16x16x32_bf16 v[96:99], v[44:47], v[112:115], v[96:99]
    ds_read_b64_tr_b16 v[66:67], v10 offset:32432
    v_mfma_f32_16x16x32_bf16 v[100:103], v[44:47], v[116:119], v[100:103]
    ds_read_b64_tr_b16 v[68:69], v11 offset:23040
    s_waitcnt lgkmcnt(11)
    v_mfma_f32_16x16x32_bf16 v[104:107], v[48:51], v[112:115], v[104:107]
    ds_read_b64_tr_b16 v[70:71], v11 offset:23184
    v_mfma_f32_16x16x32_bf16 v[108:111], v[48:51], v[116:119], v[108:111]
    s_add_u32 s66, s89, 2
    s_sub_u32 s15, s66, 3
    s_cmp_ge_u32 s66, 3
    s_cselect_b32 s66, s15, s66
    s_add_u32 s66, s66, 6
    s_mul_i32 s66, s66, 221184
    s_add_u32 s67, s66, s92
    s_add_u32 m0, s70, 0
    s_mov_b32 exec_hi, 0x7fffffff
    buffer_load_dwordx4 v5, s[48:51], s67 offen lds
    s_mov_b64 exec, -1
    s_add_u32 m0, s70, 1008
    s_mov_b32 exec_hi, 0x7fffffff
    buffer_load_dwordx4 v6, s[48:51], s67 offen lds
    s_mov_b64 exec, -1
    s_add_u32 m0, s70, 2016
    s_mov_b64 exec, 0x3ffff
    buffer_load_dwordx4 v7, s[48:51], s67 offen lds
    s_mov_b64 exec, -1
    s_add_u32 s67, s66, s93
    s_add_u32 m0, s70, 9216
    s_mov_b32 exec_hi, 0x7fffffff
    buffer_load_dwordx4 v5, s[48:51], s67 offen lds
    s_mov_b64 exec, -1
    s_add_u32 m0, s70, 10224
    s_mov_b32 exec_hi, 0x7fffffff
    buffer_load_dwordx4 v6, s[48:51], s67 offen lds
    s_mov_b64 exec, -1
    s_add_u32 m0, s70, 11232
    s_mov_b64 exec, 0x3ffff
    buffer_load_dwordx4 v7, s[48:51], s67 offen lds
    s_mov_b64 exec, -1
    s_waitcnt vmcnt(7) lgkmcnt(0)
    s_barrier
    v_mfma_f32_16x16x32_bf16 v[72:75], v[52:55], v[120:123], v[72:75]
    ds_read_b128 v[112:115], v8 offset:20480
    ds_read_b128 v[116:119], v8 offset:22528
    v_mfma_f32_16x16x32_bf16 v[76:79], v[52:55], v[124:127], v[76:79]
    ds_read_b64_tr_b16 v[32:33], v10 offset:36864
    ds_read_b64_tr_b16 v[34:35], v10 offset:37008
    v_mfma_f32_16x16x32_bf16 v[80:83], v[56:59], v[120:123], v[80:83]
    ds_read_b64_tr_b16 v[36:37], v10 offset:36896
    ds_read_b64_tr_b16 v[38:39], v10 offset:37040
    v_mfma_f32_16x16x32_bf16 v[84:87], v[56:59], v[124:127], v[84:87]
    ds_read_b64_tr_b16 v[40:41], v10 offset:46080
    v_mfma_f32_16x16x32_bf16 v[88:91], v[60:63], v[120:123], v[88:91]
    ds_read_b64_tr_b16 v[42:43], v10 offset:46224
    v_mfma_f32_16x16x32_bf16 v[92:95], v[60:63], v[124:127], v[92:95]
    ds_read_b64_tr_b16 v[44:45], v10 offset:46112
    v_mfma_f32_16x16x32_bf16 v[96:99], v[64:67], v[120:123], v[96:99]
    ds_read_b64_tr_b16 v[46:47], v10 offset:46256
    v_mfma_f32_16x16x32_bf16 v[100:103], v[64:67], v[124:127], v[100:103]
    ds_read_b64_tr_b16 v[48:49], v11 offset:36864
    v_mfma_f32_16x16x32_bf16 v[104:107], v[68:71], v[120:123], v[104:107]
    ds_read_b64_tr_b16 v[50:51], v11 offset:37008
    v_mfma_f32_16x16x32_bf16 v[108:111], v[68:71], v[124:127], v[108:111]
    s_waitcnt lgkmcnt(8)
    v_mfma_f32_16x16x32_bf16 v[72:75], v[32:35], v[112:115], v[72:75]
    ds_read_b128 v[120:123], v9 offset:20480
    ds_read_b128 v[124:127], v9 offset:22528
    v_mfma_f32_16x16x32_bf16 v[76:79], v[32:35], v[116:119], v[76:79]
    ds_read_b64_tr_b16 v[52:53], v10 offset:41472
    ds_read_b64_tr_b16 v[54:55], v10 offset:41616
    s_waitcnt lgkmcnt(10)
    v_mfma_f32_16x16x32_bf16 v[80:83], v[36:39], v[112:115], v[80:83]
    ds_read_b64_tr_b16 v[56:57], v10 offset:41504
    ds_read_b64_tr_b16 v[58:59], v10 offset:41648
    v_mfma_f32_16x16x32_bf16 v[84:87], v[36:39], v[116:119], v[84:87]
    ds_read_b64_tr_b16 v[60:61], v10 offset:50688
    s_waitcnt lgkmcnt(11)
    v_mfma_f32_16x16x32_bf16 v[88:91], v[40:43], v[112:115], v[88:91]
    ds_read_b64_tr_b16 v[62:63], v10 offset:50832
    v_mfma_f32_16x16x32_bf16 v[92:95], v[40:43], v[116:119], v[92:95]
    ds_read_b64_tr_b16 v[64:65], v10 offset:50720
    s_waitcnt lgkmcnt(11)
    v_mfma_f32_16x16x32_bf16 v[96:99], v[44:47], v[112:115], v[96:99]
    ds_read_b64_tr_b16 v[66:67], v10 offset:50864
    v_mfma_f32_16x16x32_bf16 v[100:103], v[44:47], v[116:119], v[100:103]
    ds_read_b64_tr_b16 v[68:69], v11 offset:41472
    s_waitcnt lgkmcnt(11)
    v_mfma_f32_16x16x32_bf16 v[104:107], v[48:51], v[112:115], v[104:107]
    ds_read_b64_tr_b16 v[70:71], v11 offset:41616
    v_mfma_f32_16x16x32_bf16 v[108:111], v[48:51], v[116:119], v[108:111]
    s_waitcnt vmcnt(0) lgkmcnt(0)
    s_barrier
    v_mfma_f32_16x16x32_bf16 v[72:75], v[52:55], v[120:123], v[72:75]
    ds_read_b128 v[112:115], v8 offset:40960
    ds_read_b128 v[116:119], v8 offset:43008
    v_mfma_f32_16x16x32_bf16 v[76:79], v[52:55], v[124:127], v[76:79]
    ds_read_b64_tr_b16 v[32:33], v10 offset:0
    ds_read_b64_tr_b16 v[34:35], v10 offset:144
    v_mfma_f32_16x16x32_bf16 v[80:83], v[56:59], v[120:123], v[80:83]
    ds_read_b64_tr_b16 v[36:37], v10 offset:32
    ds_read_b64_tr_b16 v[38:39], v10 offset:176
    v_mfma_f32_16x16x32_bf16 v[84:87], v[56:59], v[124:127], v[84:87]
    ds_read_b64_tr_b16 v[40:41], v10 offset:9216
    v_mfma_f32_16x16x32_bf16 v[88:91], v[60:63], v[120:123], v[88:91]
    ds_read_b64_tr_b16 v[42:43], v10 offset:9360
    v_mfma_f32_16x16x32_bf16 v[92:95], v[60:63], v[124:127], v[92:95]
    ds_read_b64_tr_b16 v[44:45], v10 offset:9248
    v_mfma_f32_16x16x32_bf16 v[96:99], v[64:67], v[120:123], v[96:99]
    ds_read_b64_tr_b16 v[46:47], v10 offset:9392
    v_mfma_f32_16x16x32_bf16 v[100:103], v[64:67], v[124:127], v[100:103]
    ds_read_b64_tr_b16 v[48:49], v11 offset:0
    v_mfma_f32_16x16x32_bf16 v[104:107], v[68:71], v[120:123], v[104:107]
    ds_read_b64_tr_b16 v[50:51], v11 offset:144
    v_mfma_f32_16x16x32_bf16 v[108:111], v[68:71], v[124:127], v[108:111]
    s_waitcnt lgkmcnt(8)
    v_mfma_f32_16x16x32_bf16 v[72:75], v[32:35], v[112:115], v[72:75]
    ds_read_b128 v[120:123], v9 offset:40960
    ds_read_b128 v[124:127], v9 offset:43008
    v_mfma_f32_16x16x32_bf16 v[76:79], v[32:35], v[116:119], v[76:79]
    ds_read_b64_tr_b16 v[52:53], v10 offset:4608
    ds_read_b64_tr_b16 v[54:55], v10 offset:4752
    s_waitcnt lgkmcnt(10)
    v_mfma_f32_16x16x32_bf16 v[80:83], v[36:39], v[112:115], v[80:83]
    ds_read_b64_tr_b16 v[56:57], v10 offset:4640
    ds_read_b64_tr_b16 v[58:59], v10 offset:4784
    v_mfma_f32_16x16x32_bf16 v[84:87], v[36:39], v[116:119], v[84:87]
    ds_read_b64_tr_b16 v[60:61], v10 offset:13824
    s_waitcnt lgkmcnt(11)
    v_mfma_f32_16x16x32_bf16 v[88:91], v[40:43], v[112:115], v[88:91]
    ds_read_b64_tr_b16 v[62:63], v10 offset:13968
    v_mfma_f32_16x16x32_bf16 v[92:95], v[40:43], v[116:119], v[92:95]
    ds_read_b64_tr_b16 v[64:65], v10 offset:13856
    s_waitcnt lgkmcnt(11)
    v_mfma_f32_16x16x32_bf16 v[96:99], v[44:47], v[112:115], v[96:99]
    ds_read_b64_tr_b16 v[66:67], v10 offset:14000
    v_mfma_f32_16x16x32_bf16 v[100:103], v[44:47], v[116:119], v[100:103]
    ds_read_b64_tr_b16 v[68:69], v11 offset:4608
    s_waitcnt lgkmcnt(11)
    v_mfma_f32_16x16x32_bf16 v[104:107], v[48:51], v[112:115], v[104:107]
    ds_read_b64_tr_b16 v[70:71], v11 offset:4752
    v_mfma_f32_16x16x32_bf16 v[108:111], v[48:51], v[116:119], v[108:111]
    s_waitcnt lgkmcnt(8)
    v_mfma_f32_16x16x32_bf16 v[72:75], v[52:55], v[120:123], v[72:75]
    v_mfma_f32_16x16x32_bf16 v[76:79], v[52:55], v[124:127], v[76:79]
    s_waitcnt lgkmcnt(6)
    v_mfma_f32_16x16x32_bf16 v[80:83], v[56:59], v[120:123], v[80:83]
    v_mfma_f32_16x16x32_bf16 v[84:87], v[56:59], v[124:127], v[84:87]
    s_waitcnt lgkmcnt(4)
    v_mfma_f32_16x16x32_bf16 v[88:91], v[60:63], v[120:123], v[88:91]
    v_mfma_f32_16x16x32_bf16 v[92:95], v[60:63], v[124:127], v[92:95]
    s_waitcnt lgkmcnt(2)
    v_mfma_f32_16x16x32_bf16 v[96:99], v[64:67], v[120:123], v[96:99]
    v_mfma_f32_16x16x32_bf16 v[100:103], v[64:67], v[124:127], v[100:103]
    s_waitcnt lgkmcnt(0)
    v_mfma_f32_16x16x32_bf16 v[104:107], v[68:71], v[120:123], v[104:107]
    v_mfma_f32_16x16x32_bf16 v[108:111], v[68:71], v[124:127], v[108:111]
    s_mov_b32 s74, 0
    v_cvt_pk_bf16_f32 v72, v72, v73
    v_cvt_pk_bf16_f32 v73, v74, v75
    v_cvt_pk_bf16_f32 v74, v80, v81
    v_cvt_pk_bf16_f32 v75, v82, v83
    v_cvt_pk_bf16_f32 v88, v88, v89
    v_cvt_pk_bf16_f32 v89, v90, v91
    v_cvt_pk_bf16_f32 v90, v96, v97
    v_cvt_pk_bf16_f32 v91, v98, v99
    v_cvt_pk_bf16_f32 v104, v104, v105
    v_cvt_pk_bf16_f32 v105, v106, v107
    buffer_store_dwordx4 v[72:75], v200, s[52:55], s74 offen sc1
    buffer_store_dwordx4 v[88:91], v200, s[52:55], s74 offen offset:2048 sc1
    buffer_store_dwordx2 v[104:105], v201, s[52:55], s74 offen sc1
    s_add_u32 s74, s74, 18432
    v_cvt_pk_bf16_f32 v76, v76, v77
    v_cvt_pk_bf16_f32 v77, v78, v79
    v_cvt_pk_bf16_f32 v78, v84, v85
    v_cvt_pk_bf16_f32 v79, v86, v87
    v_cvt_pk_bf16_f32 v92, v92, v93
    v_cvt_pk_bf16_f32 v93, v94, v95
    v_cvt_pk_bf16_f32 v94, v100, v101
    v_cvt_pk_bf16_f32 v95, v102, v103
    v_cvt_pk_bf16_f32 v108, v108, v109
    v_cvt_pk_bf16_f32 v109, v110, v111
    buffer_store_dwordx4 v[76:79], v200, s[52:55], s74 offen sc1
    buffer_store_dwordx4 v[92:95], v200, s[52:55], s74 offen offset:2048 sc1
    buffer_store_dwordx2 v[108:109], v201, s[52:55], s74 offen sc1
    s_add_u32 s74, s74, 18432
    s_branch Q_join
Q_v2:
    v_mov_b32 v30, 0
    v_lshrrev_b32 v21, 1, v22
    v_xor_b32 v21, v21, v19
    v_lshlrev_b32 v21, 4, v21
    v_lshl_add_u32 v8, v22, 7, v21
    s_lshl_b32 s14, s68, 11
    v_add_u32 v8, s14, v8
    v_xor_b32 v9, 64, v8
    v_lshlrev_b32 v21, 1, v23
    v_lshl_add_u32 v21, v19, 3, v21
    v_mul_u32_u24 v21, 144, v21
    v_add_u32 v21, 61512, v21
    v_lshl_add_u32 v10, v24, 3, v21
    v_and_b32 v20, 1, v24
    v_mul_u32_u24 v20, 9216, v20
    v_add3_u32 v11, v21, v20, 64

    v_lshrrev_b32 v20, 1, v24
    v_mul_u32_u24 v20, 72, v20
    v_add_u32 v11, v11, v20
    v_subrev_u32 v11, 72, v11
    s_mul_i32 s14, s4, 10
    s_add_u32 s14, s14, s68
    s_mul_i32 s74, s14, 18432
    s_add_u32 s74, s74, 0x401000
    s_lshl_b32 s75, s5, 2
    s_add_u32 s75, s75, s13
    s_lshl_b32 s75, s75, 10
    s_add_u32 s75, s75, s74
    v_lshl_add_u32 v200, v2, 4, s75
    s_lshl_b32 s75, s5, 9
    s_add_u32 s75, s75, s74
    s_add_u32 s75, s75, 16384
    v_lshl_add_u32 v201, v2, 3, s75
    s_lshl_b32 s74, s3, 7
    s_add_u32 s74, s74, 0xdc000
    v_mov_b32 v202, s74

    s_add_u32 s64, s89, 1
    s_sub_u32 s15, s64, 3
    s_cmp_ge_u32 s64, 3
    s_cselect_b32 s64, s15, s64
    s_add_u32 s64, s64, 0
    s_mul_i32 s64, s64, 128
    s_add_u32 m0, s69, 20480
    s_nop 0
    buffer_load_dwordx4 v3, s[44:47], s64 offen lds
    s_add_u32 m0, s69, 21504
    s_nop 0
    buffer_load_dwordx4 v4, s[44:47], s64 offen lds
    s_add_u32 s65, s64, 18432
    s_add_u32 m0, s69, 22528
    s_nop 0
    buffer_load_dwordx4 v3, s[44:47], s65 offen lds
    s_add_u32 m0, s69, 23552
    s_nop 0
    buffer_load_dwordx4 v4, s[44:47], s65 offen lds
    v_lshlrev_b32 v250, 21, v24
    v_add_u32 v251, 0x1f0000, v250
    v_cmp_eq_u32 vcc, 0, v24
    v_mov_b32 v252, 0xf0000
    s_nop 0
    v_cndmask_b32 v251, v251, v252, vcc
    v_cmp_eq_u32 vcc, 2, v24
    v_mov_b32 v252, 0x400000
    s_nop 0
    v_cndmask_b32 v251, v251, v252, vcc
    s_mov_b64 exec, 15
    buffer_load_dword v253, v251, s[52:55], 0 offen
    buffer_load_dword v254, v250, s[56:59], 0 offen
    s_mov_b64 exec, -1

    s_waitcnt vmcnt(6) lgkmcnt(0)
    s_barrier
    s_add_u32 s64, s89, 2
    s_sub_u32 s15, s64, 3
    s_cmp_ge_u32 s64, 3
    s_cselect_b32 s64, s15, s64
    s_add_u32 s64, s64, 0
    s_mul_i32 s64, s64, 128
    s_add_u32 m0, s69, 40960
    s_nop 0
    buffer_load_dwordx4 v3, s[44:47], s64 offen lds
    s_add_u32 m0, s69, 41984
    s_nop 0
    buffer_load_dwordx4 v4, s[44:47], s64 offen lds
    s_add_u32 s65, s64, 18432
    s_add_u32 m0, s69, 43008
    s_nop 0
    buffer_load_dwordx4 v3, s[44:47], s65 offen lds
    s_add_u32 m0, s69, 44032
    s_nop 0
    buffer_load_dwordx4 v4, s[44:47], s65 offen lds
    ds_read_b128 v[112:115], v8 offset:0
    ds_read_b128 v[116:119], v8 offset:2048
    ds_read_b64_tr_b16 v[32:33], v10 offset:18432
    ds_read_b64_tr_b16 v[34:35], v10 offset:18576
    ds_read_b64_tr_b16 v[36:37], v10 offset:18464
    ds_read_b64_tr_b16 v[38:39], v10 offset:18608
    ds_read_b64_tr_b16 v[40:41], v10 offset:27648
    ds_read_b64_tr_b16 v[42:43], v10 offset:27792
    ds_read_b64_tr_b16 v[44:45], v10 offset:27680
    ds_read_b64_tr_b16 v[46:47], v10 offset:27824
    ds_read_b64_tr_b16 v[48:49], v11 offset:18432
    ds_read_b64_tr_b16 v[50:51], v11 offset:18576
    s_waitcnt lgkmcnt(8)
    v_mfma_f32_16x16x32_bf16 v[72:75], v[32:35], v[112:115], 0
    ds_read_b128 v[120:123], v9 offset:0
    ds_read_b128 v[124:127], v9 offset:2048
    v_mfma_f32_16x16x32_bf16 v[76:79], v[32:35], v[116:119], 0
    ds_read_b64_tr_b16 v[52:53], v10 offset:23040
    ds_read_b64_tr_b16 v[54:55], v10 offset:23184
    s_waitcnt lgkmcnt(10)
    v_mfma_f32_16x16x32_bf16 v[80:83], v[36:39], v[112:115], 0
    ds_read_b64_tr_b16 v[56:57], v10 offset:23072
    ds_read_b64_tr_b16 v[58:59], v10 offset:23216
    v_mfma_f32_16x16x32_bf16 v[84:87], v[36:39], v[116:119], 0
    ds_read_b64_tr_b16 v[60:61], v10 offset:32256
    s_waitcnt lgkmcnt(11)
    v_mfma_f32_16x16x32_bf16 v[88:91], v[40:43], v[112:115], 0
    ds_read_b64_tr_b16 v[62:63], v10 offset:32400
    v_mfma_f32_16x16x32_bf16 v[92:95], v[40:43], v[116:119], 0
    ds_read_b64_tr_b16 v[64:65], v10 offset:32288
    s_waitcnt lgkmcnt(11)
    v_mfma_f32_16x16x32_bf16 v[96:99], v[44:47], v[112:115], 0
    ds_read_b64_tr_b16 v[66:67], v10 offset:32432
    v_mfma_f32_16x16x32_bf16 v[100:103], v[44:47], v[116:119], 0
    ds_read_b64_tr_b16 v[68:69], v11 offset:23040
    s_waitcnt lgkmcnt(11)
    v_mfma_f32_16x16x32_bf16 v[104:107], v[48:51], v[112:115], 0
    ds_read_b64_tr_b16 v[70:71], v11 offset:23184
    v_mfma_f32_16x16x32_bf16 v[108:111], v[48:51], v[116:119], 0
    s_waitcnt vmcnt(6) lgkmcnt(0)
    s_barrier
    s_add_u32 s64, s89, 0
    s_sub_u32 s15, s64, 3
    s_cmp_ge_u32 s64, 3
    s_cselect_b32 s64, s15, s64
    s_add_u32 s64, s64, 3
    s_mul_i32 s64, s64, 128
    s_add_u32 m0, s69, 0
    s_nop 0
    buffer_load_dwordx4 v3, s[44:47], s64 offen lds
    s_add_u32 m0, s69, 1024
    s_nop 0
    buffer_load_dwordx4 v4, s[44:47], s64 offen lds
    s_add_u32 s65, s64, 18432
    s_add_u32 m0, s69, 2048
    s_nop 0
    buffer_load_dwordx4 v3, s[44:47], s65 offen lds
    s_add_u32 m0, s69, 3072
    s_nop 0
    buffer_load_dwordx4 v4, s[44:47], s65 offen lds
    v_mfma_f32_16x16x32_bf16 v[72:75], v[52:55], v[120:123], v[72:75]
    ds_read_b128 v[112:115], v8 offset:20480
    ds_read_b128 v[116:119], v8 offset:22528
    v_mfma_f32_16x16x32_bf16 v[76:79], v[52:55], v[124:127], v[76:79]
    ds_read_b64_tr_b16 v[32:33], v10 offset:36864
    ds_read_b64_tr_b16 v[34:35], v10 offset:37008
    v_mfma_f32_16x16x32_bf16 v[80:83], v[56:59], v[120:123], v[80:83]
    ds_read_b64_tr_b16 v[36:37], v10 offset:36896
    ds_read_b64_tr_b16 v[38:39], v10 offset:37040
    v_mfma_f32_16x16x32_bf16 v[84:87], v[56:59], v[124:127], v[84:87]
    ds_read_b64_tr_b16 v[40:41], v10 offset:46080
    v_mfma_f32_16x16x32_bf16 v[88:91], v[60:63], v[120:123], v[88:91]
    ds_read_b64_tr_b16 v[42:43], v10 offset:46224
    v_mfma_f32_16x16x32_bf16 v[92:95], v[60:63], v[124:127], v[92:95]
    ds_read_b64_tr_b16 v[44:45], v10 offset:46112
    v_mfma_f32_16x16x32_bf16 v[96:99], v[64:67], v[120:123], v[96:99]
    ds_read_b64_tr_b16 v[46:47], v10 offset:46256
    v_mfma_f32_16x16x32_bf16 v[100:103], v[64:67], v[124:127], v[100:103]
    ds_read_b64_tr_b16 v[48:49], v11 offset:36864
    v_mfma_f32_16x16x32_bf16 v[104:107], v[68:71], v[120:123], v[104:107]
    ds_read_b64_tr_b16 v[50:51], v11 offset:37008
    v_mfma_f32_16x16x32_bf16 v[108:111], v[68:71], v[124:127], v[108:111]
    s_waitcnt lgkmcnt(8)
    v_mfma_f32_16x16x32_bf16 v[72:75], v[32:35], v[112:115], v[72:75]
    ds_read_b128 v[120:123], v9 offset:20480
    ds_read_b128 v[124:127], v9 offset:22528
    v_mfma_f32_16x16x32_bf16 v[76:79], v[32:35], v[116:119], v[76:79]
    ds_read_b64_tr_b16 v[52:53], v10 offset:41472
    ds_read_b64_tr_b16 v[54:55], v10 offset:41616
    s_waitcnt lgkmcnt(10)
    v_mfma_f32_16x16x32_bf16 v[80:83], v[36:39], v[112:115], v[80:83]
    ds_read_b64_tr_b16 v[56:57], v10 offset:41504
    ds_read_b64_tr_b16 v[58:59], v10 offset:41648
    v_mfma_f32_16x16x32_bf16 v[84:87], v[36:39], v[116:119], v[84:87]
    ds_read_b64_tr_b16 v[60:61], v10 offset:50688
    s_waitcnt lgkmcnt(11)
    v_mfma_f32_16x16x32_bf16 v[88:91], v[40:43], v[112:115], v[88:91]
    ds_read_b64_tr_b16 v[62:63], v10 offset:50832
    v_mfma_f32_16x16x32_bf16 v[92:95], v[40:43], v[116:119], v[92:95]
    ds_read_b64_tr_b16 v[64:65], v10 offset:50720
    s_waitcnt lgkmcnt(11)
    v_mfma_f32_16x16x32_bf16 v[96:99], v[44:47], v[112:115], v[96:99]
    ds_read_b64_tr_b16 v[66:67], v10 offset:50864
    v_mfma_f32_16x16x32_bf16 v[100:103], v[44:47], v[116:119], v[100:103]
    ds_read_b64_tr_b16 v[68:69], v11 offset:41472
    s_waitcnt lgkmcnt(11)
    v_mfma_f32_16x16x32_bf16 v[104:107], v[48:51], v[112:115], v[104:107]
    ds_read_b64_tr_b16 v[70:71], v11 offset:41616
    v_mfma_f32_16x16x32_bf16 v[108:111], v[48:51], v[116:119], v[108:111]
    s_waitcnt vmcnt(4) lgkmcnt(0)
    s_barrier
    s_add_u32 s64, s89, 1
    s_sub_u32 s15, s64, 3
    s_cmp_ge_u32 s64, 3
    s_cselect_b32 s64, s15, s64
    s_add_u32 s64, s64, 3
    s_mul_i32 s64, s64, 128
    s_add_u32 m0, s69, 20480
    s_nop 0
    buffer_load_dwordx4 v3, s[44:47], s64 offen lds
    s_add_u32 m0, s69, 21504
    s_nop 0
    buffer_load_dwordx4 v4, s[44:47], s64 offen lds
    s_add_u32 s65, s64, 18432
    s_add_u32 m0, s69, 22528
    s_nop 0
    buffer_load_dwordx4 v3, s[44:47], s65 offen lds
    s_add_u32 m0, s69, 23552
    s_nop 0
    buffer_load_dwordx4 v4, s[44:47], s65 offen lds
    v_mfma_f32_16x16x32_bf16 v[72:75], v[52:55], v[120:123], v[72:75]
    ds_read_b128 v[112:115], v8 offset:40960
    ds_read_b128 v[116:119], v8 offset:43008
    v_mfma_f32_16x16x32_bf16 v[76:79], v[52:55], v[124:127], v[76:79]
    ds_read_b64_tr_b16 v[32:33], v10 offset:0
    ds_read_b64_tr_b16 v[34:35], v10 offset:144
    v_mfma_f32_16x16x32_bf16 v[80:83], v[56:59], v[120:123], v[80:83]
    ds_read_b64_tr_b16 v[36:37], v10 offset:32
    ds_read_b64_tr_b16 v[38:39], v10 offset:176
    v_mfma_f32_16x16x32_bf16 v[84:87], v[56:59], v[124:127], v[84:87]
    ds_read_b64_tr_b16 v[40:41], v10 offset:9216
    v_mfma_f32_16x16x32_bf16 v[88:91], v[60:63], v[120:123], v[88:91]
    ds_read_b64_tr_b16 v[42:43], v10 offset:9360
    v_mfma_f32_16x16x32_bf16 v[92:95], v[60:63], v[124:127], v[92:95]
    ds_read_b64_tr_b16 v[44:45], v10 offset:9248
    v_mfma_f32_16x16x32_bf16 v[96:99], v[64:67], v[120:123], v[96:99]
    ds_read_b64_tr_b16 v[46:47], v10 offset:9392
    v_mfma_f32_16x16x32_bf16 v[100:103], v[64:67], v[124:127], v[100:103]
    ds_read_b64_tr_b16 v[48:49], v11 offset:0
    v_mfma_f32_16x16x32_bf16 v[104:107], v[68:71], v[120:123], v[104:107]
    ds_read_b64_tr_b16 v[50:51], v11 offset:144
    v_mfma_f32_16x16x32_bf16 v[108:111], v[68:71], v[124:127], v[108:111]
    s_waitcnt lgkmcnt(8)
    v_mfma_f32_16x16x32_bf16 v[72:75], v[32:35], v[112:115], v[72:75]
    ds_read_b128 v[120:123], v9 offset:40960
    ds_read_b128 v[124:127], v9 offset:43008
    v_mfma_f32_16x16x32_bf16 v[76:79], v[32:35], v[116:119], v[76:79]
    ds_read_b64_tr_b16 v[52:53], v10 offset:4608
    ds_read_b64_tr_b16 v[54:55], v10 offset:4752
    s_waitcnt lgkmcnt(10)
    v_mfma_f32_16x16x32_bf16 v[80:83], v[36:39], v[112:115], v[80:83]
    ds_read_b64_tr_b16 v[56:57], v10 offset:4640
    ds_read_b64_tr_b16 v[58:59], v10 offset:4784
    v_mfma_f32_16x16x32_bf16 v[84:87], v[36:39], v[116:119], v[84:87]
    ds_read_b64_tr_b16 v[60:61], v10 offset:13824
    s_waitcnt lgkmcnt(11)
    v_mfma_f32_16x16x32_bf16 v[88:91], v[40:43], v[112:115], v[88:91]
    ds_read_b64_tr_b16 v[62:63], v10 offset:13968
    v_mfma_f32_16x16x32_bf16 v[92:95], v[40:43], v[116:119], v[92:95]
    ds_read_b64_tr_b16 v[64:65], v10 offset:13856
    s_waitcnt lgkmcnt(11)
    v_mfma_f32_16x16x32_bf16 v[96:99], v[44:47], v[112:115], v[96:99]
    ds_read_b64_tr_b16 v[66:67], v10 offset:14000
    v_mfma_f32_16x16x32_bf16 v[100:103], v[44:47], v[116:119], v[100:103]
    ds_read_b64_tr_b16 v[68:69], v11 offset:4608
    s_waitcnt lgkmcnt(11)
    v_mfma_f32_16x16x32_bf16 v[104:107], v[48:51], v[112:115], v[104:107]
    ds_read_b64_tr_b16 v[70:71], v11 offset:4752
    v_mfma_f32_16x16x32_bf16 v[108:111], v[48:51], v[116:119], v[108:111]
    s_waitcnt vmcnt(4) lgkmcnt(0)
    s_barrier
    s_add_u32 s64, s89, 2
    s_sub_u32 s15, s64, 3
    s_cmp_ge_u32 s64, 3
    s_cselect_b32 s64, s15, s64
    s_add_u32 s64, s64, 3
    s_mul_i32 s64, s64, 128
    s_add_u32 m0, s69, 40960
    s_nop 0
    buffer_load_dwordx4 v3, s[44:47], s64 offen lds
    s_add_u32 m0, s69, 41984
    s_nop 0
    buffer_load_dwordx4 v4, s[44:47], s64 offen lds
    s_add_u32 s65, s64, 18432
    s_add_u32 m0, s69, 43008
    s_nop 0
    buffer_load_dwordx4 v3, s[44:47], s65 offen lds
    s_add_u32 m0, s69, 44032
    s_nop 0
    buffer_load_dwordx4 v4, s[44:47], s65 offen lds
    v_mfma_f32_16x16x32_bf16 v[72:75], v[52:55], v[120:123], v[72:75]
    ds_read_b128 v[112:115], v8 offset:0
    ds_read_b128 v[116:119], v8 offset:2048
    v_mfma_f32_16x16x32_bf16 v[76:79], v[52:55], v[124:127], v[76:79]
    ds_read_b64_tr_b16 v[32:33], v10 offset:18432
    ds_read_b64_tr_b16 v[34:35], v10 offset:18576
    v_mfma_f32_16x16x32_bf16 v[80:83], v[56:59], v[120:123], v[80:83]
    ds_read_b64_tr_b16 v[36:37], v10 offset:18464
    ds_read_b64_tr_b16 v[38:39], v10 offset:18608
    v_mfma_f32_16x16x32_bf16 v[84:87], v[56:59], v[124:127], v[84:87]
    ds_read_b64_tr_b16 v[40:41], v10 offset:27648
    v_mfma_f32_16x16x32_bf16 v[88:91], v[60:63], v[120:123], v[88:91]
    ds_read_b64_tr_b16 v[42:43], v10 offset:27792
    v_mfma_f32_16x16x32_bf16 v[92:95], v[60:63], v[124:127], v[92:95]
    ds_read_b64_tr_b16 v[44:45], v10 offset:27680
    v_mfma_f32_16x16x32_bf16 v[96:99], v[64:67], v[120:123], v[96:99]
    ds_read_b64_tr_b16 v[46:47], v10 offset:27824
    v_mfma_f32_16x16x32_bf16 v[100:103], v[64:67], v[124:127], v[100:103]
    ds_read_b64_tr_b16 v[48:49], v11 offset:18432
    v_mfma_f32_16x16x32_bf16 v[104:107], v[68:71], v[120:123], v[104:107]
    ds_read_b64_tr_b16 v[50:51], v11 offset:18576
    v_mfma_f32_16x16x32_bf16 v[108:111], v[68:71], v[124:127], v[108:111]
    s_waitcnt lgkmcnt(8)
    v_mfma_f32_16x16x32_bf16 v[72:75], v[32:35], v[112:115], v[72:75]
    ds_read_b128 v[120:123], v9 offset:0
    ds_read_b128 v[124:127], v9 offset:2048
    v_mfma_f32_16x16x32_bf16 v[76:79], v[32:35], v[116:119], v[76:79]
    ds_read_b64_tr_b16 v[52:53], v10 offset:23040
    ds_read_b64_tr_b16 v[54:55], v10 offset:23184
    s_waitcnt lgkmcnt(10)
    v_mfma_f32_16x16x32_bf16 v[80:83], v[36:39], v[112:115], v[80:83]
    ds_read_b64_tr_b16 v[56:57], v10 offset:23072
    ds_read_b64_tr_b16 v[58:59], v10 offset:23216
    v_mfma_f32_16x16x32_bf16 v[84:87], v[36:39], v[116:119], v[84:87]
    ds_read_b64_tr_b16 v[60:61], v10 offset:32256
    s_waitcnt lgkmcnt(11)
    v_mfma_f32_16x16x32_bf16 v[88:91], v[40:43], v[112:115], v[88:91]
    ds_read_b64_tr_b16 v[62:63], v10 offset:32400
    v_mfma_f32_16x16x32_bf16 v[92:95], v[40:43], v[116:119], v[92:95]
    ds_read_b64_tr_b16 v[64:65], v10 offset:32288
    s_waitcnt lgkmcnt(11)
    v_mfma_f32_16x16x32_bf16 v[96:99], v[44:47], v[112:115], v[96:99]
    ds_read_b64_tr_b16 v[66:67], v10 offset:32432
    v_mfma_f32_16x16x32_bf16 v[100:103], v[44:47], v[116:119], v[100:103]
    ds_read_b64_tr_b16 v[68:69], v11 offset:23040
    s_waitcnt lgkmcnt(11)
    v_mfma_f32_16x16x32_bf16 v[104:107], v[48:51], v[112:115], v[104:107]
    ds_read_b64_tr_b16 v[70:71], v11 offset:23184
    v_mfma_f32_16x16x32_bf16 v[108:111], v[48:51], v[116:119], v[108:111]
    s_waitcnt vmcnt(4) lgkmcnt(0)
    s_barrier
    s_add_u32 s64, s89, 0
    s_sub_u32 s15, s64, 3
    s_cmp_ge_u32 s64, 3
    s_cselect_b32 s64, s15, s64
    s_add_u32 s64, s64, 6
    s_mul_i32 s64, s64, 128
    s_add_u32 m0, s69, 0
    s_nop 0
    buffer_load_dwordx4 v3, s[44:47], s64 offen lds
    s_add_u32 m0, s69, 1024
    s_nop 0
    buffer_load_dwordx4 v4, s[44:47], s64 offen lds
    s_add_u32 s65, s64, 18432
    s_add_u32 m0, s69, 2048
    s_nop 0
    buffer_load_dwordx4 v3, s[44:47], s65 offen lds
    s_add_u32 m0, s69, 3072
    s_nop 0
    buffer_load_dwordx4 v4, s[44:47], s65 offen lds
    v_mfma_f32_16x16x32_bf16 v[72:75], v[52:55], v[120:123], v[72:75]
    ds_read_b128 v[112:115], v8 offset:20480
    ds_read_b128 v[116:119], v8 offset:22528
    v_mfma_f32_16x16x32_bf16 v[76:79], v[52:55], v[124:127], v[76:79]
    ds_read_b64_tr_b16 v[32:33], v10 offset:36864
    ds_read_b64_tr_b16 v[34:35], v10 offset:37008
    v_mfma_f32_16x16x32_bf16 v[80:83], v[56:59], v[120:123], v[80:83]
    ds_read_b64_tr_b16 v[36:37], v10 offset:36896
    ds_read_b64_tr_b16 v[38:39], v10 offset:37040
    v_mfma_f32_16x16x32_bf16 v[84:87], v[56:59], v[124:127], v[84:87]
    ds_read_b64_tr_b16 v[40:41], v10 offset:46080
    v_mfma_f32_16x16x32_bf16 v[88:91], v[60:63], v[120:123], v[88:91]
    ds_read_b64_tr_b16 v[42:43], v10 offset:46224
    v_mfma_f32_16x16x32_bf16 v[92:95], v[60:63], v[124:127], v[92:95]
    ds_read_b64_tr_b16 v[44:45], v10 offset:46112
    v_mfma_f32_16x16x32_bf16 v[96:99], v[64:67], v[120:123], v[96:99]
    ds_read_b64_tr_b16 v[46:47], v10 offset:46256
    v_mfma_f32_16x16x32_bf16 v[100:103], v[64:67], v[124:127], v[100:103]
    ds_read_b64_tr_b16 v[48:49], v11 offset:36864
    v_mfma_f32_16x16x32_bf16 v[104:107], v[68:71], v[120:123], v[104:107]
    ds_read_b64_tr_b16 v[50:51], v11 offset:37008
    v_mfma_f32_16x16x32_bf16 v[108:111], v[68:71], v[124:127], v[108:111]
    s_waitcnt lgkmcnt(8)
    v_mfma_f32_16x16x32_bf16 v[72:75], v[32:35], v[112:115], v[72:75]
    ds_read_b128 v[120:123], v9 offset:20480
    ds_read_b128 v[124:127], v9 offset:22528
    v_mfma_f32_16x16x32_bf16 v[76:79], v[32:35], v[116:119], v[76:79]
    ds_read_b64_tr_b16 v[52:53], v10 offset:41472
    ds_read_b64_tr_b16 v[54:55], v10 offset:41616
    s_waitcnt lgkmcnt(10)
    v_mfma_f32_16x16x32_bf16 v[80:83], v[36:39], v[112:115], v[80:83]
    ds_read_b64_tr_b16 v[56:57], v10 offset:41504
    ds_read_b64_tr_b16 v[58:59], v10 offset:41648
    v_mfma_f32_16x16x32_bf16 v[84:87], v[36:39], v[116:119], v[84:87]
    ds_read_b64_tr_b16 v[60:61], v10 offset:50688
    s_waitcnt lgkmcnt(11)
    v_mfma_f32_16x16x32_bf16 v[88:91], v[40:43], v[112:115], v[88:91]
    ds_read_b64_tr_b16 v[62:63], v10 offset:50832
    v_mfma_f32_16x16x32_bf16 v[92:95], v[40:43], v[116:119], v[92:95]
    ds_read_b64_tr_b16 v[64:65], v10 offset:50720
    s_waitcnt lgkmcnt(11)
    v_mfma_f32_16x16x32_bf16 v[96:99], v[44:47], v[112:115], v[96:99]
    ds_read_b64_tr_b16 v[66:67], v10 offset:50864
    v_mfma_f32_16x16x32_bf16 v[100:103], v[44:47], v[116:119], v[100:103]
    ds_read_b64_tr_b16 v[68:69], v11 offset:41472
    s_waitcnt lgkmcnt(11)
    v_mfma_f32_16x16x32_bf16 v[104:107], v[48:51], v[112:115], v[104:107]
    ds_read_b64_tr_b16 v[70:71], v11 offset:41616
    v_mfma_f32_16x16x32_bf16 v[108:111], v[48:51], v[116:119], v[108:111]
    s_waitcnt vmcnt(4) lgkmcnt(0)
    s_barrier
    s_add_u32 s64, s89, 1
    s_sub_u32 s15, s64, 3
    s_cmp_ge_u32 s64, 3
    s_cselect_b32 s64, s15, s64
    s_add_u32 s64, s64, 6
    s_mul_i32 s64, s64, 128
    s_add_u32 m0, s69, 20480
    s_nop 0
    buffer_load_dwordx4 v3, s[44:47], s64 offen lds
    s_add_u32 m0, s69, 21504
    s_nop 0
    buffer_load_dwordx4 v4, s[44:47], s64 offen lds
    s_add_u32 s65, s64, 18432
    s_add_u32 m0, s69, 22528
    s_nop 0
    buffer_load_dwordx4 v3, s[44:47], s65 offen lds
    s_add_u32 m0, s69, 23552
    s_nop 0
    buffer_load_dwordx4 v4, s[44:47], s65 offen lds
    v_mfma_f32_16x16x32_bf16 v[72:75], v[52:55], v[120:123], v[72:75]
    ds_read_b128 v[112:115], v8 offset:40960
    ds_read_b128 v[116:119], v8 offset:43008
    v_mfma_f32_16x16x32_bf16 v[76:79], v[52:55], v[124:127], v[76:79]
    ds_read_b64_tr_b16 v[32:33], v10 offset:0
    ds_read_b64_tr_b16 v[34:35], v10 offset:144
    v_mfma_f32_16x16x32_bf16 v[80:83], v[56:59], v[120:123], v[80:83]
    ds_read_b64_tr_b16 v[36:37], v10 offset:32
    ds_read_b64_tr_b16 v[38:39], v10 offset:176
    v_mfma_f32_16x16x32_bf16 v[84:87], v[56:59], v[124:127], v[84:87]
    ds_read_b64_tr_b16 v[40:41], v10 offset:9216
    v_mfma_f32_16x16x32_bf16 v[88:91], v[60:63], v[120:123], v[88:91]
    ds_read_b64_tr_b16 v[42:43], v10 offset:9360
    v_mfma_f32_16x16x32_bf16 v[92:95], v[60:63], v[124:127], v[92:95]
    ds_read_b64_tr_b16 v[44:45], v10 offset:9248
    v_mfma_f32_16x16x32_bf16 v[96:99], v[64:67], v[120:123], v[96:99]
    ds_read_b64_tr_b16 v[46:47], v10 offset:9392
    v_mfma_f32_16x16x32_bf16 v[100:103], v[64:67], v[124:127], v[100:103]
    ds_read_b64_tr_b16 v[48:49], v11 offset:0
    v_mfma_f32_16x16x32_bf16 v[104:107], v[68:71], v[120:123], v[104:107]
    ds_read_b64_tr_b16 v[50:51], v11 offset:144
    v_mfma_f32_16x16x32_bf16 v[108:111], v[68:71], v[124:127], v[108:111]
    s_waitcnt lgkmcnt(8)
    v_mfma_f32_16x16x32_bf16 v[72:75], v[32:35], v[112:115], v[72:75]
    ds_read_b128 v[120:123], v9 offset:40960
    ds_read_b128 v[124:127], v9 offset:43008
    v_mfma_f32_16x16x32_bf16 v[76:79], v[32:35], v[116:119], v[76:79]
    ds_read_b64_tr_b16 v[52:53], v10 offset:4608
    ds_read_b64_tr_b16 v[54:55], v10 offset:4752
    s_waitcnt lgkmcnt(10)
    v_mfma_f32_16x16x32_bf16 v[80:83], v[36:39], v[112:115], v[80:83]
    ds_read_b64_tr_b16 v[56:57], v10 offset:4640
    ds_read_b64_tr_b16 v[58:59], v10 offset:4784
    v_mfma_f32_16x16x32_bf16 v[84:87], v[36:39], v[116:119], v[84:87]
    ds_read_b64_tr_b16 v[60:61], v10 offset:13824
    s_waitcnt lgkmcnt(11)
    v_mfma_f32_16x16x32_bf16 v[88:91], v[40:43], v[112:115], v[88:91]
    ds_read_b64_tr_b16 v[62:63], v10 offset:13968
    v_mfma_f32_16x16x32_bf16 v[92:95], v[40:43], v[116:119], v[92:95]
    ds_read_b64_tr_b16 v[64:65], v10 offset:13856
    s_waitcnt lgkmcnt(11)
    v_mfma_f32_16x16x32_bf16 v[96:99], v[44:47], v[112:115], v[96:99]
    ds_read_b64_tr_b16 v[66:67], v10 offset:14000
    v_mfma_f32_16x16x32_bf16 v[100:103], v[44:47], v[116:119], v[100:103]
    ds_read_b64_tr_b16 v[68:69], v11 offset:4608
    s_waitcnt lgkmcnt(11)
    v_mfma_f32_16x16x32_bf16 v[104:107], v[48:51], v[112:115], v[104:107]
    ds_read_b64_tr_b16 v[70:71], v11 offset:4752
    v_mfma_f32_16x16x32_bf16 v[108:111], v[48:51], v[116:119], v[108:111]
    s_waitcnt vmcnt(4) lgkmcnt(0)
    s_barrier
    s_add_u32 s64, s89, 2
    s_sub_u32 s15, s64, 3
    s_cmp_ge_u32 s64, 3
    s_cselect_b32 s64, s15, s64
    s_add_u32 s64, s64, 6
    s_mul_i32 s64, s64, 128
    s_add_u32 m0, s69, 40960
    s_nop 0
    buffer_load_dwordx4 v3, s[44:47], s64 offen lds
    s_add_u32 m0, s69, 41984
    s_nop 0
    buffer_load_dwordx4 v4, s[44:47], s64 offen lds
    s_add_u32 s65, s64, 18432
    s_add_u32 m0, s69, 43008
    s_nop 0
    buffer_load_dwordx4 v3, s[44:47], s65 offen lds
    s_add_u32 m0, s69, 44032
    s_nop 0
    buffer_load_dwordx4 v4, s[44:47], s65 offen lds
    global_load_dword v18, v30, s[40:41] sc1
    v_mfma_f32_16x16x32_bf16 v[72:75], v[52:55], v[120:123], v[72:75]
    ds_read_b128 v[112:115], v8 offset:0
    ds_read_b128 v[116:119], v8 offset:2048
    v_mfma_f32_16x16x32_bf16 v[76:79], v[52:55], v[124:127], v[76:79]
    ds_read_b64_tr_b16 v[32:33], v10 offset:18432
    ds_read_b64_tr_b16 v[34:35], v10 offset:18576
    v_mfma_f32_16x16x32_bf16 v[80:83], v[56:59], v[120:123], v[80:83]
    ds_read_b64_tr_b16 v[36:37], v10 offset:18464
    ds_read_b64_tr_b16 v[38:39], v10 offset:18608
    v_mfma_f32_16x16x32_bf16 v[84:87], v[56:59], v[124:127], v[84:87]
    ds_read_b64_tr_b16 v[40:41], v10 offset:27648
    v_mfma_f32_16x16x32_bf16 v[88:91], v[60:63], v[120:123], v[88:91]
    ds_read_b64_tr_b16 v[42:43], v10 offset:27792
    v_mfma_f32_16x16x32_bf16 v[92:95], v[60:63], v[124:127], v[92:95]
    ds_read_b64_tr_b16 v[44:45], v10 offset:27680
    v_mfma_f32_16x16x32_bf16 v[96:99], v[64:67], v[120:123], v[96:99]
    ds_read_b64_tr_b16 v[46:47], v10 offset:27824
    v_mfma_f32_16x16x32_bf16 v[100:103], v[64:67], v[124:127], v[100:103]
    ds_read_b64_tr_b16 v[48:49], v11 offset:18432
    v_mfma_f32_16x16x32_bf16 v[104:107], v[68:71], v[120:123], v[104:107]
    ds_read_b64_tr_b16 v[50:51], v11 offset:18576
    v_mfma_f32_16x16x32_bf16 v[108:111], v[68:71], v[124:127], v[108:111]
    s_waitcnt lgkmcnt(8)
    v_mfma_f32_16x16x32_bf16 v[72:75], v[32:35], v[112:115], v[72:75]
    ds_read_b128 v[120:123], v9 offset:0
    ds_read_b128 v[124:127], v9 offset:2048
    v_mfma_f32_16x16x32_bf16 v[76:79], v[32:35], v[116:119], v[76:79]
    ds_read_b64_tr_b16 v[52:53], v10 offset:23040
    ds_read_b64_tr_b16 v[54:55], v10 offset:23184
    s_waitcnt lgkmcnt(10)
    v_mfma_f32_16x16x32_bf16 v[80:83], v[36:39], v[112:115], v[80:83]
    ds_read_b64_tr_b16 v[56:57], v10 offset:23072
    ds_read_b64_tr_b16 v[58:59], v10 offset:23216
    v_mfma_f32_16x16x32_bf16 v[84:87], v[36:39], v[116:119], v[84:87]
    ds_read_b64_tr_b16 v[60:61], v10 offset:32256
    s_waitcnt lgkmcnt(11)
    v_mfma_f32_16x16x32_bf16 v[88:91], v[40:43], v[112:115], v[88:91]
    ds_read_b64_tr_b16 v[62:63], v10 offset:32400
    v_mfma_f32_16x16x32_bf16 v[92:95], v[40:43], v[116:119], v[92:95]
    ds_read_b64_tr_b16 v[64:65], v10 offset:32288
    s_waitcnt lgkmcnt(11)
    v_mfma_f32_16x16x32_bf16 v[96:99], v[44:47], v[112:115], v[96:99]
    ds_read_b64_tr_b16 v[66:67], v10 offset:32432
    v_mfma_f32_16x16x32_bf16 v[100:103], v[44:47], v[116:119], v[100:103]
    ds_read_b64_tr_b16 v[68:69], v11 offset:23040
    s_waitcnt lgkmcnt(11)
    v_mfma_f32_16x16x32_bf16 v[104:107], v[48:51], v[112:115], v[104:107]
    ds_read_b64_tr_b16 v[70:71], v11 offset:23184
    v_mfma_f32_16x16x32_bf16 v[108:111], v[48:51], v[116:119], v[108:111]
    s_waitcnt vmcnt(5) lgkmcnt(0)
    s_barrier
    v_mfma_f32_16x16x32_bf16 v[72:75], v[52:55], v[120:123], v[72:75]
    ds_read_b128 v[112:115], v8 offset:20480
    ds_read_b128 v[116:119], v8 offset:22528
    v_mfma_f32_16x16x32_bf16 v[76:79], v[52:55], v[124:127], v[76:79]
    ds_read_b64_tr_b16 v[32:33], v10 offset:36864
    ds_read_b64_tr_b16 v[34:35], v10 offset:37008
    v_mfma_f32_16x16x32_bf16 v[80:83], v[56:59], v[120:123], v[80:83]
    ds_read_b64_tr_b16 v[36:37], v10 offset:36896
    ds_read_b64_tr_b16 v[38:39], v10 offset:37040
    v_mfma_f32_16x16x32_bf16 v[84:87], v[56:59], v[124:127], v[84:87]
    ds_read_b64_tr_b16 v[40:41], v10 offset:46080
    v_mfma_f32_16x16x32_bf16 v[88:91], v[60:63], v[120:123], v[88:91]
    ds_read_b64_tr_b16 v[42:43], v10 offset:46224
    v_mfma_f32_16x16x32_bf16 v[92:95], v[60:63], v[124:127], v[92:95]
    ds_read_b64_tr_b16 v[44:45], v10 offset:46112
    v_mfma_f32_16x16x32_bf16 v[96:99], v[64:67], v[120:123], v[96:99]
    ds_read_b64_tr_b16 v[46:47], v10 offset:46256
    v_mfma_f32_16x16x32_bf16 v[100:103], v[64:67], v[124:127], v[100:103]
    ds_read_b64_tr_b16 v[48:49], v11 offset:36864
    v_mfma_f32_16x16x32_bf16 v[104:107], v[68:71], v[120:123], v[104:107]
    ds_read_b64_tr_b16 v[50:51], v11 offset:37008
    v_mfma_f32_16x16x32_bf16 v[108:111], v[68:71], v[124:127], v[108:111]
    s_waitcnt lgkmcnt(8)
    v_mfma_f32_16x16x32_bf16 v[72:75], v[32:35], v[112:115], v[72:75]
    ds_read_b128 v[120:123], v9 offset:20480
    ds_read_b128 v[124:127], v9 offset:22528
    v_mfma_f32_16x16x32_bf16 v[76:79], v[32:35], v[116:119], v[76:79]
    ds_read_b64_tr_b16 v[52:53], v10 offset:41472
    ds_read_b64_tr_b16 v[54:55], v10 offset:41616
    s_waitcnt lgkmcnt(10)
    v_mfma_f32_16x16x32_bf16 v[80:83], v[36:39], v[112:115], v[80:83]
    ds_read_b64_tr_b16 v[56:57], v10 offset:41504
    ds_read_b64_tr_b16 v[58:59], v10 offset:41648
    v_mfma_f32_16x16x32_bf16 v[84:87], v[36:39], v[116:119], v[84:87]
    ds_read_b64_tr_b16 v[60:61], v10 offset:50688
    s_waitcnt lgkmcnt(11)
    v_mfma_f32_16x16x32_bf16 v[88:91], v[40:43], v[112:115], v[88:91]
    ds_read_b64_tr_b16 v[62:63], v10 offset:50832
    v_mfma_f32_16x16x32_bf16 v[92:95], v[40:43], v[116:119], v[92:95]
    ds_read_b64_tr_b16 v[64:65], v10 offset:50720
    s_waitcnt lgkmcnt(11)
    v_mfma_f32_16x16x32_bf16 v[96:99], v[44:47], v[112:115], v[96:99]
    ds_read_b64_tr_b16 v[66:67], v10 offset:50864
    v_mfma_f32_16x16x32_bf16 v[100:103], v[44:47], v[116:119], v[100:103]
    ds_read_b64_tr_b16 v[68:69], v11 offset:41472
    s_waitcnt lgkmcnt(11)
    v_mfma_f32_16x16x32_bf16 v[104:107], v[48:51], v[112:115], v[104:107]
    ds_read_b64_tr_b16 v[70:71], v11 offset:41616
    v_mfma_f32_16x16x32_bf16 v[108:111], v[48:51], v[116:119], v[108:111]
    s_waitcnt vmcnt(1) lgkmcnt(0)
    s_barrier
    v_mfma_f32_16x16x32_bf16 v[72:75], v[52:55], v[120:123], v[72:75]
    ds_read_b128 v[112:115], v8 offset:40960
    ds_read_b128 v[116:119], v8 offset:43008
    v_mfma_f32_16x16x32_bf16 v[76:79], v[52:55], v[124:127], v[76:79]
    ds_read_b64_tr_b16 v[32:33], v10 offset:0
    ds_read_b64_tr_b16 v[34:35], v10 offset:144
    v_mfma_f32_16x16x32_bf16 v[80:83], v[56:59], v[120:123], v[80:83]
    ds_read_b64_tr_b16 v[36:37], v10 offset:32
    ds_read_b64_tr_b16 v[38:39], v10 offset:176
    v_mfma_f32_16x16x32_bf16 v[84:87], v[56:59], v[124:127], v[84:87]
    ds_read_b64_tr_b16 v[40:41], v10 offset:9216
    v_mfma_f32_16x16x32_bf16 v[88:91], v[60:63], v[120:123], v[88:91]
    ds_read_b64_tr_b16 v[42:43], v10 offset:9360
    v_mfma_f32_16x16x32_bf16 v[92:95], v[60:63], v[124:127], v[92:95]
    ds_read_b64_tr_b16 v[44:45], v10 offset:9248
    v_mfma_f32_16x16x32_bf16 v[96:99], v[64:67], v[120:123], v[96:99]
    ds_read_b64_tr_b16 v[46:47], v10 offset:9392
    v_mfma_f32_16x16x32_bf16 v[100:103], v[64:67], v[124:127], v[100:103]
    ds_read_b64_tr_b16 v[48:49], v11 offset:0
    v_mfma_f32_16x16x32_bf16 v[104:107], v[68:71], v[120:123], v[104:107]
    ds_read_b64_tr_b16 v[50:51], v11 offset:144
    v_mfma_f32_16x16x32_bf16 v[108:111], v[68:71], v[124:127], v[108:111]
    s_waitcnt lgkmcnt(8)
    v_mfma_f32_16x16x32_bf16 v[72:75], v[32:35], v[112:115], v[72:75]
    ds_read_b128 v[120:123], v9 offset:40960
    ds_read_b128 v[124:127], v9 offset:43008
    v_mfma_f32_16x16x32_bf16 v[76:79], v[32:35], v[116:119], v[76:79]
    ds_read_b64_tr_b16 v[52:53], v10 offset:4608
    ds_read_b64_tr_b16 v[54:55], v10 offset:4752
    s_waitcnt lgkmcnt(10)
    v_mfma_f32_16x16x32_bf16 v[80:83], v[36:39], v[112:115], v[80:83]
    ds_read_b64_tr_b16 v[56:57], v10 offset:4640
    ds_read_b64_tr_b16 v[58:59], v10 offset:4784
    v_mfma_f32_16x16x32_bf16 v[84:87], v[36:39], v[116:119], v[84:87]
    ds_read_b64_tr_b16 v[60:61], v10 offset:13824
    s_waitcnt lgkmcnt(11)
    v_mfma_f32_16x16x32_bf16 v[88:91], v[40:43], v[112:115], v[88:91]
    ds_read_b64_tr_b16 v[62:63], v10 offset:13968
    v_mfma_f32_16x16x32_bf16 v[92:95], v[40:43], v[116:119], v[92:95]
    ds_read_b64_tr_b16 v[64:65], v10 offset:13856
    s_waitcnt lgkmcnt(11)
    v_mfma_f32_16x16x32_bf16 v[96:99], v[44:47], v[112:115], v[96:99]
    ds_read_b64_tr_b16 v[66:67], v10 offset:14000
    v_mfma_f32_16x16x32_bf16 v[100:103], v[44:47], v[116:119], v[100:103]
    ds_read_b64_tr_b16 v[68:69], v11 offset:4608
    s_waitcnt lgkmcnt(11)
    v_mfma_f32_16x16x32_bf16 v[104:107], v[48:51], v[112:115], v[104:107]
    ds_read_b64_tr_b16 v[70:71], v11 offset:4752
    v_mfma_f32_16x16x32_bf16 v[108:111], v[48:51], v[116:119], v[108:111]
    s_waitcnt lgkmcnt(8)
    v_mfma_f32_16x16x32_bf16 v[72:75], v[52:55], v[120:123], v[72:75]
    v_mfma_f32_16x16x32_bf16 v[76:79], v[52:55], v[124:127], v[76:79]
    s_waitcnt lgkmcnt(6)
    v_mfma_f32_16x16x32_bf16 v[80:83], v[56:59], v[120:123], v[80:83]
    v_mfma_f32_16x16x32_bf16 v[84:87], v[56:59], v[124:127], v[84:87]
    s_waitcnt lgkmcnt(4)
    v_mfma_f32_16x16x32_bf16 v[88:91], v[60:63], v[120:123], v[88:91]
    v_mfma_f32_16x16x32_bf16 v[92:95], v[60:63], v[124:127], v[92:95]
    s_waitcnt lgkmcnt(2)
    v_mfma_f32_16x16x32_bf16 v[96:99], v[64:67], v[120:123], v[96:99]
    v_mfma_f32_16x16x32_bf16 v[100:103], v[64:67], v[124:127], v[100:103]
    s_waitcnt lgkmcnt(0)
    v_mfma_f32_16x16x32_bf16 v[104:107], v[68:71], v[120:123], v[104:107]
    v_mfma_f32_16x16x32_bf16 v[108:111], v[68:71], v[124:127], v[108:111]
    s_mov_b32 s74, 0
    v_cvt_pk_bf16_f32 v72, v72, v73
    v_cvt_pk_bf16_f32 v73, v74, v75
    v_cvt_pk_bf16_f32 v74, v80, v81
    v_cvt_pk_bf16_f32 v75, v82, v83
    v_cvt_pk_bf16_f32 v88, v88, v89
    v_cvt_pk_bf16_f32 v89, v90, v91
    v_cvt_pk_bf16_f32 v90, v96, v97
    v_cvt_pk_bf16_f32 v91, v98, v99
    v_cvt_pk_bf16_f32 v104, v104, v105
    v_cvt_pk_bf16_f32 v105, v106, v107
    buffer_store_dwordx4 v[72:75], v200, s[52:55], s74 offen sc1
    buffer_store_dwordx4 v[88:91], v200, s[52:55], s74 offen offset:2048 sc1
    buffer_store_dwordx2 v[104:105], v201, s[52:55], s74 offen sc1
    s_add_u32 s74, s74, 18432
    v_cvt_pk_bf16_f32 v76, v76, v77
    v_cvt_pk_bf16_f32 v77, v78, v79
    v_cvt_pk_bf16_f32 v78, v84, v85
    v_cvt_pk_bf16_f32 v79, v86, v87
    v_cvt_pk_bf16_f32 v92, v92, v93
    v_cvt_pk_bf16_f32 v93, v94, v95
    v_cvt_pk_bf16_f32 v94, v100, v101
    v_cvt_pk_bf16_f32 v95, v102, v103
    v_cvt_pk_bf16_f32 v108, v108, v109
    v_cvt_pk_bf16_f32 v109, v110, v111
    buffer_store_dwordx4 v[76:79], v200, s[52:55], s74 offen sc1
    buffer_store_dwordx4 v[92:95], v200, s[52:55], s74 offen offset:2048 sc1
    buffer_store_dwordx2 v[108:109], v201, s[52:55], s74 offen sc1
    s_add_u32 s74, s74, 18432
    s_branch Q_join
Q_v3:
    v_mov_b32 v30, 0
    v_lshrrev_b32 v21, 1, v22
    v_xor_b32 v21, v21, v19
    v_lshlrev_b32 v21, 4, v21
    v_lshl_add_u32 v8, v22, 7, v21
    s_lshl_b32 s14, s68, 11
    v_add_u32 v8, s14, v8
    v_xor_b32 v9, 64, v8
    v_lshlrev_b32 v21, 1, v23
    v_lshl_add_u32 v21, v19, 3, v21
    v_mul_u32_u24 v21, 144, v21
    v_add_u32 v21, 61512, v21
    v_lshl_add_u32 v10, v24, 3, v21
    v_and_b32 v20, 1, v24
    v_mul_u32_u24 v20, 9216, v20
    v_add3_u32 v11, v21, v20, 64

    v_lshrrev_b32 v20, 1, v24
    v_mul_u32_u24 v20, 72, v20
    v_add_u32 v11, v11, v20
    v_subrev_u32 v11, 72, v11
    s_mul_i32 s14, s4, 10
    s_add_u32 s14, s14, s68
    s_mul_i32 s74, s14, 18432
    s_add_u32 s74, s74, 0x401000
    s_lshl_b32 s75, s5, 2
    s_add_u32 s75, s75, s13
    s_lshl_b32 s75, s75, 10
    s_add_u32 s75, s75, s74
    v_lshl_add_u32 v200, v2, 4, s75
    s_lshl_b32 s75, s5, 9
    s_add_u32 s75, s75, s74
    s_add_u32 s75, s75, 16384
    v_lshl_add_u32 v201, v2, 3, s75
    s_lshl_b32 s74, s3, 7
    s_add_u32 s74, s74, 0xdc000
    v_mov_b32 v202, s74

    s_add_u32 s64, s89, 1
    s_sub_u32 s15, s64, 3
    s_cmp_ge_u32 s64, 3
    s_cselect_b32 s64, s15, s64
    s_add_u32 s64, s64, 0
    s_mul_i32 s64, s64, 128
    s_add_u32 m0, s69, 20480
    s_nop 0
    buffer_load_dwordx4 v3, s[44:47], s64 offen lds
    s_add_u32 m0, s69, 21504
    s_nop 0
    buffer_load_dwordx4 v4, s[44:47], s64 offen lds
    s_add_u32 s65, s64, 18432
    s_add_u32 m0, s69, 22528
    s_nop 0
    buffer_load_dwordx4 v3, s[44:47], s65 offen lds
    s_add_u32 m0, s69, 23552
    s_nop 0
    buffer_load_dwordx4 v4, s[44:47], s65 offen lds
    s_add_u32 s65, s64, 36864
    s_add_u32 m0, s69, 24576
    s_nop 0
    buffer_load_dwordx4 v3, s[44:47], s65 offen lds
    s_add_u32 m0, s69, 25600
    s_nop 0
    buffer_load_dwordx4 v4, s[44:47], s65 offen lds
    v_lshlrev_b32 v250, 21, v24
    v_add_u32 v251, 0x1f0000, v250
    v_cmp_eq_u32 vcc, 0, v24
    v_mov_b32 v252, 0xf0000
    s_nop 0
    v_cndmask_b32 v251, v251, v252, vcc
    v_cmp_eq_u32 vcc, 2, v24
    v_mov_b32 v252, 0x400000
    s_nop 0
    v_cndmask_b32 v251, v251, v252, vcc
    s_mov_b64 exec, 15
    buffer_load_dword v253, v251, s[52:55], 0 offen
    buffer_load_dword v254, v250, s[56:59], 0 offen
    s_mov_b64 exec, -1

    s_waitcnt vmcnt(8) lgkmcnt(0)
    s_barrier
    s_add_u32 s64, s89, 2
    s_sub_u32 s15, s64, 3
    s_cmp_ge_u32 s64, 3
    s_cselect_b32 s64, s15, s64
    s_add_u32 s64, s64, 0
    s_mul_i32 s64, s64, 128
    s_add_u32 m0, s69, 40960
    s_nop 0
    buffer_load_dwordx4 v3, s[44:47], s64 offen lds
    s_add_u32 m0, s69, 41984
    s_nop 0
    buffer_load_dwordx4 v4, s[44:47], s64 offen lds
    s_add_u32 s65, s64, 18432
    s_add_u32 m0, s69, 43008
    s_nop 0
    buffer_load_dwordx4 v3, s[44:47], s65 offen lds
    s_add_u32 m0, s69, 44032
    s_nop 0
    buffer_load_dwordx4 v4, s[44:47], s65 offen lds
    s_add_u32 s65, s64, 36864
    s_add_u32 m0, s69, 45056
    s_nop 0
    buffer_load_dwordx4 v3, s[44:47], s65 offen lds
    s_add_u32 m0, s69, 46080
    s_nop 0
    buffer_load_dwordx4 v4, s[44:47], s65 offen lds
    ds_read_b128 v[132:135], v8 offset:0
    ds_read_b128 v[136:139], v8 offset:2048
    ds_read_b128 v[140:143], v8 offset:4096
    ds_read_b64_tr_b16 v[32:33], v10 offset:18432
    ds_read_b64_tr_b16 v[34:35], v10 offset:18576
    ds_read_b64_tr_b16 v[36:37], v10 offset:18464
    ds_read_b64_tr_b16 v[38:39], v10 offset:18608
    ds_read_b64_tr_b16 v[40:41], v10 offset:27648
    ds_read_b64_tr_b16 v[42:43], v10 offset:27792
    ds_read_b64_tr_b16 v[44:45], v10 offset:27680
    ds_read_b64_tr_b16 v[46:47], v10 offset:27824
    ds_read_b64_tr_b16 v[48:49], v11 offset:18432
    ds_read_b64_tr_b16 v[50:51], v11 offset:18576
    s_waitcnt lgkmcnt(8)
    v_mfma_f32_16x16x32_bf16 v[72:75], v[32:35], v[132:135], 0
    ds_read_b128 v[144:147], v9 offset:0
    ds_read_b128 v[148:151], v9 offset:2048
    v_mfma_f32_16x16x32_bf16 v[76:79], v[32:35], v[136:139], 0
    ds_read_b128 v[152:155], v9 offset:4096
    v_mfma_f32_16x16x32_bf16 v[80:83], v[32:35], v[140:143], 0
    ds_read_b64_tr_b16 v[52:53], v10 offset:23040
    s_waitcnt lgkmcnt(10)
    v_mfma_f32_16x16x32_bf16 v[84:87], v[36:39], v[132:135], 0
    ds_read_b64_tr_b16 v[54:55], v10 offset:23184
    v_mfma_f32_16x16x32_bf16 v[88:91], v[36:39], v[136:139], 0
    ds_read_b64_tr_b16 v[56:57], v10 offset:23072
    v_mfma_f32_16x16x32_bf16 v[92:95], v[36:39], v[140:143], 0
    ds_read_b64_tr_b16 v[58:59], v10 offset:23216
    s_waitcnt lgkmcnt(11)
    v_mfma_f32_16x16x32_bf16 v[96:99], v[40:43], v[132:135], 0
    ds_read_b64_tr_b16 v[60:61], v10 offset:32256
    v_mfma_f32_16x16x32_bf16 v[100:103], v[40:43], v[136:139], 0
    ds_read_b64_tr_b16 v[62:63], v10 offset:32400
    v_mfma_f32_16x16x32_bf16 v[104:107], v[40:43], v[140:143], 0
    ds_read_b64_tr_b16 v[64:65], v10 offset:32288
    s_waitcnt lgkmcnt(12)
    v_mfma_f32_16x16x32_bf16 v[108:111], v[44:47], v[132:135], 0
    ds_read_b64_tr_b16 v[66:67], v10 offset:32432
    v_mfma_f32_16x16x32_bf16 v[112:115], v[44:47], v[136:139], 0
    ds_read_b64_tr_b16 v[68:69], v11 offset:23040
    v_mfma_f32_16x16x32_bf16 v[116:119], v[44:47], v[140:143], 0
    ds_read_b64_tr_b16 v[70:71], v11 offset:23184
    s_waitcnt lgkmcnt(13)
    v_mfma_f32_16x16x32_bf16 v[120:123], v[48:51], v[132:135], 0
    s_waitcnt vmcnt(8) lgkmcnt(0)
    s_barrier
    s_add_u32 s64, s89, 0
    s_sub_u32 s15, s64, 3
    s_cmp_ge_u32 s64, 3
    s_cselect_b32 s64, s15, s64
    s_add_u32 s64, s64, 3
    s_mul_i32 s64, s64, 128
    s_add_u32 m0, s69, 0
    s_nop 0
    buffer_load_dwordx4 v3, s[44:47], s64 offen lds
    s_add_u32 m0, s69, 1024
    s_nop 0
    buffer_load_dwordx4 v4, s[44:47], s64 offen lds
    s_add_u32 s65, s64, 18432
    s_add_u32 m0, s69, 2048
    s_nop 0
    buffer_load_dwordx4 v3, s[44:47], s65 offen lds
    s_add_u32 m0, s69, 3072
    s_nop 0
    buffer_load_dwordx4 v4, s[44:47], s65 offen lds
    s_add_u32 s65, s64, 36864
    s_add_u32 m0, s69, 4096
    s_nop 0
    buffer_load_dwordx4 v3, s[44:47], s65 offen lds
    s_add_u32 m0, s69, 5120
    s_nop 0
    buffer_load_dwordx4 v4, s[44:47], s65 offen lds
    v_mfma_f32_16x16x32_bf16 v[72:75], v[52:55], v[144:147], v[72:75]
    ds_read_b128 v[132:135], v8 offset:20480
    ds_read_b128 v[136:139], v8 offset:22528
    v_mfma_f32_16x16x32_bf16 v[76:79], v[52:55], v[148:151], v[76:79]
    ds_read_b128 v[140:143], v8 offset:24576
    v_mfma_f32_16x16x32_bf16 v[80:83], v[52:55], v[152:155], v[80:83]
    ds_read_b64_tr_b16 v[32:33], v10 offset:36864
    v_mfma_f32_16x16x32_bf16 v[84:87], v[56:59], v[144:147], v[84:87]
    ds_read_b64_tr_b16 v[34:35], v10 offset:37008
    v_mfma_f32_16x16x32_bf16 v[88:91], v[56:59], v[148:151], v[88:91]
    ds_read_b64_tr_b16 v[36:37], v10 offset:36896
    v_mfma_f32_16x16x32_bf16 v[92:95], v[56:59], v[152:155], v[92:95]
    ds_read_b64_tr_b16 v[38:39], v10 offset:37040
    v_mfma_f32_16x16x32_bf16 v[96:99], v[60:63], v[144:147], v[96:99]
    ds_read_b64_tr_b16 v[40:41], v10 offset:46080
    v_mfma_f32_16x16x32_bf16 v[100:103], v[60:63], v[148:151], v[100:103]
    ds_read_b64_tr_b16 v[42:43], v10 offset:46224
    v_mfma_f32_16x16x32_bf16 v[104:107], v[60:63], v[152:155], v[104:107]
    ds_read_b64_tr_b16 v[44:45], v10 offset:46112
    v_mfma_f32_16x16x32_bf16 v[108:111], v[64:67], v[144:147], v[108:111]
    ds_read_b64_tr_b16 v[46:47], v10 offset:46256
    v_mfma_f32_16x16x32_bf16 v[112:115], v[64:67], v[148:151], v[112:115]
    ds_read_b64_tr_b16 v[48:49], v11 offset:36864
    v_mfma_f32_16x16x32_bf16 v[116:119], v[64:67], v[152:155], v[116:119]
    ds_read_b64_tr_b16 v[50:51], v11 offset:37008
    v_mfma_f32_16x16x32_bf16 v[120:123], v[68:71], v[144:147], v[120:123]
    s_waitcnt lgkmcnt(8)
    v_mfma_f32_16x16x32_bf16 v[72:75], v[32:35], v[132:135], v[72:75]
    ds_read_b128 v[144:147], v9 offset:20480
    ds_read_b128 v[148:151], v9 offset:22528
    v_mfma_f32_16x16x32_bf16 v[76:79], v[32:35], v[136:139], v[76:79]
    ds_read_b128 v[152:155], v9 offset:24576
    v_mfma_f32_16x16x32_bf16 v[80:83], v[32:35], v[140:143], v[80:83]
    ds_read_b64_tr_b16 v[52:53], v10 offset:41472
    s_waitcnt lgkmcnt(10)
    v_mfma_f32_16x16x32_bf16 v[84:87], v[36:39], v[132:135], v[84:87]
    ds_read_b64_tr_b16 v[54:55], v10 offset:41616
    v_mfma_f32_16x16x32_bf16 v[88:91], v[36:39], v[136:139], v[88:91]
    ds_read_b64_tr_b16 v[56:57], v10 offset:41504
    v_mfma_f32_16x16x32_bf16 v[92:95], v[36:39], v[140:143], v[92:95]
    ds_read_b64_tr_b16 v[58:59], v10 offset:41648
    s_waitcnt lgkmcnt(11)
    v_mfma_f32_16x16x32_bf16 v[96:99], v[40:43], v[132:135], v[96:99]
    ds_read_b64_tr_b16 v[60:61], v10 offset:50688
    v_mfma_f32_16x16x32_bf16 v[100:103], v[40:43], v[136:139], v[100:103]
    ds_read_b64_tr_b16 v[62:63], v10 offset:50832
    v_mfma_f32_16x16x32_bf16 v[104:107], v[40:43], v[140:143], v[104:107]
    ds_read_b64_tr_b16 v[64:65], v10 offset:50720
    s_waitcnt lgkmcnt(12)
    v_mfma_f32_16x16x32_bf16 v[108:111], v[44:47], v[132:135], v[108:111]
    ds_read_b64_tr_b16 v[66:67], v10 offset:50864
    v_mfma_f32_16x16x32_bf16 v[112:115], v[44:47], v[136:139], v[112:115]
    ds_read_b64_tr_b16 v[68:69], v11 offset:41472
    v_mfma_f32_16x16x32_bf16 v[116:119], v[44:47], v[140:143], v[116:119]
    ds_read_b64_tr_b16 v[70:71], v11 offset:41616
    s_waitcnt lgkmcnt(13)
    v_mfma_f32_16x16x32_bf16 v[120:123], v[48:51], v[132:135], v[120:123]
    s_waitcnt vmcnt(6) lgkmcnt(0)
    s_barrier
    s_add_u32 s64, s89, 1
    s_sub_u32 s15, s64, 3
    s_cmp_ge_u32 s64, 3
    s_cselect_b32 s64, s15, s64
    s_add_u32 s64, s64, 3
    s_mul_i32 s64, s64, 128
    s_add_u32 m0, s69, 20480
    s_nop 0
    buffer_load_dwordx4 v3, s[44:47], s64 offen lds
    s_add_u32 m0, s69, 21504
    s_nop 0
    buffer_load_dwordx4 v4, s[44:47], s64 offen lds
    s_add_u32 s65, s64, 18432
    s_add_u32 m0, s69, 22528
    s_nop 0
    buffer_load_dwordx4 v3, s[44:47], s65 offen lds
    s_add_u32 m0, s69, 23552
    s_nop 0
    buffer_load_dwordx4 v4, s[44:47], s65 offen lds
    s_add_u32 s65, s64, 36864
    s_add_u32 m0, s69, 24576
    s_nop 0
    buffer_load_dwordx4 v3, s[44:47], s65 offen lds
    s_add_u32 m0, s69, 25600
    s_nop 0
    buffer_load_dwordx4 v4, s[44:47], s65 offen lds
    v_mfma_f32_16x16x32_bf16 v[72:75], v[52:55], v[144:147], v[72:75]
    ds_read_b128 v[132:135], v8 offset:40960
    ds_read_b128 v[136:139], v8 offset:43008
    v_mfma_f32_16x16x32_bf16 v[76:79], v[52:55], v[148:151], v[76:79]
    ds_read_b128 v[140:143], v8 offset:45056
    v_mfma_f32_16x16x32_bf16 v[80:83], v[52:55], v[152:155], v[80:83]
    ds_read_b64_tr_b16 v[32:33], v10 offset:0
    v_mfma_f32_16x16x32_bf16 v[84:87], v[56:59], v[144:147], v[84:87]
    ds_read_b64_tr_b16 v[34:35], v10 offset:144
    v_mfma_f32_16x16x32_bf16 v[88:91], v[56:59], v[148:151], v[88:91]
    ds_read_b64_tr_b16 v[36:37], v10 offset:32
    v_mfma_f32_16x16x32_bf16 v[92:95], v[56:59], v[152:155], v[92:95]
    ds_read_b64_tr_b16 v[38:39], v10 offset:176
    v_mfma_f32_16x16x32_bf16 v[96:99], v[60:63], v[144:147], v[96:99]
    ds_read_b64_tr_b16 v[40:41], v10 offset:9216
    v_mfma_f32_16x16x32_bf16 v[100:103], v[60:63], v[148:151], v[100:103]
    ds_read_b64_tr_b16 v[42:43], v10 offset:9360
    v_mfma_f32_16x16x32_bf16 v[104:107], v[60:63], v[152:155], v[104:107]
    ds_read_b64_tr_b16 v[44:45], v10 offset:9248
    v_mfma_f32_16x16x32_bf16 v[108:111], v[64:67], v[144:147], v[108:111]
    ds_read_b64_tr_b16 v[46:47], v10 offset:9392
    v_mfma_f32_16x16x32_bf16 v[112:115], v[64:67], v[148:151], v[112:115]
    ds_read_b64_tr_b16 v[48:49], v11 offset:0
    v_mfma_f32_16x16x32_bf16 v[116:119], v[64:67], v[152:155], v[116:119]
    ds_read_b64_tr_b16 v[50:51], v11 offset:144
    v_mfma_f32_16x16x32_bf16 v[120:123], v[68:71], v[144:147], v[120:123]
    s_waitcnt lgkmcnt(8)
    v_mfma_f32_16x16x32_bf16 v[72:75], v[32:35], v[132:135], v[72:75]
    ds_read_b128 v[144:147], v9 offset:40960
    ds_read_b128 v[148:151], v9 offset:43008
    v_mfma_f32_16x16x32_bf16 v[76:79], v[32:35], v[136:139], v[76:79]
    ds_read_b128 v[152:155], v9 offset:45056
    v_mfma_f32_16x16x32_bf16 v[80:83], v[32:35], v[140:143], v[80:83]
    ds_read_b64_tr_b16 v[52:53], v10 offset:4608
    s_waitcnt lgkmcnt(10)
    v_mfma_f32_16x16x32_bf16 v[84:87], v[36:39], v[132:135], v[84:87]
    ds_read_b64_tr_b16 v[54:55], v10 offset:4752
    v_mfma_f32_16x16x32_bf16 v[88:91], v[36:39], v[136:139], v[88:91]
    ds_read_b64_tr_b16 v[56:57], v10 offset:4640
    v_mfma_f32_16x16x32_bf16 v[92:95], v[36:39], v[140:143], v[92:95]
    ds_read_b64_tr_b16 v[58:59], v10 offset:4784
    s_waitcnt lgkmcnt(11)
    v_mfma_f32_16x16x32_bf16 v[96:99], v[40:43], v[132:135], v[96:99]
    ds_read_b64_tr_b16 v[60:61], v10 offset:13824
    v_mfma_f32_16x16x32_bf16 v[100:103], v[40:43], v[136:139], v[100:103]
    ds_read_b64_tr_b16 v[62:63], v10 offset:13968
    v_mfma_f32_16x16x32_bf16 v[104:107], v[40:43], v[140:143], v[104:107]
    ds_read_b64_tr_b16 v[64:65], v10 offset:13856
    s_waitcnt lgkmcnt(12)
    v_mfma_f32_16x16x32_bf16 v[108:111], v[44:47], v[132:135], v[108:111]
    ds_read_b64_tr_b16 v[66:67], v10 offset:14000
    v_mfma_f32_16x16x32_bf16 v[112:115], v[44:47], v[136:139], v[112:115]
    ds_read_b64_tr_b16 v[68:69], v11 offset:4608
    v_mfma_f32_16x16x32_bf16 v[116:119], v[44:47], v[140:143], v[116:119]
    ds_read_b64_tr_b16 v[70:71], v11 offset:4752
    s_waitcnt lgkmcnt(13)
    v_mfma_f32_16x16x32_bf16 v[120:123], v[48:51], v[132:135], v[120:123]
    s_waitcnt vmcnt(6) lgkmcnt(0)
    s_barrier
    s_add_u32 s64, s89, 2
    s_sub_u32 s15, s64, 3
    s_cmp_ge_u32 s64, 3
    s_cselect_b32 s64, s15, s64
    s_add_u32 s64, s64, 3
    s_mul_i32 s64, s64, 128
    s_add_u32 m0, s69, 40960
    s_nop 0
    buffer_load_dwordx4 v3, s[44:47], s64 offen lds
    s_add_u32 m0, s69, 41984
    s_nop 0
    buffer_load_dwordx4 v4, s[44:47], s64 offen lds
    s_add_u32 s65, s64, 18432
    s_add_u32 m0, s69, 43008
    s_nop 0
    buffer_load_dwordx4 v3, s[44:47], s65 offen lds
    s_add_u32 m0, s69, 44032
    s_nop 0
    buffer_load_dwordx4 v4, s[44:47], s65 offen lds
    s_add_u32 s65, s64, 36864
    s_add_u32 m0, s69, 45056
    s_nop 0
    buffer_load_dwordx4 v3, s[44:47], s65 offen lds
    s_add_u32 m0, s69, 46080
    s_nop 0
    buffer_load_dwordx4 v4, s[44:47], s65 offen lds
    v_mfma_f32_16x16x32_bf16 v[72:75], v[52:55], v[144:147], v[72:75]
    ds_read_b128 v[132:135], v8 offset:0
    ds_read_b128 v[136:139], v8 offset:2048
    v_mfma_f32_16x16x32_bf16 v[76:79], v[52:55], v[148:151], v[76:79]
    ds_read_b128 v[140:143], v8 offset:4096
    v_mfma_f32_16x16x32_bf16 v[80:83], v[52:55], v[152:155], v[80:83]
    ds_read_b64_tr_b16 v[32:33], v10 offset:18432
    v_mfma_f32_16x16x32_bf16 v[84:87], v[56:59], v[144:147], v[84:87]
    ds_read_b64_tr_b16 v[34:35], v10 offset:18576
    v_mfma_f32_16x16x32_bf16 v[88:91], v[56:59], v[148:151], v[88:91]
    ds_read_b64_tr_b16 v[36:37], v10 offset:18464
    v_mfma_f32_16x16x32_bf16 v[92:95], v[56:59], v[152:155], v[92:95]
    ds_read_b64_tr_b16 v[38:39], v10 offset:18608
    v_mfma_f32_16x16x32_bf16 v[96:99], v[60:63], v[144:147], v[96:99]
    ds_read_b64_tr_b16 v[40:41], v10 offset:27648
    v_mfma_f32_16x16x32_bf16 v[100:103], v[60:63], v[148:151], v[100:103]
    ds_read_b64_tr_b16 v[42:43], v10 offset:27792
    v_mfma_f32_16x16x32_bf16 v[104:107], v[60:63], v[152:155], v[104:107]
    ds_read_b64_tr_b16 v[44:45], v10 offset:27680
    v_mfma_f32_16x16x32_bf16 v[108:111], v[64:67], v[144:147], v[108:111]
    ds_read_b64_tr_b16 v[46:47], v10 offset:27824
    v_mfma_f32_16x16x32_bf16 v[112:115], v[64:67], v[148:151], v[112:115]
    ds_read_b64_tr_b16 v[48:49], v11 offset:18432
    v_mfma_f32_16x16x32_bf16 v[116:119], v[64:67], v[152:155], v[116:119]
    ds_read_b64_tr_b16 v[50:51], v11 offset:18576
    v_mfma_f32_16x16x32_bf16 v[120:123], v[68:71], v[144:147], v[120:123]
    s_waitcnt lgkmcnt(8)
    v_mfma_f32_16x16x32_bf16 v[72:75], v[32:35], v[132:135], v[72:75]
    ds_read_b128 v[144:147], v9 offset:0
    ds_read_b128 v[148:151], v9 offset:2048
    v_mfma_f32_16x16x32_bf16 v[76:79], v[32:35], v[136:139], v[76:79]
    ds_read_b128 v[152:155], v9 offset:4096
    v_mfma_f32_16x16x32_bf16 v[80:83], v[32:35], v[140:143], v[80:83]
    ds_read_b64_tr_b16 v[52:53], v10 offset:23040
    s_waitcnt lgkmcnt(10)
    v_mfma_f32_16x16x32_bf16 v[84:87], v[36:39], v[132:135], v[84:87]
    ds_read_b64_tr_b16 v[54:55], v10 offset:23184
    v_mfma_f32_16x16x32_bf16 v[88:91], v[36:39], v[136:139], v[88:91]
    ds_read_b64_tr_b16 v[56:57], v10 offset:23072
    v_mfma_f32_16x16x32_bf16 v[92:95], v[36:39], v[140:143], v[92:95]
    ds_read_b64_tr_b16 v[58:59], v10 offset:23216
    s_waitcnt lgkmcnt(11)
    v_mfma_f32_16x16x32_bf16 v[96:99], v[40:43], v[132:135], v[96:99]
    ds_read_b64_tr_b16 v[60:61], v10 offset:32256
    v_mfma_f32_16x16x32_bf16 v[100:103], v[40:43], v[136:139], v[100:103]
    ds_read_b64_tr_b16 v[62:63], v10 offset:32400
    v_mfma_f32_16x16x32_bf16 v[104:107], v[40:43], v[140:143], v[104:107]
    ds_read_b64_tr_b16 v[64:65], v10 offset:32288
    s_waitcnt lgkmcnt(12)
    v_mfma_f32_16x16x32_bf16 v[108:111], v[44:47], v[132:135], v[108:111]
    ds_read_b64_tr_b16 v[66:67], v10 offset:32432
    v_mfma_f32_16x16x32_bf16 v[112:115], v[44:47], v[136:139], v[112:115]
    ds_read_b64_tr_b16 v[68:69], v11 offset:23040
    v_mfma_f32_16x16x32_bf16 v[116:119], v[44:47], v[140:143], v[116:119]
    ds_read_b64_tr_b16 v[70:71], v11 offset:23184
    s_waitcnt lgkmcnt(13)
    v_mfma_f32_16x16x32_bf16 v[120:123], v[48:51], v[132:135], v[120:123]
    s_waitcnt vmcnt(6) lgkmcnt(0)
    s_barrier
    s_add_u32 s64, s89, 0
    s_sub_u32 s15, s64, 3
    s_cmp_ge_u32 s64, 3
    s_cselect_b32 s64, s15, s64
    s_add_u32 s64, s64, 6
    s_mul_i32 s64, s64, 128
    s_add_u32 m0, s69, 0
    s_nop 0
    buffer_load_dwordx4 v3, s[44:47], s64 offen lds
    s_add_u32 m0, s69, 1024
    s_nop 0
    buffer_load_dwordx4 v4, s[44:47], s64 offen lds
    s_add_u32 s65, s64, 18432
    s_add_u32 m0, s69, 2048
    s_nop 0
    buffer_load_dwordx4 v3, s[44:47], s65 offen lds
    s_add_u32 m0, s69, 3072
    s_nop 0
    buffer_load_dwordx4 v4, s[44:47], s65 offen lds
    s_add_u32 s65, s64, 36864
    s_add_u32 m0, s69, 4096
    s_nop 0
    buffer_load_dwordx4 v3, s[44:47], s65 offen lds
    s_add_u32 m0, s69, 5120
    s_nop 0
    buffer_load_dwordx4 v4, s[44:47], s65 offen lds
    v_mfma_f32_16x16x32_bf16 v[72:75], v[52:55], v[144:147], v[72:75]
    ds_read_b128 v[132:135], v8 offset:20480
    ds_read_b128 v[136:139], v8 offset:22528
    v_mfma_f32_16x16x32_bf16 v[76:79], v[52:55], v[148:151], v[76:79]
    ds_read_b128 v[140:143], v8 offset:24576
    v_mfma_f32_16x16x32_bf16 v[80:83], v[52:55], v[152:155], v[80:83]
    ds_read_b64_tr_b16 v[32:33], v10 offset:36864
    v_mfma_f32_16x16x32_bf16 v[84:87], v[56:59], v[144:147], v[84:87]
    ds_read_b64_tr_b16 v[34:35], v10 offset:37008
    v_mfma_f32_16x16x32_bf16 v[88:91], v[56:59], v[148:151], v[88:91]
    ds_read_b64_tr_b16 v[36:37], v10 offset:36896
    v_mfma_f32_16x16x32_bf16 v[92:95], v[56:59], v[152:155], v[92:95]
    ds_read_b64_tr_b16 v[38:39], v10 offset:37040
    v_mfma_f32_16x16x32_bf16 v[96:99], v[60:63], v[144:147], v[96:99]
    ds_read_b64_tr_b16 v[40:41], v10 offset:46080
    v_mfma_f32_16x16x32_bf16 v[100:103], v[60:63], v[148:151], v[100:103]
    ds_read_b64_tr_b16 v[42:43], v10 offset:46224
    v_mfma_f32_16x16x32_bf16 v[104:107], v[60:63], v[152:155], v[104:107]
    ds_read_b64_tr_b16 v[44:45], v10 offset:46112
    v_mfma_f32_16x16x32_bf16 v[108:111], v[64:67], v[144:147], v[108:111]
    ds_read_b64_tr_b16 v[46:47], v10 offset:46256
    v_mfma_f32_16x16x32_bf16 v[112:115], v[64:67], v[148:151], v[112:115]
    ds_read_b64_tr_b16 v[48:49], v11 offset:36864
    v_mfma_f32_16x16x32_bf16 v[116:119], v[64:67], v[152:155], v[116:119]
    ds_read_b64_tr_b16 v[50:51], v11 offset:37008
    v_mfma_f32_16x16x32_bf16 v[120:123], v[68:71], v[144:147], v[120:123]
    s_waitcnt lgkmcnt(8)
    v_mfma_f32_16x16x32_bf16 v[72:75], v[32:35], v[132:135], v[72:75]
    ds_read_b128 v[144:147], v9 offset:20480
    ds_read_b128 v[148:151], v9 offset:22528
    v_mfma_f32_16x16x32_bf16 v[76:79], v[32:35], v[136:139], v[76:79]
    ds_read_b128 v[152:155], v9 offset:24576
    v_mfma_f32_16x16x32_bf16 v[80:83], v[32:35], v[140:143], v[80:83]
    ds_read_b64_tr_b16 v[52:53], v10 offset:41472
    s_waitcnt lgkmcnt(10)
    v_mfma_f32_16x16x32_bf16 v[84:87], v[36:39], v[132:135], v[84:87]
    ds_read_b64_tr_b16 v[54:55], v10 offset:41616
    v_mfma_f32_16x16x32_bf16 v[88:91], v[36:39], v[136:139], v[88:91]
    ds_read_b64_tr_b16 v[56:57], v10 offset:41504
    v_mfma_f32_16x16x32_bf16 v[92:95], v[36:39], v[140:143], v[92:95]
    ds_read_b64_tr_b16 v[58:59], v10 offset:41648
    s_waitcnt lgkmcnt(11)
    v_mfma_f32_16x16x32_bf16 v[96:99], v[40:43], v[132:135], v[96:99]
    ds_read_b64_tr_b16 v[60:61], v10 offset:50688
    v_mfma_f32_16x16x32_bf16 v[100:103], v[40:43], v[136:139], v[100:103]
    ds_read_b64_tr_b16 v[62:63], v10 offset:50832
    v_mfma_f32_16x16x32_bf16 v[104:107], v[40:43], v[140:143], v[104:107]
    ds_read_b64_tr_b16 v[64:65], v10 offset:50720
    s_waitcnt lgkmcnt(12)
    v_mfma_f32_16x16x32_bf16 v[108:111], v[44:47], v[132:135], v[108:111]
    ds_read_b64_tr_b16 v[66:67], v10 offset:50864
    v_mfma_f32_16x16x32_bf16 v[112:115], v[44:47], v[136:139], v[112:115]
    ds_read_b64_tr_b16 v[68:69], v11 offset:41472
    v_mfma_f32_16x16x32_bf16 v[116:119], v[44:47], v[140:143], v[116:119]
    ds_read_b64_tr_b16 v[70:71], v11 offset:41616
    s_waitcnt lgkmcnt(13)
    v_mfma_f32_16x16x32_bf16 v[120:123], v[48:51], v[132:135], v[120:123]
    s_waitcnt vmcnt(6) lgkmcnt(0)
    s_barrier
    s_add_u32 s64, s89, 1
    s_sub_u32 s15, s64, 3
    s_cmp_ge_u32 s64, 3
    s_cselect_b32 s64, s15, s64
    s_add_u32 s64, s64, 6
    s_mul_i32 s64, s64, 128
    s_add_u32 m0, s69, 20480
    s_nop 0
    buffer_load_dwordx4 v3, s[44:47], s64 offen lds
    s_add_u32 m0, s69, 21504
    s_nop 0
    buffer_load_dwordx4 v4, s[44:47], s64 offen lds
    s_add_u32 s65, s64, 18432
    s_add_u32 m0, s69, 22528
    s_nop 0
    buffer_load_dwordx4 v3, s[44:47], s65 offen lds
    s_add_u32 m0, s69, 23552
    s_nop 0
    buffer_load_dwordx4 v4, s[44:47], s65 offen lds
    s_add_u32 s65, s64, 36864
    s_add_u32 m0, s69, 24576
    s_nop 0
    buffer_load_dwordx4 v3, s[44:47], s65 offen lds
    s_add_u32 m0, s69, 25600
    s_nop 0
    buffer_load_dwordx4 v4, s[44:47], s65 offen lds
    v_mfma_f32_16x16x32_bf16 v[72:75], v[52:55], v[144:147], v[72:75]
    ds_read_b128 v[132:135], v8 offset:40960
    ds_read_b128 v[136:139], v8 offset:43008
    v_mfma_f32_16x16x32_bf16 v[76:79], v[52:55], v[148:151], v[76:79]
    ds_read_b128 v[140:143], v8 offset:45056
    v_mfma_f32_16x16x32_bf16 v[80:83], v[52:55], v[152:155], v[80:83]
    ds_read_b64_tr_b16 v[32:33], v10 offset:0
    v_mfma_f32_16x16x32_bf16 v[84:87], v[56:59], v[144:147], v[84:87]
    ds_read_b64_tr_b16 v[34:35], v10 offset:144
    v_mfma_f32_16x16x32_bf16 v[88:91], v[56:59], v[148:151], v[88:91]
    ds_read_b64_tr_b16 v[36:37], v10 offset:32
    v_mfma_f32_16x16x32_bf16 v[92:95], v[56:59], v[152:155], v[92:95]
    ds_read_b64_tr_b16 v[38:39], v10 offset:176
    v_mfma_f32_16x16x32_bf16 v[96:99], v[60:63], v[144:147], v[96:99]
    ds_read_b64_tr_b16 v[40:41], v10 offset:9216
    v_mfma_f32_16x16x32_bf16 v[100:103], v[60:63], v[148:151], v[100:103]
    ds_read_b64_tr_b16 v[42:43], v10 offset:9360
    v_mfma_f32_16x16x32_bf16 v[104:107], v[60:63], v[152:155], v[104:107]
    ds_read_b64_tr_b16 v[44:45], v10 offset:9248
    v_mfma_f32_16x16x32_bf16 v[108:111], v[64:67], v[144:147], v[108:111]
    ds_read_b64_tr_b16 v[46:47], v10 offset:9392
    v_mfma_f32_16x16x32_bf16 v[112:115], v[64:67], v[148:151], v[112:115]
    ds_read_b64_tr_b16 v[48:49], v11 offset:0
    v_mfma_f32_16x16x32_bf16 v[116:119], v[64:67], v[152:155], v[116:119]
    ds_read_b64_tr_b16 v[50:51], v11 offset:144
    v_mfma_f32_16x16x32_bf16 v[120:123], v[68:71], v[144:147], v[120:123]
    s_waitcnt lgkmcnt(8)
    v_mfma_f32_16x16x32_bf16 v[72:75], v[32:35], v[132:135], v[72:75]
    ds_read_b128 v[144:147], v9 offset:40960
    ds_read_b128 v[148:151], v9 offset:43008
    v_mfma_f32_16x16x32_bf16 v[76:79], v[32:35], v[136:139], v[76:79]
    ds_read_b128 v[152:155], v9 offset:45056
    v_mfma_f32_16x16x32_bf16 v[80:83], v[32:35], v[140:143], v[80:83]
    ds_read_b64_tr_b16 v[52:53], v10 offset:4608
    s_waitcnt lgkmcnt(10)
    v_mfma_f32_16x16x32_bf16 v[84:87], v[36:39], v[132:135], v[84:87]
    ds_read_b64_tr_b16 v[54:55], v10 offset:4752
    v_mfma_f32_16x16x32_bf16 v[88:91], v[36:39], v[136:139], v[88:91]
    ds_read_b64_tr_b16 v[56:57], v10 offset:4640
    v_mfma_f32_16x16x32_bf16 v[92:95], v[36:39], v[140:143], v[92:95]
    ds_read_b64_tr_b16 v[58:59], v10 offset:4784
    s_waitcnt lgkmcnt(11)
    v_mfma_f32_16x16x32_bf16 v[96:99], v[40:43], v[132:135], v[96:99]
    ds_read_b64_tr_b16 v[60:61], v10 offset:13824
    v_mfma_f32_16x16x32_bf16 v[100:103], v[40:43], v[136:139], v[100:103]
    ds_read_b64_tr_b16 v[62:63], v10 offset:13968
    v_mfma_f32_16x16x32_bf16 v[104:107], v[40:43], v[140:143], v[104:107]
    ds_read_b64_tr_b16 v[64:65], v10 offset:13856
    s_waitcnt lgkmcnt(12)
    v_mfma_f32_16x16x32_bf16 v[108:111], v[44:47], v[132:135], v[108:111]
    ds_read_b64_tr_b16 v[66:67], v10 offset:14000
    v_mfma_f32_16x16x32_bf16 v[112:115], v[44:47], v[136:139], v[112:115]
    ds_read_b64_tr_b16 v[68:69], v11 offset:4608
    v_mfma_f32_16x16x32_bf16 v[116:119], v[44:47], v[140:143], v[116:119]
    ds_read_b64_tr_b16 v[70:71], v11 offset:4752
    s_waitcnt lgkmcnt(13)
    v_mfma_f32_16x16x32_bf16 v[120:123], v[48:51], v[132:135], v[120:123]
    s_waitcnt vmcnt(6) lgkmcnt(0)
    s_barrier
    s_add_u32 s64, s89, 2
    s_sub_u32 s15, s64, 3
    s_cmp_ge_u32 s64, 3
    s_cselect_b32 s64, s15, s64
    s_add_u32 s64, s64, 6
    s_mul_i32 s64, s64, 128
    s_add_u32 m0, s69, 40960
    s_nop 0
    buffer_load_dwordx4 v3, s[44:47], s64 offen lds
    s_add_u32 m0, s69, 41984
    s_nop 0
    buffer_load_dwordx4 v4, s[44:47], s64 offen lds
    s_add_u32 s65, s64, 18432
    s_add_u32 m0, s69, 43008
    s_nop 0
    buffer_load_dwordx4 v3, s[44:47], s65 offen lds
    s_add_u32 m0, s69, 44032
    s_nop 0
    buffer_load_dwordx4 v4, s[44:47], s65 offen lds
    s_add_u32 s65, s64, 36864
    s_add_u32 m0, s69, 45056
    s_nop 0
    buffer_load_dwordx4 v3, s[44:47], s65 offen lds
    s_add_u32 m0, s69, 46080
    s_nop 0
    buffer_load_dwordx4 v4, s[44:47], s65 offen lds
    global_load_dword v18, v30, s[40:41] sc1
    v_mfma_f32_16x16x32_bf16 v[72:75], v[52:55], v[144:147], v[72:75]
    ds_read_b128 v[132:135], v8 offset:0
    ds_read_b128 v[136:139], v8 offset:2048
    v_mfma_f32_16x16x32_bf16 v[76:79], v[52:55], v[148:151], v[76:79]
    ds_read_b128 v[140:143], v8 offset:4096
    v_mfma_f32_16x16x32_bf16 v[80:83], v[52:55], v[152:155], v[80:83]
    ds_read_b64_tr_b16 v[32:33], v10 offset:18432
    v_mfma_f32_16x16x32_bf16 v[84:87], v[56:59], v[144:147], v[84:87]
    ds_read_b64_tr_b16 v[34:35], v10 offset:18576
    v_mfma_f32_16x16x32_bf16 v[88:91], v[56:59], v[148:151], v[88:91]
    ds_read_b64_tr_b16 v[36:37], v10 offset:18464
    v_mfma_f32_16x16x32_bf16 v[92:95], v[56:59], v[152:155], v[92:95]
    ds_read_b64_tr_b16 v[38:39], v10 offset:18608
    v_mfma_f32_16x16x32_bf16 v[96:99], v[60:63], v[144:147], v[96:99]
    ds_read_b64_tr_b16 v[40:41], v10 offset:27648
    v_mfma_f32_16x16x32_bf16 v[100:103], v[60:63], v[148:151], v[100:103]
    ds_read_b64_tr_b16 v[42:43], v10 offset:27792
    v_mfma_f32_16x16x32_bf16 v[104:107], v[60:63], v[152:155], v[104:107]
    ds_read_b64_tr_b16 v[44:45], v10 offset:27680
    v_mfma_f32_16x16x32_bf16 v[108:111], v[64:67], v[144:147], v[108:111]
    ds_read_b64_tr_b16 v[46:47], v10 offset:27824
    v_mfma_f32_16x16x32_bf16 v[112:115], v[64:67], v[148:151], v[112:115]
    ds_read_b64_tr_b16 v[48:49], v11 offset:18432
    v_mfma_f32_16x16x32_bf16 v[116:119], v[64:67], v[152:155], v[116:119]
    ds_read_b64_tr_b16 v[50:51], v11 offset:18576
    v_mfma_f32_16x16x32_bf16 v[120:123], v[68:71], v[144:147], v[120:123]
    s_waitcnt lgkmcnt(8)
    v_mfma_f32_16x16x32_bf16 v[72:75], v[32:35], v[132:135], v[72:75]
    ds_read_b128 v[144:147], v9 offset:0
    ds_read_b128 v[148:151], v9 offset:2048
    v_mfma_f32_16x16x32_bf16 v[76:79], v[32:35], v[136:139], v[76:79]
    ds_read_b128 v[152:155], v9 offset:4096
    v_mfma_f32_16x16x32_bf16 v[80:83], v[32:35], v[140:143], v[80:83]
    ds_read_b64_tr_b16 v[52:53], v10 offset:23040
    s_waitcnt lgkmcnt(10)
    v_mfma_f32_16x16x32_bf16 v[84:87], v[36:39], v[132:135], v[84:87]
    ds_read_b64_tr_b16 v[54:55], v10 offset:23184
    v_mfma_f32_16x16x32_bf16 v[88:91], v[36:39], v[136:139], v[88:91]
    ds_read_b64_tr_b16 v[56:57], v10 offset:23072
    v_mfma_f32_16x16x32_bf16 v[92:95], v[36:39], v[140:143], v[92:95]
    ds_read_b64_tr_b16 v[58:59], v10 offset:23216
    s_waitcnt lgkmcnt(11)
    v_mfma_f32_16x16x32_bf16 v[96:99], v[40:43], v[132:135], v[96:99]
    ds_read_b64_tr_b16 v[60:61], v10 offset:32256
    v_mfma_f32_16x16x32_bf16 v[100:103], v[40:43], v[136:139], v[100:103]
    ds_read_b64_tr_b16 v[62:63], v10 offset:32400
    v_mfma_f32_16x16x32_bf16 v[104:107], v[40:43], v[140:143], v[104:107]
    ds_read_b64_tr_b16 v[64:65], v10 offset:32288
    s_waitcnt lgkmcnt(12)
    v_mfma_f32_16x16x32_bf16 v[108:111], v[44:47], v[132:135], v[108:111]
    ds_read_b64_tr_b16 v[66:67], v10 offset:32432
    v_mfma_f32_16x16x32_bf16 v[112:115], v[44:47], v[136:139], v[112:115]
    ds_read_b64_tr_b16 v[68:69], v11 offset:23040
    v_mfma_f32_16x16x32_bf16 v[116:119], v[44:47], v[140:143], v[116:119]
    ds_read_b64_tr_b16 v[70:71], v11 offset:23184
    s_waitcnt lgkmcnt(13)
    v_mfma_f32_16x16x32_bf16 v[120:123], v[48:51], v[132:135], v[120:123]
    s_waitcnt vmcnt(7) lgkmcnt(0)
    s_barrier
    v_mfma_f32_16x16x32_bf16 v[72:75], v[52:55], v[144:147], v[72:75]
    ds_read_b128 v[132:135], v8 offset:20480
    ds_read_b128 v[136:139], v8 offset:22528
    v_mfma_f32_16x16x32_bf16 v[76:79], v[52:55], v[148:151], v[76:79]
    ds_read_b128 v[140:143], v8 offset:24576
    v_mfma_f32_16x16x32_bf16 v[80:83], v[52:55], v[152:155], v[80:83]
    ds_read_b64_tr_b16 v[32:33], v10 offset:36864
    v_mfma_f32_16x16x32_bf16 v[84:87], v[56:59], v[144:147], v[84:87]
    ds_read_b64_tr_b16 v[34:35], v10 offset:37008
    v_mfma_f32_16x16x32_bf16 v[88:91], v[56:59], v[148:151], v[88:91]
    ds_read_b64_tr_b16 v[36:37], v10 offset:36896
    v_mfma_f32_16x16x32_bf16 v[92:95], v[56:59], v[152:155], v[92:95]
    ds_read_b64_tr_b16 v[38:39], v10 offset:37040
    v_mfma_f32_16x16x32_bf16 v[96:99], v[60:63], v[144:147], v[96:99]
    ds_read_b64_tr_b16 v[40:41], v10 offset:46080
    v_mfma_f32_16x16x32_bf16 v[100:103], v[60:63], v[148:151], v[100:103]
    ds_read_b64_tr_b16 v[42:43], v10 offset:46224
    v_mfma_f32_16x16x32_bf16 v[104:107], v[60:63], v[152:155], v[104:107]
    ds_read_b64_tr_b16 v[44:45], v10 offset:46112
    v_mfma_f32_16x16x32_bf16 v[108:111], v[64:67], v[144:147], v[108:111]
    ds_read_b64_tr_b16 v[46:47], v10 offset:46256
    v_mfma_f32_16x16x32_bf16 v[112:115], v[64:67], v[148:151], v[112:115]
    ds_read_b64_tr_b16 v[48:49], v11 offset:36864
    v_mfma_f32_16x16x32_bf16 v[116:119], v[64:67], v[152:155], v[116:119]
    ds_read_b64_tr_b16 v[50:51], v11 offset:37008
    v_mfma_f32_16x16x32_bf16 v[120:123], v[68:71], v[144:147], v[120:123]
    s_waitcnt lgkmcnt(8)
    v_mfma_f32_16x16x32_bf16 v[72:75], v[32:35], v[132:135], v[72:75]
    ds_read_b128 v[144:147], v9 offset:20480
    ds_read_b128 v[148:151], v9 offset:22528
    v_mfma_f32_16x16x32_bf16 v[76:79], v[32:35], v[136:139], v[76:79]
    ds_read_b128 v[152:155], v9 offset:24576
    v_mfma_f32_16x16x32_bf16 v[80:83], v[32:35], v[140:143], v[80:83]
    ds_read_b64_tr_b16 v[52:53], v10 offset:41472
    s_waitcnt lgkmcnt(10)
    v_mfma_f32_16x16x32_bf16 v[84:87], v[36:39], v[132:135], v[84:87]
    ds_read_b64_tr_b16 v[54:55], v10 offset:41616
    v_mfma_f32_16x16x32_bf16 v[88:91], v[36:39], v[136:139], v[88:91]
    ds_read_b64_tr_b16 v[56:57], v10 offset:41504
    v_mfma_f32_16x16x32_bf16 v[92:95], v[36:39], v[140:143], v[92:95]
    ds_read_b64_tr_b16 v[58:59], v10 offset:41648
    s_waitcnt lgkmcnt(11)
    v_mfma_f32_16x16x32_bf16 v[96:99], v[40:43], v[132:135], v[96:99]
    ds_read_b64_tr_b16 v[60:61], v10 offset:50688
    v_mfma_f32_16x16x32_bf16 v[100:103], v[40:43], v[136:139], v[100:103]
    ds_read_b64_tr_b16 v[62:63], v10 offset:50832
    v_mfma_f32_16x16x32_bf16 v[104:107], v[40:43], v[140:143], v[104:107]
    ds_read_b64_tr_b16 v[64:65], v10 offset:50720
    s_waitcnt lgkmcnt(12)
    v_mfma_f32_16x16x32_bf16 v[108:111], v[44:47], v[132:135], v[108:111]
    ds_read_b64_tr_b16 v[66:67], v10 offset:50864
    v_mfma_f32_16x16x32_bf16 v[112:115], v[44:47], v[136:139], v[112:115]
    ds_read_b64_tr_b16 v[68:69], v11 offset:41472
    v_mfma_f32_16x16x32_bf16 v[116:119], v[44:47], v[140:143], v[116:119]
    ds_read_b64_tr_b16 v[70:71], v11 offset:41616
    s_waitcnt lgkmcnt(13)
    v_mfma_f32_16x16x32_bf16 v[120:123], v[48:51], v[132:135], v[120:123]
    s_waitcnt vmcnt(1) lgkmcnt(0)
    s_barrier
    v_mfma_f32_16x16x32_bf16 v[72:75], v[52:55], v[144:147], v[72:75]
    ds_read_b128 v[132:135], v8 offset:40960
    ds_read_b128 v[136:139], v8 offset:43008
    v_mfma_f32_16x16x32_bf16 v[76:79], v[52:55], v[148:151], v[76:79]
    ds_read_b128 v[140:143], v8 offset:45056
    v_mfma_f32_16x16x32_bf16 v[80:83], v[52:55], v[152:155], v[80:83]
    ds_read_b64_tr_b16 v[32:33], v10 offset:0
    v_mfma_f32_16x16x32_bf16 v[84:87], v[56:59], v[144:147], v[84:87]
    ds_read_b64_tr_b16 v[34:35], v10 offset:144
    v_mfma_f32_16x16x32_bf16 v[88:91], v[56:59], v[148:151], v[88:91]
    ds_read_b64_tr_b16 v[36:37], v10 offset:32
    v_mfma_f32_16x16x32_bf16 v[92:95], v[56:59], v[152:155], v[92:95]
    ds_read_b64_tr_b16 v[38:39], v10 offset:176
    v_mfma_f32_16x16x32_bf16 v[96:99], v[60:63], v[144:147], v[96:99]
    ds_read_b64_tr_b16 v[40:41], v10 offset:9216
    v_mfma_f32_16x16x32_bf16 v[100:103], v[60:63], v[148:151], v[100:103]
    ds_read_b64_tr_b16 v[42:43], v10 offset:9360
    v_mfma_f32_16x16x32_bf16 v[104:107], v[60:63], v[152:155], v[104:107]
    ds_read_b64_tr_b16 v[44:45], v10 offset:9248
    v_mfma_f32_16x16x32_bf16 v[108:111], v[64:67], v[144:147], v[108:111]
    ds_read_b64_tr_b16 v[46:47], v10 offset:9392
    v_mfma_f32_16x16x32_bf16 v[112:115], v[64:67], v[148:151], v[112:115]
    ds_read_b64_tr_b16 v[48:49], v11 offset:0
    v_mfma_f32_16x16x32_bf16 v[116:119], v[64:67], v[152:155], v[116:119]
    ds_read_b64_tr_b16 v[50:51], v11 offset:144
    v_mfma_f32_16x16x32_bf16 v[120:123], v[68:71], v[144:147], v[120:123]
    s_waitcnt lgkmcnt(8)
    v_mfma_f32_16x16x32_bf16 v[72:75], v[32:35], v[132:135], v[72:75]
    ds_read_b128 v[144:147], v9 offset:40960
    ds_read_b128 v[148:151], v9 offset:43008
    v_mfma_f32_16x16x32_bf16 v[76:79], v[32:35], v[136:139], v[76:79]
    ds_read_b128 v[152:155], v9 offset:45056
    v_mfma_f32_16x16x32_bf16 v[80:83], v[32:35], v[140:143], v[80:83]
    ds_read_b64_tr_b16 v[52:53], v10 offset:4608
    s_waitcnt lgkmcnt(10)
    v_mfma_f32_16x16x32_bf16 v[84:87], v[36:39], v[132:135], v[84:87]
    ds_read_b64_tr_b16 v[54:55], v10 offset:4752
    v_mfma_f32_16x16x32_bf16 v[88:91], v[36:39], v[136:139], v[88:91]
    ds_read_b64_tr_b16 v[56:57], v10 offset:4640
    v_mfma_f32_16x16x32_bf16 v[92:95], v[36:39], v[140:143], v[92:95]
    ds_read_b64_tr_b16 v[58:59], v10 offset:4784
    s_waitcnt lgkmcnt(11)
    v_mfma_f32_16x16x32_bf16 v[96:99], v[40:43], v[132:135], v[96:99]
    ds_read_b64_tr_b16 v[60:61], v10 offset:13824
    v_mfma_f32_16x16x32_bf16 v[100:103], v[40:43], v[136:139], v[100:103]
    ds_read_b64_tr_b16 v[62:63], v10 offset:13968
    v_mfma_f32_16x16x32_bf16 v[104:107], v[40:43], v[140:143], v[104:107]
    ds_read_b64_tr_b16 v[64:65], v10 offset:13856
    s_waitcnt lgkmcnt(12)
    v_mfma_f32_16x16x32_bf16 v[108:111], v[44:47], v[132:135], v[108:111]
    ds_read_b64_tr_b16 v[66:67], v10 offset:14000
    v_mfma_f32_16x16x32_bf16 v[112:115], v[44:47], v[136:139], v[112:115]
    ds_read_b64_tr_b16 v[68:69], v11 offset:4608
    v_mfma_f32_16x16x32_bf16 v[116:119], v[44:47], v[140:143], v[116:119]
    ds_read_b64_tr_b16 v[70:71], v11 offset:4752
    s_waitcnt lgkmcnt(13)
    v_mfma_f32_16x16x32_bf16 v[120:123], v[48:51], v[132:135], v[120:123]
    s_waitcnt lgkmcnt(8)
    v_mfma_f32_16x16x32_bf16 v[72:75], v[52:55], v[144:147], v[72:75]
    v_mfma_f32_16x16x32_bf16 v[76:79], v[52:55], v[148:151], v[76:79]
    v_mfma_f32_16x16x32_bf16 v[80:83], v[52:55], v[152:155], v[80:83]
    s_waitcnt lgkmcnt(6)
    v_mfma_f32_16x16x32_bf16 v[84:87], v[56:59], v[144:147], v[84:87]
    v_mfma_f32_16x16x32_bf16 v[88:91], v[56:59], v[148:151], v[88:91]
    v_mfma_f32_16x16x32_bf16 v[92:95], v[56:59], v[152:155], v[92:95]
    s_waitcnt lgkmcnt(4)
    v_mfma_f32_16x16x32_bf16 v[96:99], v[60:63], v[144:147], v[96:99]
    v_mfma_f32_16x16x32_bf16 v[100:103], v[60:63], v[148:151], v[100:103]
    v_mfma_f32_16x16x32_bf16 v[104:107], v[60:63], v[152:155], v[104:107]
    s_waitcnt lgkmcnt(2)
    v_mfma_f32_16x16x32_bf16 v[108:111], v[64:67], v[144:147], v[108:111]
    v_mfma_f32_16x16x32_bf16 v[112:115], v[64:67], v[148:151], v[112:115]
    v_mfma_f32_16x16x32_bf16 v[116:119], v[64:67], v[152:155], v[116:119]
    s_waitcnt lgkmcnt(0)
    v_mfma_f32_16x16x32_bf16 v[120:123], v[68:71], v[144:147], v[120:123]
    s_mov_b32 s74, 0
    v_cvt_pk_bf16_f32 v72, v72, v73
    v_cvt_pk_bf16_f32 v73, v74, v75
    v_cvt_pk_bf16_f32 v74, v84, v85
    v_cvt_pk_bf16_f32 v75, v86, v87
    v_cvt_pk_bf16_f32 v96, v96, v97
    v_cvt_pk_bf16_f32 v97, v98, v99
    v_cvt_pk_bf16_f32 v98, v108, v109
    v_cvt_pk_bf16_f32 v99, v110, v111
    v_cvt_pk_bf16_f32 v120, v120, v121
    v_cvt_pk_bf16_f32 v121, v122, v123
    buffer_store_dwordx4 v[72:75], v200, s[52:55], s74 offen sc1
    buffer_store_dwordx4 v[96:99], v200, s[52:55], s74 offen offset:2048 sc1
    buffer_store_dwordx2 v[120:121], v201, s[52:55], s74 offen sc1
    s_add_u32 s74, s74, 18432
    v_cvt_pk_bf16_f32 v76, v76, v77
    v_cvt_pk_bf16_f32 v77, v78, v79
    v_cvt_pk_bf16_f32 v78, v88, v89
    v_cvt_pk_bf16_f32 v79, v90, v91
    v_cvt_pk_bf16_f32 v100, v100, v101
    v_cvt_pk_bf16_f32 v101, v102, v103
    v_cvt_pk_bf16_f32 v102, v112, v113
    v_cvt_pk_bf16_f32 v103, v114, v115
    buffer_store_dwordx4 v[76:79], v200, s[52:55], s74 offen sc1
    buffer_store_dwordx4 v[100:103], v200, s[52:55], s74 offen offset:2048 sc1
    s_add_u32 s74, s74, 18432
    v_cvt_pk_bf16_f32 v80, v80, v81
    v_cvt_pk_bf16_f32 v81, v82, v83
    v_cvt_pk_bf16_f32 v82, v92, v93
    v_cvt_pk_bf16_f32 v83, v94, v95
    v_cvt_pk_bf16_f32 v104, v104, v105
    v_cvt_pk_bf16_f32 v105, v106, v107
    v_cvt_pk_bf16_f32 v106, v116, v117
    v_cvt_pk_bf16_f32 v107, v118, v119
    buffer_store_dwordx4 v[80:83], v200, s[52:55], s74 offen sc1
    buffer_store_dwordx4 v[104:107], v200, s[52:55], s74 offen offset:2048 sc1
    s_add_u32 s74, s74, 18432
Q_join:
    s_waitcnt vmcnt(0)
    s_movk_i32 s77, 20000
    v_readfirstlane_b32 s9, v18
    s_nop 0
    s_cmp_lg_u32 s9, 0
    s_cbranch_scc1 Q_nonce_ok
Q_nonce_poll:
    s_sleep 1
    global_load_dword v18, v30, s[40:41] sc1
    s_waitcnt vmcnt(0)
    v_readfirstlane_b32 s9, v18
    s_sub_u32 s77, s77, 1
    s_cbranch_scc1 Q_nonce_ok
    s_cmp_eq_u32 s9, 0
    s_cbranch_scc1 Q_nonce_poll

Q_nonce_ok:
    v_mov_b32 v6, s9
    s_barrier
    s_cmp_lg_u32 s6, 7
    s_cbranch_scc1 O_join
    s_mov_b64 exec, 1
    buffer_store_dword v6, v202, s[52:55], 0 offen sc1
    s_mov_b64 exec, -1

O_join:
    s_mov_b32 s95, 0
    s_movk_i32 s77, 20000
O_nonce_poll:
    global_load_dword v18, v30, s[40:41] sc1
    s_waitcnt vmcnt(0)
    v_readfirstlane_b32 s9, v18
    s_nop 0
    s_cmp_lg_u32 s9, 0
    s_cbranch_scc1 O_go
    s_sleep 32
    s_sub_u32 s77, s77, 1
    s_cbranch_scc0 O_nonce_poll

O_go:
    s_cmp_ge_u32 s6, 4
    s_cbranch_scc1 O_nodma
    s_mov_b32 s60, s36
    s_mov_b32 s61, s37
    s_mov_b32 s62, 663552
    s_mov_b32 s63, 0x00020000
    s_lshl_b32 s71, s12, 10
    s_add_u32 s71, s71, 49152
    v_lshrrev_b32 v25, 3, v2
    v_and_b32 v26, 1, v19
    v_lshlrev_b32 v26, 1, v26
    s_and_b32 s74, s12, 1
    s_lshl_b32 s74, s74, 2
    v_or_b32 v26, s74, v26
    v_and_b32 v27, 7, v2
    v_xor_b32 v26, v26, v27
    s_lshl_b32 s75, s8, 7
    v_lshl_add_u32 v26, v26, 4, s75
    s_lshl_b32 s74, s12, 3
    v_add_u32 v240, s74, v25
    v_mul_u32_u24 v240, 1152, v240
    v_add_u32 v240, v240, v26
    v_lshrrev_b32 v27, 2, v25
    s_lshl_b32 s74, s12, 1
    v_add_u32 v27, s74, v27
    v_mul_u32_u24 v27, 36, v27
    v_and_b32 v28, 3, v25
    v_add3_u32 v27, v27, v28, 32
    v_mul_u32_u24 v241, 1152, v27
    v_add_u32 v241, v241, v26

    s_mov_b32 s88, 0
    s_add_u32 m0, s71, 0
    s_nop 0
    buffer_load_dwordx4 v240, s[60:63], s88 offen lds
    s_mov_b32 s88, 41472
    s_add_u32 m0, s71, 4096
    s_nop 0
    buffer_load_dwordx4 v240, s[60:63], s88 offen lds
    s_mov_b32 s88, 82944
    s_add_u32 m0, s71, 8192
    s_nop 0
    buffer_load_dwordx4 v240, s[60:63], s88 offen lds
    s_mov_b32 s88, 124416
    s_add_u32 m0, s71, 12288
    s_nop 0
    buffer_load_dwordx4 v240, s[60:63], s88 offen lds
    s_mov_b32 s88, 165888
    s_add_u32 m0, s71, 16384
    s_nop 0
    buffer_load_dwordx4 v240, s[60:63], s88 offen lds
    s_mov_b32 s88, 207360
    s_add_u32 m0, s71, 20480
    s_nop 0
    buffer_load_dwordx4 v240, s[60:63], s88 offen lds
    s_mov_b32 s88, 248832
    s_add_u32 m0, s71, 24576
    s_nop 0
    buffer_load_dwordx4 v240, s[60:63], s88 offen lds
    s_mov_b32 s88, 290304
    s_add_u32 m0, s71, 28672
    s_nop 0
    buffer_load_dwordx4 v240, s[60:63], s88 offen lds
    s_mov_b32 s88, 331776
    s_add_u32 m0, s71, 32768
    s_nop 0
    buffer_load_dwordx4 v240, s[60:63], s88 offen lds
    s_mov_b32 s88, 373248
    s_add_u32 m0, s71, 36864
    s_nop 0
    buffer_load_dwordx4 v240, s[60:63], s88 offen lds
    s_mov_b32 s88, 414720
    s_add_u32 m0, s71, 40960
    s_nop 0
    buffer_load_dwordx4 v240, s[60:63], s88 offen lds
    s_mov_b32 s88, 456192
    s_add_u32 m0, s71, 45056
    s_nop 0
    buffer_load_dwordx4 v240, s[60:63], s88 offen lds
    s_mov_b32 s88, 497664
    s_add_u32 m0, s71, 49152
    s_nop 0
    buffer_load_dwordx4 v240, s[60:63], s88 offen lds
    s_mov_b32 s88, 539136
    s_add_u32 m0, s71, 53248
    s_nop 0
    buffer_load_dwordx4 v240, s[60:63], s88 offen lds
    s_mov_b32 s88, 580608
    s_add_u32 m0, s71, 57344
    s_nop 0
    buffer_load_dwordx4 v240, s[60:63], s88 offen lds
    s_mov_b32 s88, 622080
    s_add_u32 m0, s71, 61440
    s_nop 0
    buffer_load_dwordx4 v240, s[60:63], s88 offen lds
    s_mov_b32 s88, 0
    s_add_u32 m0, s71, 65536
    s_nop 0
    buffer_load_dwordx4 v241, s[60:63], s88 offen lds
    s_mov_b32 s88, 331776
    s_add_u32 m0, s71, 69632
    s_nop 0
    buffer_load_dwordx4 v241, s[60:63], s88 offen lds
O_nodma:
    s_waitcnt vmcnt(0)
O_join2:
    v_mov_b32 v20, 0xd0000
    s_lshl_b32 s74, s2, 7
    s_and_b32 s74, s74, 0x3fff
    v_add_u32 v20, s74, v20
    s_cmp_lg_u32 s6, 7
    s_cbranch_scc1 O_w1_done
    s_movk_i32 s77, 30000
O_w1_poll:
    buffer_load_dword v21, v20, s[52:55], 0 offen sc1
    s_waitcnt vmcnt(0)
    v_cmp_ne_u32 vcc, s9, v21
    s_cbranch_vccz O_w1_done

    s_sleep 16
    s_sub_u32 s77, s77, 1
    s_cbranch_scc0 O_w1_poll
O_w1_done:
    s_barrier
    s_branch OUT_entry
A_entry:
    s_mul_i32 s10, s6, 17920
    s_lshl_b32 s11, s4, 4
    s_mov_b32 s44, s16
    s_mov_b32 s45, s17
    s_mov_b32 s46, 2359296
    s_mov_b32 s47, 0x00020000
    s_mov_b32 s14, 0x05040100
    s_mov_b32 s15, 0x07060302

    v_mov_b32 v32, 0
    v_mov_b32 v33, 0
    v_lshl_add_u32 v34, v2, 3, s10
    s_mov_b32 exec_hi, 0x00ffffff
    ds_write_b64 v34, v[32:33] offset:8704
    ds_write_b64 v34, v[32:33] offset:13280
    s_mov_b64 exec, -1
    v_mul_u32_u24 v20, 9216, v0
    v_add_u32 v20, s11, v20
    v_subrev_u32 v30, 1152, v20
    s_and_b32 s61, s4, 7
    s_barrier
    s_mov_b64 exec, 1
    buffer_load_dwordx4 v[240:243], v30, s[44:47], 0 offen
    s_mov_b64 exec, -1

    s_cmp_ge_u32 s4, 64
    s_cbranch_scc1 A_nopf
    s_cmp_lt_u32 s6, 4
    s_cbranch_scc1 A_nopf
    s_lshr_b32 s73, s4, 4
    s_mul_i32 s73, s73, 589824
    s_add_u32 s64, s30, s73
    s_addc_u32 s65, s31, 0
    s_sub_u32 s66, 2359296, s73
    s_min_u32 s66, s66, 737280
    s_mov_b32 s67, 0x00020000
    s_mov_b32 s68, s32
    s_mov_b32 s69, s33
    s_mov_b32 s70, 1990656
    s_mov_b32 s71, 0x00020000
    s_and_b32 s72, s4, 7
    s_lshl_b32 s72, s72, 8
    v_and_b32 v96, 255, v0
    v_add_u32 v96, s72, v96
    s_bfe_u32 s74, s4, 0x10003
    s_lshl_b32 s74, s74, 9
    s_add_u32 s74, s74, 663552
    s_mov_b32 s75, 10923
    s_movk_i32 s73, 13108

    v_add_u32 v97, 0, v96
    v_mul_lo_u32 v98, v97, s73
    v_lshrrev_b32 v98, 16, v98
    v_mul_u32_u24 v99, 5, v98
    v_sub_u32 v99, v97, v99
    v_mul_u32_u24 v98, 1152, v98
    v_lshl_add_u32 v98, v99, 7, v98

    buffer_load_dword v244, v98, s[68:71], s74 offen
    v_sub_u32 v100, 2047, v96
    v_add_u32 v97, 0, v100
    v_mul_lo_u32 v98, v97, s75
    v_lshrrev_b32 v98, 16, v98
    v_mul_u32_u24 v99, 6, v98
    v_sub_u32 v99, v97, v99
    v_mul_u32_u24 v98, 1152, v98
    v_lshl_add_u32 v98, v99, 7, v98

    buffer_load_dword v245, v98, s[64:67], 0 offen offset:384
    v_add_u32 v97, 2048, v96
    v_mul_lo_u32 v98, v97, s73
    v_lshrrev_b32 v98, 16, v98
    v_mul_u32_u24 v99, 5, v98
    v_sub_u32 v99, v97, v99
    v_mul_u32_u24 v98, 1152, v98
    v_lshl_add_u32 v98, v99, 7, v98

    buffer_load_dword v246, v98, s[68:71], s74 offen
    v_add_u32 v97, 2048, v100
    v_mul_lo_u32 v98, v97, s75
    v_lshrrev_b32 v98, 16, v98
    v_mul_u32_u24 v99, 6, v98
    v_sub_u32 v99, v97, v99
    v_mul_u32_u24 v98, 1152, v98
    v_lshl_add_u32 v98, v99, 7, v98

    buffer_load_dword v247, v98, s[64:67], 0 offen offset:384
    v_add_u32 v97, 4096, v96
    v_mul_lo_u32 v98, v97, s73
    v_lshrrev_b32 v98, 16, v98
    v_mul_u32_u24 v99, 5, v98
    v_sub_u32 v99, v97, v99
    v_mul_u32_u24 v98, 1152, v98
    v_lshl_add_u32 v98, v99, 7, v98

    buffer_load_dword v248, v98, s[68:71], s74 offen
    s_branch A_pfd
A_nopf:
    s_waitcnt vmcnt(1)
A_pfd:
    v_mul_u32_u24 v58, 136, v2
    v_add_u32 v58, s10, v58
    v_lshrrev_b32 v60, 5, v2
    v_lshl_add_u32 v60, v60, 2, v75
    v_mul_u32_u24 v59, 1088, v60
    v_and_b32 v61, 1, v74
    v_lshl_add_u32 v59, v61, 5, v59
    v_lshl_add_u32 v59, v76, 3, v59
    v_add_u32 v59, s10, v59

    v_mov_b32 v80, 0
    v_mov_b32 v81, 0
    v_mov_b32 v82, 0
    v_mov_b32 v83, 0
    v_mov_b32 v84, 0
    v_mov_b32 v85, 0
    v_mov_b32 v86, 0
    v_mov_b32 v87, 0
    v_mov_b32 v88, 0
    v_mov_b32 v89, 0
    v_mov_b32 v90, 0
    v_mov_b32 v91, 0
    v_mov_b32 v92, 0
    v_mov_b32 v93, 0
    v_mov_b32 v94, 0
    v_mov_b32 v95, 0
    s_waitcnt vmcnt(6)
    v_lshlrev_b32 v26, 16, v26
    v_mul_f32 v26, 0x3fb8aa3b, v26
    v_exp_f32 v26, v26
    v_lshlrev_b32 v62, 16, v22
    v_and_b32 v63, 0xffff0000, v22
    v_cvt_pk_bf16_f32 v26, v26, v26
    v_mul_f32 v62, 0x3fb8aa3b, v62
    v_mul_f32 v63, 0x3fb8aa3b, v63
    v_exp_f32 v62, v62
    v_exp_f32 v63, v63
    v_lshlrev_b32 v28, 16, v26
    v_lshlrev_b32 v27, 16, v27
    v_cvt_pk_bf16_f32 v62, v62, v63
    v_add_f32 v29, v28, v28
    v_lshlrev_b32 v30, 16, v62
    v_and_b32 v34, 0xffff0000, v62
    v_mul_f32 v30, v30, v28
    v_mul_f32 v34, v34, v28
    v_mul_f32 v30, 0xbfb8aa3b, v30
    v_mul_f32 v34, 0xbfb8aa3b, v34
    v_lshlrev_b32 v31, 16, v23
    v_and_b32 v35, 0xffff0000, v23
    v_mul_f32 v31, v31, v28
    v_mul_f32 v35, v35, v28
    v_mul_f32 v31, 0x3e22f983, v31
    v_mul_f32 v35, 0x3e22f983, v35
    v_lshlrev_b32 v32, 16, v24
    v_and_b32 v36, 0xffff0000, v24
    v_lshlrev_b32 v33, 16, v25
    v_and_b32 v37, 0xffff0000, v25
    v_mul_f32 v32, v32, v29
    v_mul_f32 v36, v36, v29
    v_mul_f32 v33, v33, v29
    v_mul_f32 v37, v37, v29
    v_xor_b32 v33, 0x80000000, v33
    v_xor_b32 v37, 0x80000000, v37
    s_mov_b32 s3, 2
    v_mov_b32 v68, 1.0
    v_mov_b32 v69, 0

A_pass:
A_u1_skip:
    v_exp_f32 v60, v30
    v_fract_f32 v61, v31
    v_cos_f32 v38, v61
    v_sin_f32 v39, v61
    v_mul_f32 v38, v38, v60
    v_mul_f32 v39, v39, v60
    v_xor_b32 v40, 0x80000000, v39
    v_mul_f32 v60, 0x41000000, v30
    v_mul_f32 v61, 0x41000000, v31
    v_exp_f32 v60, v60
    v_fract_f32 v61, v61
    v_cos_f32 v42, v61
    v_sin_f32 v43, v61
    v_mul_f32 v42, v42, v60
    v_mul_f32 v43, v43, v60
    v_xor_b32 v44, 0x80000000, v43
    v_mul_f32 v60, 0x43800000, v30
    v_mul_f32 v61, 0x43800000, v31
    v_exp_f32 v60, v60
    v_fract_f32 v61, v61
    v_cos_f32 v46, v61
    v_sin_f32 v47, v61
    v_mul_f32 v46, v46, v60
    v_mul_f32 v47, v47, v60
    v_xor_b32 v48, 0x80000000, v47
    v_pk_mul_f32 v[160:161], v[32:33], v[38:39] op_sel:[0,0] op_sel_hi:[1,0]
    v_pk_fma_f32 v[160:161], v[32:33], v[38:39], v[160:161] op_sel:[1,1,0] op_sel_hi:[0,1,1] neg_hi:[0,1,0]
    v_pk_mul_f32 v[162:163], v[160:161], v[38:39] op_sel:[0,0] op_sel_hi:[1,0]
    v_pk_fma_f32 v[162:163], v[160:161], v[38:39], v[162:163] op_sel:[1,1,0] op_sel_hi:[0,1,1] neg_hi:[0,1,0]
    v_pk_mul_f32 v[164:165], v[162:163], v[38:39] op_sel:[0,0] op_sel_hi:[1,0]
    v_pk_fma_f32 v[164:165], v[162:163], v[38:39], v[164:165] op_sel:[1,1,0] op_sel_hi:[0,1,1] neg_hi:[0,1,0]
    v_cvt_pk_bf16_f32 v50, v32, v160
    v_cvt_pk_bf16_f32 v51, v162, v164
    v_cvt_pk_bf16_f32 v52, v33, v161
    v_cvt_pk_bf16_f32 v53, v163, v165
    ds_write2_b64 v58, v[50:51], v[52:53] offset0:0 offset1:8
    v_pk_mul_f32 v[166:167], v[164:165], v[38:39] op_sel:[0,0] op_sel_hi:[1,0]
    v_pk_fma_f32 v[166:167], v[164:165], v[38:39], v[166:167] op_sel:[1,1,0] op_sel_hi:[0,1,1] neg_hi:[0,1,0]
    v_pk_mul_f32 v[168:169], v[166:167], v[38:39] op_sel:[0,0] op_sel_hi:[1,0]
    v_pk_fma_f32 v[168:169], v[166:167], v[38:39], v[168:169] op_sel:[1,1,0] op_sel_hi:[0,1,1] neg_hi:[0,1,0]
    v_pk_mul_f32 v[170:171], v[168:169], v[38:39] op_sel:[0,0] op_sel_hi:[1,0]
    v_pk_fma_f32 v[170:171], v[168:169], v[38:39], v[170:171] op_sel:[1,1,0] op_sel_hi:[0,1,1] neg_hi:[0,1,0]
    v_pk_mul_f32 v[172:173], v[170:171], v[38:39] op_sel:[0,0] op_sel_hi:[1,0]
    v_pk_fma_f32 v[172:173], v[170:171], v[38:39], v[172:173] op_sel:[1,1,0] op_sel_hi:[0,1,1] neg_hi:[0,1,0]
    v_cvt_pk_bf16_f32 v54, v166, v168
    v_cvt_pk_bf16_f32 v55, v170, v172
    v_cvt_pk_bf16_f32 v56, v167, v169
    v_cvt_pk_bf16_f32 v57, v171, v173
    ds_write2_b64 v58, v[54:55], v[56:57] offset0:1 offset1:9
    v_pk_mul_f32 v[174:175], v[32:33], v[42:43] op_sel:[0,0] op_sel_hi:[1,0]
    v_pk_fma_f32 v[174:175], v[32:33], v[42:43], v[174:175] op_sel:[1,1,0] op_sel_hi:[0,1,1] neg_hi:[0,1,0]
    v_pk_mul_f32 v[176:177], v[32:33], v[46:47] op_sel:[0,0] op_sel_hi:[1,0]
    v_pk_fma_f32 v[176:177], v[32:33], v[46:47], v[176:177] op_sel:[1,1,0] op_sel_hi:[0,1,1] neg_hi:[0,1,0]
    v_pk_mul_f32 v[178:179], v[162:163], v[46:47] op_sel:[0,0] op_sel_hi:[1,0]
    v_pk_fma_f32 v[178:179], v[162:163], v[46:47], v[178:179] op_sel:[1,1,0] op_sel_hi:[0,1,1] neg_hi:[0,1,0]
    v_pk_mul_f32 v[180:181], v[166:167], v[46:47] op_sel:[0,0] op_sel_hi:[1,0]
    v_pk_fma_f32 v[180:181], v[166:167], v[46:47], v[180:181] op_sel:[1,1,0] op_sel_hi:[0,1,1] neg_hi:[0,1,0]
    v_pk_mul_f32 v[182:183], v[170:171], v[46:47] op_sel:[0,0] op_sel_hi:[1,0]
    v_pk_fma_f32 v[182:183], v[170:171], v[46:47], v[182:183] op_sel:[1,1,0] op_sel_hi:[0,1,1] neg_hi:[0,1,0]
    v_pk_mul_f32 v[184:185], v[174:175], v[46:47] op_sel:[0,0] op_sel_hi:[1,0]
    v_pk_fma_f32 v[184:185], v[174:175], v[46:47], v[184:185] op_sel:[1,1,0] op_sel_hi:[0,1,1] neg_hi:[0,1,0]
    v_cvt_pk_bf16_f32 v50, v176, v178
    v_cvt_pk_bf16_f32 v51, v180, v180
    v_cvt_pk_bf16_f32 v52, v177, v179
    v_cvt_pk_bf16_f32 v53, v181, v181
    ds_write2_b64 v58, v[50:51], v[52:53] offset0:2 offset1:10
    v_cvt_pk_bf16_f32 v54, v180, v182
    v_cvt_pk_bf16_f32 v55, v184, v184
    v_cvt_pk_bf16_f32 v56, v181, v183
    v_cvt_pk_bf16_f32 v57, v185, v185
    ds_write2_b64 v58, v[54:55], v[56:57] offset0:3 offset1:11
    v_pk_mul_f32 v[186:187], v[176:177], v[46:47] op_sel:[0,0] op_sel_hi:[1,0]
    v_pk_fma_f32 v[186:187], v[176:177], v[46:47], v[186:187] op_sel:[1,1,0] op_sel_hi:[0,1,1] neg_hi:[0,1,0]
    v_pk_mul_f32 v[188:189], v[180:181], v[46:47] op_sel:[0,0] op_sel_hi:[1,0]
    v_pk_fma_f32 v[188:189], v[180:181], v[46:47], v[188:189] op_sel:[1,1,0] op_sel_hi:[0,1,1] neg_hi:[0,1,0]
    v_pk_mul_f32 v[190:191], v[184:185], v[46:47] op_sel:[0,0] op_sel_hi:[1,0]
    v_pk_fma_f32 v[190:191], v[184:185], v[46:47], v[190:191] op_sel:[1,1,0] op_sel_hi:[0,1,1] neg_hi:[0,1,0]
    v_cvt_pk_bf16_f32 v50, v186, v188
    v_cvt_pk_bf16_f32 v51, v190, v190
    v_cvt_pk_bf16_f32 v52, v187, v189
    v_cvt_pk_bf16_f32 v53, v191, v191
    ds_write2_b64 v58, v[50:51], v[52:53] offset0:4 offset1:12
    v_pk_mul_f32 v[192:193], v[186:187], v[46:47] op_sel:[0,0] op_sel_hi:[1,0]
    v_pk_fma_f32 v[192:193], v[186:187], v[46:47], v[192:193] op_sel:[1,1,0] op_sel_hi:[0,1,1] neg_hi:[0,1,0]
    v_pk_mul_f32 v[194:195], v[188:189], v[46:47] op_sel:[0,0] op_sel_hi:[1,0]
    v_pk_fma_f32 v[194:195], v[188:189], v[46:47], v[194:195] op_sel:[1,1,0] op_sel_hi:[0,1,1] neg_hi:[0,1,0]
    v_pk_mul_f32 v[196:197], v[190:191], v[46:47] op_sel:[0,0] op_sel_hi:[1,0]
    v_pk_fma_f32 v[196:197], v[190:191], v[46:47], v[196:197] op_sel:[1,1,0] op_sel_hi:[0,1,1] neg_hi:[0,1,0]
    v_cvt_pk_bf16_f32 v54, v192, v194
    v_cvt_pk_bf16_f32 v55, v196, v196
    v_cvt_pk_bf16_f32 v56, v193, v195
    v_cvt_pk_bf16_f32 v57, v197, v197
    ds_write2_b64 v58, v[54:55], v[56:57] offset0:5 offset1:13
    v_pk_mul_f32 v[198:199], v[192:193], v[46:47] op_sel:[0,0] op_sel_hi:[1,0]
    v_pk_fma_f32 v[198:199], v[192:193], v[46:47], v[198:199] op_sel:[1,1,0] op_sel_hi:[0,1,1] neg_hi:[0,1,0]
    v_pk_mul_f32 v[200:201], v[196:197], v[46:47] op_sel:[0,0] op_sel_hi:[1,0]
    v_pk_fma_f32 v[200:201], v[196:197], v[46:47], v[200:201] op_sel:[1,1,0] op_sel_hi:[0,1,1] neg_hi:[0,1,0]
    v_pk_mul_f32 v[202:203], v[198:199], v[46:47] op_sel:[0,0] op_sel_hi:[1,0]
    v_pk_fma_f32 v[202:203], v[198:199], v[46:47], v[202:203] op_sel:[1,1,0] op_sel_hi:[0,1,1] neg_hi:[0,1,0]
    v_pk_mul_f32 v[204:205], v[200:201], v[46:47] op_sel:[0,0] op_sel_hi:[1,0]
    v_pk_fma_f32 v[204:205], v[200:201], v[46:47], v[204:205] op_sel:[1,1,0] op_sel_hi:[0,1,1] neg_hi:[0,1,0]
    v_cvt_pk_bf16_f32 v50, v198, v200
    v_cvt_pk_bf16_f32 v51, v202, v204
    v_cvt_pk_bf16_f32 v52, v199, v201
    v_cvt_pk_bf16_f32 v53, v203, v205
    ds_write2_b64 v58, v[50:51], v[52:53] offset0:6 offset1:14
    v_pk_mul_f32 v[206:207], v[202:203], v[46:47] op_sel:[0,0] op_sel_hi:[1,0]
    v_pk_fma_f32 v[206:207], v[202:203], v[46:47], v[206:207] op_sel:[1,1,0] op_sel_hi:[0,1,1] neg_hi:[0,1,0]
    v_pk_mul_f32 v[208:209], v[204:205], v[46:47] op_sel:[0,0] op_sel_hi:[1,0]
    v_pk_fma_f32 v[208:209], v[204:205], v[46:47], v[208:209] op_sel:[1,1,0] op_sel_hi:[0,1,1] neg_hi:[0,1,0]
    v_pk_mul_f32 v[210:211], v[206:207], v[46:47] op_sel:[0,0] op_sel_hi:[1,0]
    v_pk_fma_f32 v[210:211], v[206:207], v[46:47], v[210:211] op_sel:[1,1,0] op_sel_hi:[0,1,1] neg_hi:[0,1,0]
    v_pk_mul_f32 v[212:213], v[208:209], v[46:47] op_sel:[0,0] op_sel_hi:[1,0]
    v_pk_fma_f32 v[212:213], v[208:209], v[46:47], v[212:213] op_sel:[1,1,0] op_sel_hi:[0,1,1] neg_hi:[0,1,0]
    v_cvt_pk_bf16_f32 v54, v206, v208
    v_cvt_pk_bf16_f32 v55, v210, v212
    v_cvt_pk_bf16_f32 v56, v207, v209
    v_cvt_pk_bf16_f32 v57, v211, v213
    ds_write2_b64 v58, v[54:55], v[56:57] offset0:7 offset1:15
    ds_read_b64_tr_b16 v[96:97], v59 offset:0
    ds_read_b64_tr_b16 v[98:99], v59 offset:64
    ds_read_b64_tr_b16 v[104:105], v59 offset:136
    ds_read_b64_tr_b16 v[106:107], v59 offset:200
    ds_read_b64_tr_b16 v[112:113], v59 offset:272
    ds_read_b64_tr_b16 v[114:115], v59 offset:336
    ds_read_b64_tr_b16 v[120:121], v59 offset:408
    ds_read_b64_tr_b16 v[122:123], v59 offset:472
    ds_read_b64_tr_b16 v[128:129], v59 offset:544
    ds_read_b64_tr_b16 v[130:131], v59 offset:608
    ds_read_b64_tr_b16 v[136:137], v59 offset:680
    ds_read_b64_tr_b16 v[138:139], v59 offset:744
    ds_read_b64_tr_b16 v[144:145], v59 offset:816
    ds_read_b64_tr_b16 v[146:147], v59 offset:880
    ds_read_b64_tr_b16 v[152:153], v59 offset:952
    ds_read_b64_tr_b16 v[154:155], v59 offset:1016
A_u2_skip:
    v_pk_mul_f32 v[228:229], v[42:43], v[42:43] op_sel:[0,0] op_sel_hi:[1,0]
    v_pk_fma_f32 v[228:229], v[42:43], v[42:43], v[228:229] op_sel:[1,1,0] op_sel_hi:[0,1,1] neg_lo:[0,1,0]
    v_pk_mul_f32 v[230:231], v[228:229], v[42:43] op_sel:[0,0] op_sel_hi:[1,0]
    v_pk_fma_f32 v[230:231], v[228:229], v[42:43], v[230:231] op_sel:[1,1,0] op_sel_hi:[0,1,1] neg_lo:[0,1,0]
    v_cvt_pk_bf16_f32 v50, v68, v42
    v_cvt_pk_bf16_f32 v51, v228, v230
    v_cvt_pk_bf16_f32 v52, v69, v43
    v_cvt_pk_bf16_f32 v53, v229, v231
    ds_write2_b64 v58, v[50:51], v[52:53] offset0:0 offset1:8
    v_pk_mul_f32 v[232:233], v[230:231], v[42:43] op_sel:[0,0] op_sel_hi:[1,0]
    v_pk_fma_f32 v[232:233], v[230:231], v[42:43], v[232:233] op_sel:[1,1,0] op_sel_hi:[0,1,1] neg_lo:[0,1,0]
    v_pk_mul_f32 v[234:235], v[232:233], v[42:43] op_sel:[0,0] op_sel_hi:[1,0]
    v_pk_fma_f32 v[234:235], v[232:233], v[42:43], v[234:235] op_sel:[1,1,0] op_sel_hi:[0,1,1] neg_lo:[0,1,0]
    v_pk_mul_f32 v[236:237], v[234:235], v[42:43] op_sel:[0,0] op_sel_hi:[1,0]
    v_pk_fma_f32 v[236:237], v[234:235], v[42:43], v[236:237] op_sel:[1,1,0] op_sel_hi:[0,1,1] neg_lo:[0,1,0]
    v_pk_mul_f32 v[238:239], v[236:237], v[42:43] op_sel:[0,0] op_sel_hi:[1,0]
    v_pk_fma_f32 v[238:239], v[236:237], v[42:43], v[238:239] op_sel:[1,1,0] op_sel_hi:[0,1,1] neg_lo:[0,1,0]
    v_cvt_pk_bf16_f32 v54, v232, v234
    v_cvt_pk_bf16_f32 v55, v236, v238
    v_cvt_pk_bf16_f32 v56, v233, v235
    v_cvt_pk_bf16_f32 v57, v237, v239
    ds_write2_b64 v58, v[54:55], v[56:57] offset0:1 offset1:9
    v_pk_mul_f32 v[224:225], v[238:239], v[42:43] op_sel:[0,0] op_sel_hi:[1,0]
    v_pk_fma_f32 v[224:225], v[238:239], v[42:43], v[224:225] op_sel:[1,1,0] op_sel_hi:[0,1,1] neg_lo:[0,1,0]
    v_pk_mul_f32 v[226:227], v[224:225], v[42:43] op_sel:[0,0] op_sel_hi:[1,0]
    v_pk_fma_f32 v[226:227], v[224:225], v[42:43], v[226:227] op_sel:[1,1,0] op_sel_hi:[0,1,1] neg_lo:[0,1,0]
    v_pk_mul_f32 v[228:229], v[226:227], v[42:43] op_sel:[0,0] op_sel_hi:[1,0]
    v_pk_fma_f32 v[228:229], v[226:227], v[42:43], v[228:229] op_sel:[1,1,0] op_sel_hi:[0,1,1] neg_lo:[0,1,0]
    v_pk_mul_f32 v[230:231], v[228:229], v[42:43] op_sel:[0,0] op_sel_hi:[1,0]
    v_pk_fma_f32 v[230:231], v[228:229], v[42:43], v[230:231] op_sel:[1,1,0] op_sel_hi:[0,1,1] neg_lo:[0,1,0]
    v_cvt_pk_bf16_f32 v50, v224, v226
    v_cvt_pk_bf16_f32 v51, v228, v230
    v_cvt_pk_bf16_f32 v52, v225, v227
    v_cvt_pk_bf16_f32 v53, v229, v231
    ds_write2_b64 v58, v[50:51], v[52:53] offset0:2 offset1:10
    v_pk_mul_f32 v[232:233], v[230:231], v[42:43] op_sel:[0,0] op_sel_hi:[1,0]
    v_pk_fma_f32 v[232:233], v[230:231], v[42:43], v[232:233] op_sel:[1,1,0] op_sel_hi:[0,1,1] neg_lo:[0,1,0]
    v_pk_mul_f32 v[234:235], v[232:233], v[42:43] op_sel:[0,0] op_sel_hi:[1,0]
    v_pk_fma_f32 v[234:235], v[232:233], v[42:43], v[234:235] op_sel:[1,1,0] op_sel_hi:[0,1,1] neg_lo:[0,1,0]
    v_pk_mul_f32 v[236:237], v[234:235], v[42:43] op_sel:[0,0] op_sel_hi:[1,0]
    v_pk_fma_f32 v[236:237], v[234:235], v[42:43], v[236:237] op_sel:[1,1,0] op_sel_hi:[0,1,1] neg_lo:[0,1,0]
    v_pk_mul_f32 v[238:239], v[236:237], v[42:43] op_sel:[0,0] op_sel_hi:[1,0]
    v_pk_fma_f32 v[238:239], v[236:237], v[42:43], v[238:239] op_sel:[1,1,0] op_sel_hi:[0,1,1] neg_lo:[0,1,0]
    v_cvt_pk_bf16_f32 v54, v232, v234
    v_cvt_pk_bf16_f32 v55, v236, v238
    v_cvt_pk_bf16_f32 v56, v233, v235
    v_cvt_pk_bf16_f32 v57, v237, v239
    ds_write2_b64 v58, v[54:55], v[56:57] offset0:3 offset1:11
    v_pk_mul_f32 v[224:225], v[238:239], v[42:43] op_sel:[0,0] op_sel_hi:[1,0]
    v_pk_fma_f32 v[224:225], v[238:239], v[42:43], v[224:225] op_sel:[1,1,0] op_sel_hi:[0,1,1] neg_lo:[0,1,0]
    v_pk_mul_f32 v[226:227], v[224:225], v[42:43] op_sel:[0,0] op_sel_hi:[1,0]
    v_pk_fma_f32 v[226:227], v[224:225], v[42:43], v[226:227] op_sel:[1,1,0] op_sel_hi:[0,1,1] neg_lo:[0,1,0]
    v_pk_mul_f32 v[228:229], v[226:227], v[42:43] op_sel:[0,0] op_sel_hi:[1,0]
    v_pk_fma_f32 v[228:229], v[226:227], v[42:43], v[228:229] op_sel:[1,1,0] op_sel_hi:[0,1,1] neg_lo:[0,1,0]
    v_pk_mul_f32 v[230:231], v[228:229], v[42:43] op_sel:[0,0] op_sel_hi:[1,0]
    v_pk_fma_f32 v[230:231], v[228:229], v[42:43], v[230:231] op_sel:[1,1,0] op_sel_hi:[0,1,1] neg_lo:[0,1,0]
    v_cvt_pk_bf16_f32 v50, v224, v226
    v_cvt_pk_bf16_f32 v51, v228, v230
    v_cvt_pk_bf16_f32 v52, v225, v227
    v_cvt_pk_bf16_f32 v53, v229, v231
    ds_write2_b64 v58, v[50:51], v[52:53] offset0:4 offset1:12
    v_pk_mul_f32 v[232:233], v[230:231], v[42:43] op_sel:[0,0] op_sel_hi:[1,0]
    v_pk_fma_f32 v[232:233], v[230:231], v[42:43], v[232:233] op_sel:[1,1,0] op_sel_hi:[0,1,1] neg_lo:[0,1,0]
    v_pk_mul_f32 v[234:235], v[232:233], v[42:43] op_sel:[0,0] op_sel_hi:[1,0]
    v_pk_fma_f32 v[234:235], v[232:233], v[42:43], v[234:235] op_sel:[1,1,0] op_sel_hi:[0,1,1] neg_lo:[0,1,0]
    v_pk_mul_f32 v[236:237], v[234:235], v[42:43] op_sel:[0,0] op_sel_hi:[1,0]
    v_pk_fma_f32 v[236:237], v[234:235], v[42:43], v[236:237] op_sel:[1,1,0] op_sel_hi:[0,1,1] neg_lo:[0,1,0]
    v_pk_mul_f32 v[238:239], v[236:237], v[42:43] op_sel:[0,0] op_sel_hi:[1,0]
    v_pk_fma_f32 v[238:239], v[236:237], v[42:43], v[238:239] op_sel:[1,1,0] op_sel_hi:[0,1,1] neg_lo:[0,1,0]
    v_cvt_pk_bf16_f32 v54, v232, v234
    v_cvt_pk_bf16_f32 v55, v236, v238
    v_cvt_pk_bf16_f32 v56, v233, v235
    v_cvt_pk_bf16_f32 v57, v237, v239
    ds_write2_b64 v58, v[54:55], v[56:57] offset0:5 offset1:13
    v_pk_mul_f32 v[224:225], v[238:239], v[42:43] op_sel:[0,0] op_sel_hi:[1,0]
    v_pk_fma_f32 v[224:225], v[238:239], v[42:43], v[224:225] op_sel:[1,1,0] op_sel_hi:[0,1,1] neg_lo:[0,1,0]
    v_pk_mul_f32 v[226:227], v[224:225], v[42:43] op_sel:[0,0] op_sel_hi:[1,0]
    v_pk_fma_f32 v[226:227], v[224:225], v[42:43], v[226:227] op_sel:[1,1,0] op_sel_hi:[0,1,1] neg_lo:[0,1,0]
    v_pk_mul_f32 v[228:229], v[226:227], v[42:43] op_sel:[0,0] op_sel_hi:[1,0]
    v_pk_fma_f32 v[228:229], v[226:227], v[42:43], v[228:229] op_sel:[1,1,0] op_sel_hi:[0,1,1] neg_lo:[0,1,0]
    v_pk_mul_f32 v[230:231], v[228:229], v[42:43] op_sel:[0,0] op_sel_hi:[1,0]
    v_pk_fma_f32 v[230:231], v[228:229], v[42:43], v[230:231] op_sel:[1,1,0] op_sel_hi:[0,1,1] neg_lo:[0,1,0]
    v_cvt_pk_bf16_f32 v50, v224, v226
    v_cvt_pk_bf16_f32 v51, v228, v230
    v_cvt_pk_bf16_f32 v52, v225, v227
    v_cvt_pk_bf16_f32 v53, v229, v231
    ds_write2_b64 v58, v[50:51], v[52:53] offset0:6 offset1:14
    v_pk_mul_f32 v[232:233], v[230:231], v[42:43] op_sel:[0,0] op_sel_hi:[1,0]
    v_pk_fma_f32 v[232:233], v[230:231], v[42:43], v[232:233] op_sel:[1,1,0] op_sel_hi:[0,1,1] neg_lo:[0,1,0]
    v_pk_mul_f32 v[234:235], v[232:233], v[42:43] op_sel:[0,0] op_sel_hi:[1,0]
    v_pk_fma_f32 v[234:235], v[232:233], v[42:43], v[234:235] op_sel:[1,1,0] op_sel_hi:[0,1,1] neg_lo:[0,1,0]
    v_pk_mul_f32 v[236:237], v[234:235], v[42:43] op_sel:[0,0] op_sel_hi:[1,0]
    v_pk_fma_f32 v[236:237], v[234:235], v[42:43], v[236:237] op_sel:[1,1,0] op_sel_hi:[0,1,1] neg_lo:[0,1,0]
    v_pk_mul_f32 v[238:239], v[236:237], v[42:43] op_sel:[0,0] op_sel_hi:[1,0]
    v_pk_fma_f32 v[238:239], v[236:237], v[42:43], v[238:239] op_sel:[1,1,0] op_sel_hi:[0,1,1] neg_lo:[0,1,0]
    v_cvt_pk_bf16_f32 v54, v232, v234
    v_cvt_pk_bf16_f32 v55, v236, v238
    v_cvt_pk_bf16_f32 v56, v233, v235
    v_cvt_pk_bf16_f32 v57, v237, v239
    ds_write2_b64 v58, v[54:55], v[56:57] offset0:7 offset1:15
    ds_read_b64_tr_b16 v[100:101], v59 offset:0
    ds_read_b64_tr_b16 v[102:103], v59 offset:64
    ds_read_b64_tr_b16 v[108:109], v59 offset:136
    ds_read_b64_tr_b16 v[110:111], v59 offset:200
    ds_read_b64_tr_b16 v[116:117], v59 offset:272
    ds_read_b64_tr_b16 v[118:119], v59 offset:336
    ds_read_b64_tr_b16 v[124:125], v59 offset:408
    ds_read_b64_tr_b16 v[126:127], v59 offset:472
    ds_read_b64_tr_b16 v[132:133], v59 offset:544
    ds_read_b64_tr_b16 v[134:135], v59 offset:608
    ds_read_b64_tr_b16 v[140:141], v59 offset:680
    ds_read_b64_tr_b16 v[142:143], v59 offset:744
    ds_read_b64_tr_b16 v[148:149], v59 offset:816
    ds_read_b64_tr_b16 v[150:151], v59 offset:880
    ds_read_b64_tr_b16 v[156:157], v59 offset:952
    ds_read_b64_tr_b16 v[158:159], v59 offset:1016
    v_mov_b32 v30, v34
    v_mov_b32 v31, v35
    v_mov_b32 v32, v36
    v_mov_b32 v33, v37
    s_waitcnt lgkmcnt(14)
    v_mfma_f32_32x32x16_bf16 v[80:95], v[96:99], v[100:103], v[80:95]
    s_waitcnt lgkmcnt(12)
    v_mfma_f32_32x32x16_bf16 v[80:95], v[104:107], v[108:111], v[80:95]
    s_waitcnt lgkmcnt(10)
    v_mfma_f32_32x32x16_bf16 v[80:95], v[112:115], v[116:119], v[80:95]
    s_waitcnt lgkmcnt(8)
    v_mfma_f32_32x32x16_bf16 v[80:95], v[120:123], v[124:127], v[80:95]
    s_waitcnt lgkmcnt(6)
    v_mfma_f32_32x32x16_bf16 v[80:95], v[128:131], v[132:135], v[80:95]
    s_waitcnt lgkmcnt(4)
    v_mfma_f32_32x32x16_bf16 v[80:95], v[136:139], v[140:143], v[80:95]
    s_waitcnt lgkmcnt(2)
    v_mfma_f32_32x32x16_bf16 v[80:95], v[144:147], v[148:151], v[80:95]
    s_waitcnt lgkmcnt(0)
    v_mfma_f32_32x32x16_bf16 v[80:95], v[152:155], v[156:159], v[80:95]
    s_sub_u32 s3, s3, 1
    s_cmp_lg_u32 s3, 0
    s_cbranch_scc1 A_pass

    s_cmp_ge_u32 s6, 4
    s_cbranch_scc1 A_ldd
    s_movk_i32 s60, 4608
    s_cmp_lg_u32 s61, 0
    s_cbranch_scc1 A_ld1
    buffer_load_dwordx4 v[4:7], v20, s[44:47], 0 offen offset:0
    buffer_load_dwordx4 v[8:11], v20, s[44:47], 0 offen offset:1152
    buffer_load_dwordx4 v[12:15], v20, s[44:47], 0 offen offset:2304
    buffer_load_dwordx4 v[16:19], v20, s[44:47], 0 offen offset:3456
    buffer_load_dwordx4 v[216:219], v20, s[44:47], s60 offen offset:0
    buffer_load_dwordx4 v[220:223], v20, s[44:47], s60 offen offset:1152
    buffer_load_dwordx4 v[244:247], v20, s[44:47], s60 offen offset:2304
    buffer_load_dwordx4 v[248:251], v20, s[44:47], s60 offen offset:3456
    s_branch A_ldd
A_ld1:
    s_cmp_lg_u32 s61, 1
    s_cbranch_scc1 A_ld2
    buffer_load_dwordx4 v[8:11], v20, s[44:47], 0 offen offset:1152
    buffer_load_dwordx4 v[12:15], v20, s[44:47], 0 offen offset:2304
    buffer_load_dwordx4 v[16:19], v20, s[44:47], 0 offen offset:3456
    buffer_load_dwordx4 v[216:219], v20, s[44:47], s60 offen offset:0
    buffer_load_dwordx4 v[220:223], v20, s[44:47], s60 offen offset:1152
    buffer_load_dwordx4 v[244:247], v20, s[44:47], s60 offen offset:2304
    buffer_load_dwordx4 v[248:251], v20, s[44:47], s60 offen offset:3456
    buffer_load_dwordx4 v[4:7], v20, s[44:47], 0 offen offset:0
    s_branch A_ldd
A_ld2:
    s_cmp_lg_u32 s61, 2
    s_cbranch_scc1 A_ld3
    buffer_load_dwordx4 v[12:15], v20, s[44:47], 0 offen offset:2304
    buffer_load_dwordx4 v[16:19], v20, s[44:47], 0 offen offset:3456
    buffer_load_dwordx4 v[216:219], v20, s[44:47], s60 offen offset:0
    buffer_load_dwordx4 v[220:223], v20, s[44:47], s60 offen offset:1152
    buffer_load_dwordx4 v[244:247], v20, s[44:47], s60 offen offset:2304
    buffer_load_dwordx4 v[248:251], v20, s[44:47], s60 offen offset:3456
    buffer_load_dwordx4 v[4:7], v20, s[44:47], 0 offen offset:0
    buffer_load_dwordx4 v[8:11], v20, s[44:47], 0 offen offset:1152
    s_branch A_ldd
A_ld3:
    s_cmp_lg_u32 s61, 3
    s_cbranch_scc1 A_ld4
    buffer_load_dwordx4 v[16:19], v20, s[44:47], 0 offen offset:3456
    buffer_load_dwordx4 v[216:219], v20, s[44:47], s60 offen offset:0
    buffer_load_dwordx4 v[220:223], v20, s[44:47], s60 offen offset:1152
    buffer_load_dwordx4 v[244:247], v20, s[44:47], s60 offen offset:2304
    buffer_load_dwordx4 v[248:251], v20, s[44:47], s60 offen offset:3456
    buffer_load_dwordx4 v[4:7], v20, s[44:47], 0 offen offset:0
    buffer_load_dwordx4 v[8:11], v20, s[44:47], 0 offen offset:1152
    buffer_load_dwordx4 v[12:15], v20, s[44:47], 0 offen offset:2304
    s_branch A_ldd
A_ld4:
    s_cmp_lg_u32 s61, 4
    s_cbranch_scc1 A_ld5
    buffer_load_dwordx4 v[216:219], v20, s[44:47], s60 offen offset:0
    buffer_load_dwordx4 v[220:223], v20, s[44:47], s60 offen offset:1152
    buffer_load_dwordx4 v[244:247], v20, s[44:47], s60 offen offset:2304
    buffer_load_dwordx4 v[248:251], v20, s[44:47], s60 offen offset:3456
    buffer_load_dwordx4 v[4:7], v20, s[44:47], 0 offen offset:0
    buffer_load_dwordx4 v[8:11], v20, s[44:47], 0 offen offset:1152
    buffer_load_dwordx4 v[12:15], v20, s[44:47], 0 offen offset:2304
    buffer_load_dwordx4 v[16:19], v20, s[44:47], 0 offen offset:3456
    s_branch A_ldd
A_ld5:
    s_cmp_lg_u32 s61, 5
    s_cbranch_scc1 A_ld6
    buffer_load_dwordx4 v[220:223], v20, s[44:47], s60 offen offset:1152
    buffer_load_dwordx4 v[244:247], v20, s[44:47], s60 offen offset:2304
    buffer_load_dwordx4 v[248:251], v20, s[44:47], s60 offen offset:3456
    buffer_load_dwordx4 v[4:7], v20, s[44:47], 0 offen offset:0
    buffer_load_dwordx4 v[8:11], v20, s[44:47], 0 offen offset:1152
    buffer_load_dwordx4 v[12:15], v20, s[44:47], 0 offen offset:2304
    buffer_load_dwordx4 v[16:19], v20, s[44:47], 0 offen offset:3456
    buffer_load_dwordx4 v[216:219], v20, s[44:47], s60 offen offset:0
    s_branch A_ldd
A_ld6:
    s_cmp_lg_u32 s61, 6
    s_cbranch_scc1 A_ld7
    buffer_load_dwordx4 v[244:247], v20, s[44:47], s60 offen offset:2304
    buffer_load_dwordx4 v[248:251], v20, s[44:47], s60 offen offset:3456
    buffer_load_dwordx4 v[4:7], v20, s[44:47], 0 offen offset:0
    buffer_load_dwordx4 v[8:11], v20, s[44:47], 0 offen offset:1152
    buffer_load_dwordx4 v[12:15], v20, s[44:47], 0 offen offset:2304
    buffer_load_dwordx4 v[16:19], v20, s[44:47], 0 offen offset:3456
    buffer_load_dwordx4 v[216:219], v20, s[44:47], s60 offen offset:0
    buffer_load_dwordx4 v[220:223], v20, s[44:47], s60 offen offset:1152
    s_branch A_ldd
A_ld7:
    buffer_load_dwordx4 v[248:251], v20, s[44:47], s60 offen offset:3456
    buffer_load_dwordx4 v[4:7], v20, s[44:47], 0 offen offset:0
    buffer_load_dwordx4 v[8:11], v20, s[44:47], 0 offen offset:1152
    buffer_load_dwordx4 v[12:15], v20, s[44:47], 0 offen offset:2304
    buffer_load_dwordx4 v[16:19], v20, s[44:47], 0 offen offset:3456
    buffer_load_dwordx4 v[216:219], v20, s[44:47], s60 offen offset:0
    buffer_load_dwordx4 v[220:223], v20, s[44:47], s60 offen offset:1152
    buffer_load_dwordx4 v[244:247], v20, s[44:47], s60 offen offset:2304
A_ldd:
    v_and_b32 v60, 31, v2
    v_lshrrev_b32 v61, 5, v2
    v_lshlrev_b32 v62, 4, v60
    v_sub_u32 v62, s10, v62
    v_lshlrev_b32 v63, 3, v61
    v_sub_u32 v64, v62, v63
    v_add_u32 v64, 3576, v64
    v_lshlrev_b32 v63, 9, v61
    v_sub_u32 v65, v62, v63
    v_sub_u32 v66, v65, v63
    v_add_u32 v65, 3056, v65
    v_add_u32 v66, 1520, v66
    v_add_u32 v67, 4228, v64
    v_add_u32 v68, 4228, v65
    v_add_u32 v69, 4228, v66
    v_cmp_eq_u32 vcc, 0, v2
    s_nop 1
    v_cndmask_b32 v27, 0, v27, vcc
    v_and_b32 v60, 1, v2
    v_cmp_eq_u32 vcc, 0, v60
    v_lshlrev_b32 v70, 3, v0
    v_add_u32 v71, 71680, v70
    v_add_f32 v80, v80, v27
    v_cndmask_b32 v30, v93, v92, vcc
    v_cndmask_b32 v31, v95, v94, vcc
    v_cvt_pk_bf16_f32 v96, v83, v82
    v_cvt_pk_bf16_f32 v97, v81, v80
    v_cvt_pk_bf16_f32 v98, v86, v85
    v_cvt_pk_bf16_f32 v99, v84, v84
    v_cvt_pk_bf16_f32 v100, v90, v90
    v_cvt_pk_bf16_f32 v101, v89, v89
    v_cvt_pk_bf16_f32 v102, v89, v88
    v_cvt_pk_bf16_f32 v103, v88, v88
    v_cvt_pk_bf16_f32 v104, v93, v93
    v_cvt_pk_bf16_f32 v105, v93, v30
    v_cvt_pk_bf16_f32 v106, v92, v92
    v_cvt_pk_bf16_f32 v107, v92, v92
    v_cvt_pk_bf16_f32 v108, v95, v95
    v_cvt_pk_bf16_f32 v109, v95, v31
    v_cvt_pk_bf16_f32 v110, v94, v94
    v_cvt_pk_bf16_f32 v111, v94, v94
    ds_write_b64 v64, v[96:97] offset:512
    ds_write_b64 v64, v[98:99]
    ds_write_b128 v65, v[100:103]
    ds_write_b128 v66, v[104:107] offset:512
    ds_write_b128 v66, v[108:111]
    ds_write2_b32 v67, v96, v97 offset0:128 offset1:129
    ds_write2_b32 v67, v98, v99 offset0:0 offset1:1
    ds_write2_b32 v68, v100, v101 offset0:0 offset1:1
    ds_write2_b32 v68, v102, v103 offset0:2 offset1:3
    ds_write2_b32 v69, v104, v105 offset0:128 offset1:129
    ds_write2_b32 v69, v106, v107 offset0:130 offset1:131
    ds_write2_b32 v69, v108, v109 offset0:0 offset1:1
    ds_write2_b32 v69, v110, v111 offset0:2 offset1:3
    v_mov_b32 v32, 0
    v_lshl_add_u32 v58, v2, 2, s10
    s_mov_b64 exec, 0xffff
    ds_write_b32 v58, v32 offset:4096
    ds_write_b32 v58, v32 offset:8324
    s_mov_b64 exec, -1

    s_cmp_ge_u32 s6, 4
    s_cbranch_scc1 A_nou
    v_lshlrev_b32 v72, 4, v0
    v_add_u32 v72, 9152, v72
    v_add_u32 v73, 53760, v72
    v_add_u32 v60, 107520, v72
    s_waitcnt vmcnt(0)
    v_mov_b32_dpp v240, v248 wave_shr:1 row_mask:0xf bank_mask:0xf
    v_mov_b32_dpp v241, v249 wave_shr:1 row_mask:0xf bank_mask:0xf
    v_mov_b32_dpp v242, v250 wave_shr:1 row_mask:0xf bank_mask:0xf
    v_mov_b32_dpp v243, v251 wave_shr:1 row_mask:0xf bank_mask:0xf
    v_perm_b32 v112, v8, v4, s14
    v_perm_b32 v116, v4, v240, s14
    v_perm_b32 v113, v16, v12, s14
    v_perm_b32 v117, v12, v8, s14
    v_perm_b32 v114, v220, v216, s14
    v_perm_b32 v118, v216, v16, s14
    v_perm_b32 v115, v248, v244, s14
    v_perm_b32 v119, v244, v220, s14
    ds_write_b128 v72, v[112:115] offset:0
    ds_write_b128 v72, v[116:119] offset:4576
    v_perm_b32 v120, v8, v4, s15
    v_perm_b32 v124, v4, v240, s15
    v_perm_b32 v121, v16, v12, s15
    v_perm_b32 v125, v12, v8, s15
    v_perm_b32 v122, v220, v216, s15
    v_perm_b32 v126, v216, v16, s15
    v_perm_b32 v123, v248, v244, s15
    v_perm_b32 v127, v244, v220, s15
    ds_write_b128 v72, v[120:123] offset:17920
    ds_write_b128 v72, v[124:127] offset:22496
    v_perm_b32 v128, v9, v5, s14
    v_perm_b32 v132, v5, v241, s14
    v_perm_b32 v129, v17, v13, s14
    v_perm_b32 v133, v13, v9, s14
    v_perm_b32 v130, v221, v217, s14
    v_perm_b32 v134, v217, v17, s14
    v_perm_b32 v131, v249, v245, s14
    v_perm_b32 v135, v245, v221, s14
    ds_write_b128 v72, v[128:131] offset:35840
    ds_write_b128 v72, v[132:135] offset:40416
    v_perm_b32 v136, v9, v5, s15
    v_perm_b32 v140, v5, v241, s15
    v_perm_b32 v137, v17, v13, s15
    v_perm_b32 v141, v13, v9, s15
    v_perm_b32 v138, v221, v217, s15
    v_perm_b32 v142, v217, v17, s15
    v_perm_b32 v139, v249, v245, s15
    v_perm_b32 v143, v245, v221, s15
    ds_write_b128 v73, v[136:139] offset:0
    ds_write_b128 v73, v[140:143] offset:4576
    v_perm_b32 v144, v10, v6, s14
    v_perm_b32 v148, v6, v242, s14
    v_perm_b32 v145, v18, v14, s14
    v_perm_b32 v149, v14, v10, s14
    v_perm_b32 v146, v222, v218, s14
    v_perm_b32 v150, v218, v18, s14
    v_perm_b32 v147, v250, v246, s14
    v_perm_b32 v151, v246, v222, s14
    ds_write_b128 v73, v[144:147] offset:17920
    ds_write_b128 v73, v[148:151] offset:22496
    v_perm_b32 v152, v10, v6, s15
    v_perm_b32 v156, v6, v242, s15
    v_perm_b32 v153, v18, v14, s15
    v_perm_b32 v157, v14, v10, s15
    v_perm_b32 v154, v222, v218, s15
    v_perm_b32 v158, v218, v18, s15
    v_perm_b32 v155, v250, v246, s15
    v_perm_b32 v159, v246, v222, s15
    ds_write_b128 v73, v[152:155] offset:35840
    ds_write_b128 v73, v[156:159] offset:40416
    v_perm_b32 v160, v11, v7, s14
    v_perm_b32 v164, v7, v243, s14
    v_perm_b32 v161, v19, v15, s14
    v_perm_b32 v165, v15, v11, s14
    v_perm_b32 v162, v223, v219, s14
    v_perm_b32 v166, v219, v19, s14
    v_perm_b32 v163, v251, v247, s14
    v_perm_b32 v167, v247, v223, s14
    ds_write_b128 v60, v[160:163] offset:0
    ds_write_b128 v60, v[164:167] offset:4576
    v_perm_b32 v168, v11, v7, s15
    v_perm_b32 v172, v7, v243, s15
    v_perm_b32 v169, v19, v15, s15
    v_perm_b32 v173, v15, v11, s15
    v_perm_b32 v170, v223, v219, s15
    v_perm_b32 v174, v219, v19, s15
    v_perm_b32 v171, v251, v247, s15
    v_perm_b32 v175, v247, v223, s15
    ds_write_b128 v60, v[168:171] offset:17920
    ds_write_b128 v60, v[172:175] offset:22496
A_nou:
    s_waitcnt vmcnt(0)
    v_and_b32 v60, 15, v2
    v_lshrrev_b32 v61, 4, v2
    v_lshlrev_b32 v61, 4, v61
    v_add_u32 v61, s10, v61
    v_lshrrev_b32 v62, 1, v60
    v_lshl_add_u32 v72, v62, 6, v61
    v_mov_b32 v63, 9152
    v_mov_b32 v64, 13728
    v_cndmask_b32 v63, v63, v64, vcc
    v_add_u32 v72, v72, v63
    v_lshlrev_b32 v62, 2, v60
    v_sub_u32 v73, v61, v62
    v_mov_b32 v63, 508
    v_mov_b32 v64, 4736
    v_cndmask_b32 v63, v63, v64, vcc
    v_add_u32 v73, v73, v63

    v_mov_b32 v224, 0
    v_mov_b32 v225, 0
    v_mov_b32 v226, 0
    v_mov_b32 v227, 0
    v_mov_b32 v228, 0
    v_mov_b32 v229, 0
    v_mov_b32 v230, 0
    v_mov_b32 v231, 0
    v_mov_b32 v232, 0
    v_mov_b32 v233, 0
    v_mov_b32 v234, 0
    v_mov_b32 v235, 0
    v_mov_b32 v236, 0
    v_mov_b32 v237, 0
    v_mov_b32 v238, 0
    v_mov_b32 v239, 0
    v_mov_b32 v240, 0
    v_mov_b32 v241, 0
    v_mov_b32 v242, 0
    v_mov_b32 v243, 0
    v_mov_b32 v244, 0
    v_mov_b32 v245, 0
    v_mov_b32 v246, 0
    v_mov_b32 v247, 0
    v_mov_b32 v248, 0
    v_mov_b32 v249, 0
    v_mov_b32 v250, 0
    v_mov_b32 v251, 0
    v_mov_b32 v252, 0
    v_mov_b32 v253, 0
    v_mov_b32 v254, 0
    v_mov_b32 v255, 0
    s_waitcnt lgkmcnt(0)
    s_barrier
    ds_read_b128 v[96:99], v72 offset:0
    ds_read_b64 v[128:129], v73 offset:3584
    ds_read_b64 v[130:131], v73 offset:3592
    ds_read_b128 v[100:103], v72 offset:512
    ds_read_b64 v[132:133], v73 offset:3072
    ds_read_b64 v[134:135], v73 offset:3080
    ds_read_b128 v[104:107], v72 offset:1024
    ds_read_b64 v[136:137], v73 offset:2560
    ds_read_b64 v[138:139], v73 offset:2568
    ds_read_b128 v[108:111], v72 offset:1536
    ds_read_b64 v[140:141], v73 offset:2048
    ds_read_b64 v[142:143], v73 offset:2056
    s_waitcnt lgkmcnt(4)
    ds_read_b128 v[112:115], v72 offset:2048
    ds_read_b64 v[144:145], v73 offset:1536
    ds_read_b64 v[146:147], v73 offset:1544
    ds_read_b128 v[116:119], v72 offset:2560
    ds_read_b64 v[148:149], v73 offset:1024
    ds_read_b64 v[150:151], v73 offset:1032
    ds_read_b128 v[120:123], v72 offset:3072
    ds_read_b64 v[152:153], v73 offset:512
    ds_read_b64 v[154:155], v73 offset:520
    ds_read_b128 v[124:127], v72 offset:3584
    ds_read_b64 v[156:157], v73 offset:0
    ds_read_b64 v[158:159], v73 offset:8
    s_mov_b32 s3, 4
A_conv:
    v_subrev_u32 v72, 64, v72
    v_subrev_u32 v73, 64, v73
    s_waitcnt lgkmcnt(0)
    v_mfma_f32_16x16x32_bf16 v[224:227], v[96:99], v[128:131], v[224:227]
    ds_read_b128 v[160:163], v72 offset:0
    v_mfma_f32_16x16x32_bf16 v[228:231], v[100:103], v[128:131], v[228:231]
    ds_read_b64 v[192:193], v73 offset:3584
    v_mfma_f32_16x16x32_bf16 v[232:235], v[104:107], v[128:131], v[232:235]
    ds_read_b64 v[194:195], v73 offset:3592
    v_mfma_f32_16x16x32_bf16 v[236:239], v[108:111], v[128:131], v[236:239]
    ds_read_b128 v[164:167], v72 offset:512
    v_mfma_f32_16x16x32_bf16 v[240:243], v[112:115], v[128:131], v[240:243]
    ds_read_b64 v[196:197], v73 offset:3072
    v_mfma_f32_16x16x32_bf16 v[244:247], v[116:119], v[128:131], v[244:247]
    ds_read_b64 v[198:199], v73 offset:3080
    v_mfma_f32_16x16x32_bf16 v[248:251], v[120:123], v[128:131], v[248:251]
    ds_read_b128 v[168:171], v72 offset:1024
    v_mfma_f32_16x16x32_bf16 v[252:255], v[124:127], v[128:131], v[252:255]
    ds_read_b64 v[200:201], v73 offset:2560
    v_mfma_f32_16x16x32_bf16 v[228:231], v[96:99], v[132:135], v[228:231]
    ds_read_b64 v[202:203], v73 offset:2568
    v_mfma_f32_16x16x32_bf16 v[232:235], v[100:103], v[132:135], v[232:235]
    ds_read_b128 v[172:175], v72 offset:1536
    v_mfma_f32_16x16x32_bf16 v[236:239], v[104:107], v[132:135], v[236:239]
    ds_read_b64 v[204:205], v73 offset:2048
    v_mfma_f32_16x16x32_bf16 v[240:243], v[108:111], v[132:135], v[240:243]
    ds_read_b64 v[206:207], v73 offset:2056
    v_mfma_f32_16x16x32_bf16 v[244:247], v[112:115], v[132:135], v[244:247]
    ds_read_b128 v[176:179], v72 offset:2048
    v_mfma_f32_16x16x32_bf16 v[248:251], v[116:119], v[132:135], v[248:251]
    ds_read_b64 v[208:209], v73 offset:1536
    v_mfma_f32_16x16x32_bf16 v[252:255], v[120:123], v[132:135], v[252:255]
    ds_read_b64 v[210:211], v73 offset:1544
    v_mfma_f32_16x16x32_bf16 v[232:235], v[96:99], v[136:139], v[232:235]
    ds_read_b128 v[180:183], v72 offset:2560
    v_mfma_f32_16x16x32_bf16 v[236:239], v[100:103], v[136:139], v[236:239]
    ds_read_b64 v[212:213], v73 offset:1024
    v_mfma_f32_16x16x32_bf16 v[240:243], v[104:107], v[136:139], v[240:243]
    ds_read_b64 v[214:215], v73 offset:1032
    v_mfma_f32_16x16x32_bf16 v[244:247], v[108:111], v[136:139], v[244:247]
    ds_read_b128 v[184:187], v72 offset:3072
    v_mfma_f32_16x16x32_bf16 v[248:251], v[112:115], v[136:139], v[248:251]
    ds_read_b64 v[216:217], v73 offset:512
    v_mfma_f32_16x16x32_bf16 v[252:255], v[116:119], v[136:139], v[252:255]
    ds_read_b64 v[218:219], v73 offset:520
    v_mfma_f32_16x16x32_bf16 v[236:239], v[96:99], v[140:143], v[236:239]
    ds_read_b128 v[188:191], v72 offset:3584
    v_mfma_f32_16x16x32_bf16 v[240:243], v[100:103], v[140:143], v[240:243]
    ds_read_b64 v[220:221], v73 offset:0
    v_mfma_f32_16x16x32_bf16 v[244:247], v[104:107], v[140:143], v[244:247]
    ds_read_b64 v[222:223], v73 offset:8
    v_mfma_f32_16x16x32_bf16 v[248:251], v[108:111], v[140:143], v[248:251]
    v_mfma_f32_16x16x32_bf16 v[252:255], v[112:115], v[140:143], v[252:255]
    v_mfma_f32_16x16x32_bf16 v[240:243], v[96:99], v[144:147], v[240:243]
    v_mfma_f32_16x16x32_bf16 v[244:247], v[100:103], v[144:147], v[244:247]
    v_mfma_f32_16x16x32_bf16 v[248:251], v[104:107], v[144:147], v[248:251]
    v_mfma_f32_16x16x32_bf16 v[252:255], v[108:111], v[144:147], v[252:255]
    v_mfma_f32_16x16x32_bf16 v[244:247], v[96:99], v[148:151], v[244:247]
    v_mfma_f32_16x16x32_bf16 v[248:251], v[100:103], v[148:151], v[248:251]
    v_mfma_f32_16x16x32_bf16 v[252:255], v[104:107], v[148:151], v[252:255]
    v_mfma_f32_16x16x32_bf16 v[248:251], v[96:99], v[152:155], v[248:251]
    v_mfma_f32_16x16x32_bf16 v[252:255], v[100:103], v[152:155], v[252:255]
    v_mfma_f32_16x16x32_bf16 v[252:255], v[96:99], v[156:159], v[252:255]
    v_subrev_u32 v72, 64, v72
    v_subrev_u32 v73, 64, v73
    s_waitcnt lgkmcnt(0)
    v_mfma_f32_16x16x32_bf16 v[224:227], v[160:163], v[192:195], v[224:227]
    ds_read_b128 v[96:99], v72 offset:0
    v_mfma_f32_16x16x32_bf16 v[228:231], v[164:167], v[192:195], v[228:231]
    ds_read_b64 v[128:129], v73 offset:3584
    v_mfma_f32_16x16x32_bf16 v[232:235], v[168:171], v[192:195], v[232:235]
    ds_read_b64 v[130:131], v73 offset:3592
    v_mfma_f32_16x16x32_bf16 v[236:239], v[172:175], v[192:195], v[236:239]
    ds_read_b128 v[100:103], v72 offset:512
    v_mfma_f32_16x16x32_bf16 v[240:243], v[176:179], v[192:195], v[240:243]
    ds_read_b64 v[132:133], v73 offset:3072
    v_mfma_f32_16x16x32_bf16 v[244:247], v[180:183], v[192:195], v[244:247]
    ds_read_b64 v[134:135], v73 offset:3080
    v_mfma_f32_16x16x32_bf16 v[248:251], v[184:187], v[192:195], v[248:251]
    ds_read_b128 v[104:107], v72 offset:1024
    v_mfma_f32_16x16x32_bf16 v[252:255], v[188:191], v[192:195], v[252:255]
    ds_read_b64 v[136:137], v73 offset:2560
    v_mfma_f32_16x16x32_bf16 v[228:231], v[160:163], v[196:199], v[228:231]
    ds_read_b64 v[138:139], v73 offset:2568
    v_mfma_f32_16x16x32_bf16 v[232:235], v[164:167], v[196:199], v[232:235]
    ds_read_b128 v[108:111], v72 offset:1536
    v_mfma_f32_16x16x32_bf16 v[236:239], v[168:171], v[196:199], v[236:239]
    ds_read_b64 v[140:141], v73 offset:2048
    v_mfma_f32_16x16x32_bf16 v[240:243], v[172:175], v[196:199], v[240:243]
    ds_read_b64 v[142:143], v73 offset:2056
    v_mfma_f32_16x16x32_bf16 v[244:247], v[176:179], v[196:199], v[244:247]
    ds_read_b128 v[112:115], v72 offset:2048
    v_mfma_f32_16x16x32_bf16 v[248:251], v[180:183], v[196:199], v[248:251]
    ds_read_b64 v[144:145], v73 offset:1536
    v_mfma_f32_16x16x32_bf16 v[252:255], v[184:187], v[196:199], v[252:255]
    ds_read_b64 v[146:147], v73 offset:1544
    v_mfma_f32_16x16x32_bf16 v[232:235], v[160:163], v[200:203], v[232:235]
    ds_read_b128 v[116:119], v72 offset:2560
    v_mfma_f32_16x16x32_bf16 v[236:239], v[164:167], v[200:203], v[236:239]
    ds_read_b64 v[148:149], v73 offset:1024
    v_mfma_f32_16x16x32_bf16 v[240:243], v[168:171], v[200:203], v[240:243]
    ds_read_b64 v[150:151], v73 offset:1032
    v_mfma_f32_16x16x32_bf16 v[244:247], v[172:175], v[200:203], v[244:247]
    ds_read_b128 v[120:123], v72 offset:3072
    v_mfma_f32_16x16x32_bf16 v[248:251], v[176:179], v[200:203], v[248:251]
    ds_read_b64 v[152:153], v73 offset:512
    v_mfma_f32_16x16x32_bf16 v[252:255], v[180:183], v[200:203], v[252:255]
    ds_read_b64 v[154:155], v73 offset:520
    v_mfma_f32_16x16x32_bf16 v[236:239], v[160:163], v[204:207], v[236:239]
    ds_read_b128 v[124:127], v72 offset:3584
    v_mfma_f32_16x16x32_bf16 v[240:243], v[164:167], v[204:207], v[240:243]
    ds_read_b64 v[156:157], v73 offset:0
    v_mfma_f32_16x16x32_bf16 v[244:247], v[168:171], v[204:207], v[244:247]
    ds_read_b64 v[158:159], v73 offset:8
    v_mfma_f32_16x16x32_bf16 v[248:251], v[172:175], v[204:207], v[248:251]
    v_mfma_f32_16x16x32_bf16 v[252:255], v[176:179], v[204:207], v[252:255]
    v_mfma_f32_16x16x32_bf16 v[240:243], v[160:163], v[208:211], v[240:243]
    v_mfma_f32_16x16x32_bf16 v[244:247], v[164:167], v[208:211], v[244:247]
    v_mfma_f32_16x16x32_bf16 v[248:251], v[168:171], v[208:211], v[248:251]
    v_mfma_f32_16x16x32_bf16 v[252:255], v[172:175], v[208:211], v[252:255]
    v_mfma_f32_16x16x32_bf16 v[244:247], v[160:163], v[212:215], v[244:247]
    v_mfma_f32_16x16x32_bf16 v[248:251], v[164:167], v[212:215], v[248:251]
    v_mfma_f32_16x16x32_bf16 v[252:255], v[168:171], v[212:215], v[252:255]
    v_mfma_f32_16x16x32_bf16 v[248:251], v[160:163], v[216:219], v[248:251]
    v_mfma_f32_16x16x32_bf16 v[252:255], v[164:167], v[216:219], v[252:255]
    v_mfma_f32_16x16x32_bf16 v[252:255], v[160:163], v[220:223], v[252:255]
    s_sub_u32 s3, s3, 1
    s_cmp_lg_u32 s3, 0
    s_cbranch_scc1 A_conv

    v_lshlrev_b32 v61, 7, v74
    v_lshl_add_u32 v61, v77, 2, v61
    v_add_u32 v61, s10, v61
    v_mul_u32_u24 v29, 9216, v0
    v_add_u32 v29, s11, v29
    s_movk_i32 s64, 4608
    s_waitcnt lgkmcnt(0)

    v_cvt_pk_bf16_f32 v96, v224, v225
    v_cvt_pk_bf16_f32 v97, v226, v227
    ds_write_b32 v61, v96 offset:0
    ds_write_b32 v61, v97 offset:64
    v_cvt_pk_bf16_f32 v98, v228, v229
    v_cvt_pk_bf16_f32 v99, v230, v231
    ds_write_b32 v61, v98 offset:512
    ds_write_b32 v61, v99 offset:576
    v_cvt_pk_bf16_f32 v100, v232, v233
    v_cvt_pk_bf16_f32 v101, v234, v235
    ds_write_b32 v61, v100 offset:1024
    ds_write_b32 v61, v101 offset:1088
    v_cvt_pk_bf16_f32 v102, v236, v237
    v_cvt_pk_bf16_f32 v103, v238, v239
    ds_write_b32 v61, v102 offset:1536
    ds_write_b32 v61, v103 offset:1600
    v_cvt_pk_bf16_f32 v104, v240, v241
    v_cvt_pk_bf16_f32 v105, v242, v243
    ds_write_b32 v61, v104 offset:2048
    ds_write_b32 v61, v105 offset:2112
    v_cvt_pk_bf16_f32 v106, v244, v245
    v_cvt_pk_bf16_f32 v107, v246, v247
    ds_write_b32 v61, v106 offset:2560
    ds_write_b32 v61, v107 offset:2624
    v_cvt_pk_bf16_f32 v108, v248, v249
    v_cvt_pk_bf16_f32 v109, v250, v251
    ds_write_b32 v61, v108 offset:3072
    ds_write_b32 v61, v109 offset:3136
    v_cvt_pk_bf16_f32 v110, v252, v253
    v_cvt_pk_bf16_f32 v111, v254, v255
    ds_write_b32 v61, v110 offset:3584
    ds_write_b32 v61, v111 offset:3648
    s_waitcnt lgkmcnt(0)
    s_barrier
    ds_read_b64 v[112:113], v70 offset:0
    ds_read_b64 v[114:115], v70 offset:17920
    ds_read_b64 v[116:117], v70 offset:35840
    ds_read_b64 v[118:119], v70 offset:53760
    ds_read_b64 v[120:121], v71 offset:0
    ds_read_b64 v[122:123], v71 offset:17920
    ds_read_b64 v[124:125], v71 offset:35840
    ds_read_b64 v[126:127], v71 offset:53760
    s_waitcnt lgkmcnt(0)
    v_perm_b32 v128, v114, v112, s14
    v_perm_b32 v129, v118, v116, s14
    v_perm_b32 v130, v122, v120, s14
    v_perm_b32 v131, v126, v124, s14
    buffer_store_dwordx4 v[128:131], v29, s[56:59], 0 offen offset:0
    v_perm_b32 v132, v114, v112, s15
    v_perm_b32 v133, v118, v116, s15
    v_perm_b32 v134, v122, v120, s15
    v_perm_b32 v135, v126, v124, s15
    buffer_store_dwordx4 v[132:135], v29, s[56:59], 0 offen offset:2304
    v_perm_b32 v136, v115, v113, s14
    v_perm_b32 v137, v119, v117, s14
    v_perm_b32 v138, v123, v121, s14
    v_perm_b32 v139, v127, v125, s14
    buffer_store_dwordx4 v[136:139], v29, s[56:59], s64 offen offset:0
    v_perm_b32 v140, v115, v113, s15
    v_perm_b32 v141, v119, v117, s15
    v_perm_b32 v142, v123, v121, s15
    v_perm_b32 v143, v127, v125, s15
    buffer_store_dwordx4 v[140:143], v29, s[56:59], s64 offen offset:2304
A_end:
    s_endpgm
L_code_end:
    s_endpgm

.section .rodata,"a"
.p2align 6
.amdhsa_kernel concat_heads__ssm_conv_s4d__linear_kernel_hedgehog__prompt_kernel
  .amdhsa_next_free_vgpr 256
  .amdhsa_next_free_sgpr 98
  .amdhsa_accum_offset 256
  .amdhsa_group_segment_fixed_size 0
  .amdhsa_kernarg_size 112
  .amdhsa_user_sgpr_count 2
  .amdhsa_user_sgpr_kernarg_segment_ptr 1
  .amdhsa_system_sgpr_workgroup_id_x 1
.end_amdhsa_kernel
```
